```python
import torch

def _softmax(x, axis=-1):
    return torch.softmax(x, dim=axis)
def _gelu(x):
    return torch.nn.functional.gelu(x, approximate="tanh")
def _silu(x):
    return torch.nn.functional.silu(x)
def _sigmoid(x):
    return torch.sigmoid(x)
def _layernorm(x, axis=-1, eps=1e-5):
    m = x.mean(dim=axis, keepdim=True)
    v = x.var(dim=axis, keepdim=True, unbiased=False)
    return (x - m) / torch.sqrt(v + eps)
def _scatter_add(tgt, idx, src, axis=0):
    return tgt.clone().index_add_(axis, idx, src)
def _segment_sum(src, seg, n):
    out = torch.zeros((n,) + src.shape[1:], dtype=src.dtype)
    return out.index_add_(0, seg, src)
def _pad(x, pw):
    flat = tuple(v for pair in reversed(pw) for v in pair)
    return torch.nn.functional.pad(x, flat)

kernel_name = 'standalone__mha_block_cached__near_ridge'

def setup_inputs():

    _w = (lambda a: (lambda t: t.to(torch.bfloat16) if t.is_floating_point() else t)(torch.as_tensor(a)))
    B, Sq, D = 8, 128, 576
    H, Sk, Dh = 32, 512, 128
    return {
        "x": _w((lambda *s: torch.randn(*s, dtype=torch.bfloat16) * 0.8)(B, Sq, D)),
        "k_cache": _w((lambda *s: torch.randn(*s, dtype=torch.bfloat16) * 0.8)(B, H, Sk, Dh)),
        "v_cache": _w((lambda *s: torch.randn(*s, dtype=torch.bfloat16) * 0.05)(B, H, Sk, Dh)),
        "wq": _w((lambda *s: torch.randn(*s, dtype=torch.bfloat16) * 0.8)(D, H * Dh) * (D ** -0.5)),
        "wo": _w((lambda *s: torch.randn(*s, dtype=torch.bfloat16) * 0.05)(H * Dh, D) * ((H * Dh) ** -0.5)),
    }

def reference(x, k_cache, v_cache, wq, wo):
    B, Sq, D = x.shape
    H, Dh = 32, 128
    q = (lambda x, *d: x.permute(*d))((x @ wq).reshape(B, Sq, H, Dh), 0, 2, 1, 3)
    scores = torch.einsum("bhqd,bhkd->bhqk", q, k_cache) * (Dh ** -0.5)
    p = _softmax(scores, axis=-1)
    o = torch.einsum("bhqk,bhkd->bhqd", p, v_cache)
    return (lambda x, *d: x.permute(*d))(o, 0, 2, 1, 3).reshape(B, Sq, H * Dh) @ wo
```

```asm
; @launch grid=(256,1,1) block=(512,1,1) lds=163840
.amdgcn_target "amdgcn-amd-amdhsa--gfx950"
.text
.globl standalone__mha_block_cached__near_ridge_kernel
.p2align 8
.type standalone__mha_block_cached__near_ridge_kernel,@function
standalone__mha_block_cached__near_ridge_kernel:
    s_load_dwordx16 s[40:55], s[0:1], 0
    s_cmp_ge_u32 s2, 256
    s_cbranch_scc1 L_end
    s_and_b32 s29, s2, 7
    s_lshr_b32 s30, s2, 3
    s_lshl_b32 s4, s29, 2
    s_and_b32 s31, s30, 3
    s_add_u32 s4, s4, s31
    s_lshr_b32 s3, s30, 2
    v_lshrrev_b32 v2, 6, v0
    v_and_b32 v1, 63, v0
    v_readfirstlane_b32 s38, v2
    s_lshl_b32 s31, s31, 1
    s_add_u32 s28, s3, s31
    s_cmp_ge_u32 s28, 9
    s_cselect_b32 s32, 9, 0
    s_sub_u32 s28, s28, s32
    s_lshl_b32 s39, s3, 5
    s_add_u32 s39, s39, s4
    s_and_b32 s5, s38, 3
    s_lshl_b32 s33, s5, 12
    s_cmp_ge_u32 s38, 4
    s_cbranch_scc1 L_loader
    s_mov_b32 s34, 0x3e0293ee
    s_mov_b32 s37, 0x4e800000
    v_and_b32 v2, 31, v1
    v_lshrrev_b32 v3, 5, v1
    v_bfe_u32 v4, v2, 1, 3
    v_xor_b32 v4, v4, v3
    v_lshlrev_b32 v4, 4, v4
    v_lshlrev_b32 v5, 7, v2
    v_add_u32 v5, s33, v5
    v_xor_b32 v6, 0, v4
    v_add_u32 v176, v5, v6
    v_add_u32 v180, 65536, v176
    v_add_u32 v184, 131072, v176
    v_xor_b32 v6, 32, v4
    v_add_u32 v177, v5, v6
    v_add_u32 v181, 65536, v177
    v_add_u32 v185, 131072, v177
    v_xor_b32 v6, 64, v4
    v_add_u32 v178, v5, v6
    v_add_u32 v182, 65536, v178
    v_add_u32 v186, 131072, v178
    v_xor_b32 v6, 96, v4
    v_add_u32 v179, v5, v6
    v_add_u32 v183, 65536, v179
    v_add_u32 v187, 131072, v179
    v_and_b32 v4, 15, v2
    v_xor_b32 v4, v4, v3
    v_lshlrev_b32 v4, 4, v4
    v_lshlrev_b32 v5, 8, v2
    v_xor_b32 v6, 0, v4
    v_add_u32 v16, v5, v6
    v_xor_b32 v6, 32, v4
    v_add_u32 v17, v5, v6
    v_xor_b32 v6, 64, v4
    v_add_u32 v18, v5, v6
    v_xor_b32 v6, 96, v4
    v_add_u32 v19, v5, v6
    v_xor_b32 v6, 128, v4
    v_add_u32 v20, v5, v6
    v_xor_b32 v6, 160, v4
    v_add_u32 v21, v5, v6
    v_xor_b32 v6, 192, v4
    v_add_u32 v22, v5, v6
    v_xor_b32 v6, 224, v4
    v_add_u32 v23, v5, v6
    v_bfe_u32 v2, v1, 4, 1
    v_bfe_u32 v4, v1, 2, 2
    v_and_b32 v5, 3, v1
    v_and_b32 v6, 1, v5
    v_lshlrev_b32 v6, 1, v6
    v_lshrrev_b32 v7, 1, v5
    v_or_b32 v6, v6, v7
    v_lshl_add_u32 v6, v2, 2, v6
    v_lshlrev_b32 v6, 3, v6
    v_lshl_add_u32 v7, v3, 3, v4
    v_lshl_add_u32 v6, v7, 8, v6
    v_xor_b32 v7, 0, v4
    v_lshl_add_u32 v188, v7, 6, v6
    v_add_u32 v192, 65536, v188
    v_add_u32 v196, 131072, v188
    v_xor_b32 v7, 1, v4
    v_lshl_add_u32 v189, v7, 6, v6
    v_add_u32 v193, 65536, v189
    v_add_u32 v197, 131072, v189
    v_xor_b32 v7, 2, v4
    v_lshl_add_u32 v190, v7, 6, v6
    v_add_u32 v194, 65536, v190
    v_add_u32 v198, 131072, v190
    v_xor_b32 v7, 3, v4
    v_lshl_add_u32 v191, v7, 6, v6
    v_add_u32 v195, 65536, v191
    v_add_u32 v199, 131072, v191
    v_lshl_add_u32 v6, v2, 2, v5
    v_lshlrev_b32 v6, 3, v6
    v_lshl_add_u32 v7, v3, 2, v4
    v_lshl_add_u32 v6, v7, 8, v6
    v_xor_b32 v7, 0, v4
    v_lshl_add_u32 v24, v7, 6, v6
    v_add_u32 v28, 131072, v24
    v_add_u32 v24, 65536, v24
    v_xor_b32 v7, 1, v4
    v_lshl_add_u32 v25, v7, 6, v6
    v_add_u32 v29, 131072, v25
    v_add_u32 v25, 65536, v25
    v_xor_b32 v7, 2, v4
    v_lshl_add_u32 v26, v7, 6, v6
    v_add_u32 v30, 131072, v26
    v_add_u32 v26, 65536, v26
    v_xor_b32 v7, 3, v4
    v_lshl_add_u32 v27, v7, 6, v6
    v_add_u32 v31, 131072, v27
    v_add_u32 v27, 65536, v27
    s_waitcnt lgkmcnt(0)
    s_lshl_b32 s29, s3, 5
    s_add_u32 s29, s29, s4
    s_lshl_b32 s30, s29, 15
    s_add_u32 s24, s54, s30
    s_addc_u32 s25, s55, 0
    s_mov_b32 s26, 32768
    s_mov_b32 s27, 0x20000
    s_add_u32 s20, s54, 25165824
    s_addc_u32 s21, s55, 0
    s_mov_b32 s22, 98304
    s_mov_b32 s23, 0x20000
    s_getreg_b32 s59, hwreg(HW_REG_XCC_ID)
    s_and_b32 s59, s59, 0xff
    s_mov_b32 s7, 0
    s_mov_b32 s56, 0
    s_or_b32 s29, s39, s5
    s_cmp_lg_u32 s29, 0
    s_cbranch_scc1 L_nononce
    s_memrealtime s[30:31]
    s_waitcnt lgkmcnt(0)
    s_or_b32 s30, s30, 1
    v_mov_b32 v2, 4
    v_mov_b32 v3, s30
    s_mov_b64 exec, 1
    global_store_dword v2, v3, s[52:53] sc1
    s_mov_b64 exec, -1
L_nononce:
    s_nop 1
    s_barrier
    ds_read_b128 v[128:131], v176 offset:0
    ds_read_b64_tr_b16 v[112:113], v188 offset:16384
    ds_read_b64_tr_b16 v[114:115], v188 offset:17408
    ds_read_b64_tr_b16 v[116:117], v189 offset:16384
    ds_read_b64_tr_b16 v[118:119], v189 offset:17408
    ds_read_b64_tr_b16 v[120:121], v190 offset:16384
    ds_read_b64_tr_b16 v[122:123], v190 offset:17408
    ds_read_b64_tr_b16 v[124:125], v191 offset:16384
    ds_read_b64_tr_b16 v[126:127], v191 offset:17408
    s_waitcnt lgkmcnt(6)
    v_mfma_f32_32x32x16_bf16 v[48:63], v[112:115], v[128:131], 0
    ds_read_b128 v[148:151], v177 offset:0
    ds_read_b64_tr_b16 v[132:133], v188 offset:20480
    ds_read_b64_tr_b16 v[134:135], v188 offset:21504
    s_waitcnt lgkmcnt(7)
    v_mfma_f32_32x32x16_bf16 v[64:79], v[116:119], v[128:131], 0
    ds_read_b64_tr_b16 v[136:137], v189 offset:20480
    ds_read_b64_tr_b16 v[138:139], v189 offset:21504
    s_waitcnt lgkmcnt(7)
    v_mfma_f32_32x32x16_bf16 v[80:95], v[120:123], v[128:131], 0
    ds_read_b64_tr_b16 v[140:141], v190 offset:20480
    ds_read_b64_tr_b16 v[142:143], v190 offset:21504
    s_waitcnt lgkmcnt(7)
    v_mfma_f32_32x32x16_bf16 v[96:111], v[124:127], v[128:131], 0
    ds_read_b64_tr_b16 v[144:145], v191 offset:20480
    ds_read_b64_tr_b16 v[146:147], v191 offset:21504
    s_waitcnt lgkmcnt(6)
    v_mfma_f32_32x32x16_bf16 v[48:63], v[132:135], v[148:151], v[48:63]
    ds_read_b128 v[168:171], v178 offset:0
    ds_read_b64_tr_b16 v[152:153], v188 offset:24576
    ds_read_b64_tr_b16 v[154:155], v188 offset:25600
    s_waitcnt lgkmcnt(7)
    v_mfma_f32_32x32x16_bf16 v[64:79], v[136:139], v[148:151], v[64:79]
    ds_read_b64_tr_b16 v[156:157], v189 offset:24576
    ds_read_b64_tr_b16 v[158:159], v189 offset:25600
    s_waitcnt lgkmcnt(7)
    v_mfma_f32_32x32x16_bf16 v[80:95], v[140:143], v[148:151], v[80:95]
    ds_read_b64_tr_b16 v[160:161], v190 offset:24576
    ds_read_b64_tr_b16 v[162:163], v190 offset:25600
    s_waitcnt lgkmcnt(7)
    v_mfma_f32_32x32x16_bf16 v[96:111], v[144:147], v[148:151], v[96:111]
    ds_read_b64_tr_b16 v[164:165], v191 offset:24576
    ds_read_b64_tr_b16 v[166:167], v191 offset:25600
    s_waitcnt lgkmcnt(6)
    v_mfma_f32_32x32x16_bf16 v[48:63], v[152:155], v[168:171], v[48:63]
    ds_read_b128 v[128:131], v179 offset:0
    ds_read_b64_tr_b16 v[112:113], v188 offset:28672
    ds_read_b64_tr_b16 v[114:115], v188 offset:29696
    s_waitcnt lgkmcnt(7)
    v_mfma_f32_32x32x16_bf16 v[64:79], v[156:159], v[168:171], v[64:79]
    ds_read_b64_tr_b16 v[116:117], v189 offset:28672
    ds_read_b64_tr_b16 v[118:119], v189 offset:29696
    s_waitcnt lgkmcnt(7)
    v_mfma_f32_32x32x16_bf16 v[80:95], v[160:163], v[168:171], v[80:95]
    ds_read_b64_tr_b16 v[120:121], v190 offset:28672
    ds_read_b64_tr_b16 v[122:123], v190 offset:29696
    s_waitcnt lgkmcnt(7)
    v_mfma_f32_32x32x16_bf16 v[96:111], v[164:167], v[168:171], v[96:111]
    ds_read_b64_tr_b16 v[124:125], v191 offset:28672
    ds_read_b64_tr_b16 v[126:127], v191 offset:29696
    s_barrier
    s_waitcnt lgkmcnt(6)
    v_mfma_f32_32x32x16_bf16 v[48:63], v[112:115], v[128:131], v[48:63]
    ds_read_b128 v[148:151], v176 offset:32768
    ds_read_b64_tr_b16 v[132:133], v188 offset:49152
    ds_read_b64_tr_b16 v[134:135], v188 offset:50176
    s_waitcnt lgkmcnt(7)
    v_mfma_f32_32x32x16_bf16 v[64:79], v[116:119], v[128:131], v[64:79]
    ds_read_b64_tr_b16 v[136:137], v189 offset:49152
    ds_read_b64_tr_b16 v[138:139], v189 offset:50176
    s_waitcnt lgkmcnt(7)
    v_mfma_f32_32x32x16_bf16 v[80:95], v[120:123], v[128:131], v[80:95]
    ds_read_b64_tr_b16 v[140:141], v190 offset:49152
    ds_read_b64_tr_b16 v[142:143], v190 offset:50176
    s_waitcnt lgkmcnt(7)
    v_mfma_f32_32x32x16_bf16 v[96:111], v[124:127], v[128:131], v[96:111]
    ds_read_b64_tr_b16 v[144:145], v191 offset:49152
    ds_read_b64_tr_b16 v[146:147], v191 offset:50176
    s_waitcnt lgkmcnt(6)
    v_mfma_f32_32x32x16_bf16 v[48:63], v[132:135], v[148:151], v[48:63]
    ds_read_b128 v[168:171], v177 offset:32768
    ds_read_b64_tr_b16 v[152:153], v188 offset:53248
    ds_read_b64_tr_b16 v[154:155], v188 offset:54272
    s_waitcnt lgkmcnt(7)
    v_mfma_f32_32x32x16_bf16 v[64:79], v[136:139], v[148:151], v[64:79]
    ds_read_b64_tr_b16 v[156:157], v189 offset:53248
    ds_read_b64_tr_b16 v[158:159], v189 offset:54272
    s_waitcnt lgkmcnt(7)
    v_mfma_f32_32x32x16_bf16 v[80:95], v[140:143], v[148:151], v[80:95]
    ds_read_b64_tr_b16 v[160:161], v190 offset:53248
    ds_read_b64_tr_b16 v[162:163], v190 offset:54272
    s_waitcnt lgkmcnt(7)
    v_mfma_f32_32x32x16_bf16 v[96:111], v[144:147], v[148:151], v[96:111]
    ds_read_b64_tr_b16 v[164:165], v191 offset:53248
    ds_read_b64_tr_b16 v[166:167], v191 offset:54272
    s_waitcnt lgkmcnt(6)
    v_mfma_f32_32x32x16_bf16 v[48:63], v[152:155], v[168:171], v[48:63]
    ds_read_b128 v[128:131], v178 offset:32768
    ds_read_b64_tr_b16 v[112:113], v188 offset:57344
    ds_read_b64_tr_b16 v[114:115], v188 offset:58368
    s_waitcnt lgkmcnt(7)
    v_mfma_f32_32x32x16_bf16 v[64:79], v[156:159], v[168:171], v[64:79]
    ds_read_b64_tr_b16 v[116:117], v189 offset:57344
    ds_read_b64_tr_b16 v[118:119], v189 offset:58368
    s_waitcnt lgkmcnt(7)
    v_mfma_f32_32x32x16_bf16 v[80:95], v[160:163], v[168:171], v[80:95]
    ds_read_b64_tr_b16 v[120:121], v190 offset:57344
    ds_read_b64_tr_b16 v[122:123], v190 offset:58368
    s_waitcnt lgkmcnt(7)
    v_mfma_f32_32x32x16_bf16 v[96:111], v[164:167], v[168:171], v[96:111]
    ds_read_b64_tr_b16 v[124:125], v191 offset:57344
    ds_read_b64_tr_b16 v[126:127], v191 offset:58368
    s_waitcnt lgkmcnt(6)
    v_mfma_f32_32x32x16_bf16 v[48:63], v[112:115], v[128:131], v[48:63]
    ds_read_b128 v[148:151], v179 offset:32768
    ds_read_b64_tr_b16 v[132:133], v188 offset:61440
    ds_read_b64_tr_b16 v[134:135], v188 offset:62464
    s_waitcnt lgkmcnt(7)
    v_mfma_f32_32x32x16_bf16 v[64:79], v[116:119], v[128:131], v[64:79]
    ds_read_b64_tr_b16 v[136:137], v189 offset:61440
    ds_read_b64_tr_b16 v[138:139], v189 offset:62464
    s_waitcnt lgkmcnt(7)
    v_mfma_f32_32x32x16_bf16 v[80:95], v[120:123], v[128:131], v[80:95]
    ds_read_b64_tr_b16 v[140:141], v190 offset:61440
    ds_read_b64_tr_b16 v[142:143], v190 offset:62464
    s_waitcnt lgkmcnt(7)
    v_mfma_f32_32x32x16_bf16 v[96:111], v[124:127], v[128:131], v[96:111]
    ds_read_b64_tr_b16 v[144:145], v191 offset:61440
    ds_read_b64_tr_b16 v[146:147], v191 offset:62464
    s_barrier
    s_waitcnt lgkmcnt(6)
    v_mfma_f32_32x32x16_bf16 v[48:63], v[132:135], v[148:151], v[48:63]
    ds_read_b128 v[168:171], v180 offset:0
    ds_read_b64_tr_b16 v[152:153], v192 offset:16384
    ds_read_b64_tr_b16 v[154:155], v192 offset:17408
    s_waitcnt lgkmcnt(7)
    v_mfma_f32_32x32x16_bf16 v[64:79], v[136:139], v[148:151], v[64:79]
    ds_read_b64_tr_b16 v[156:157], v193 offset:16384
    ds_read_b64_tr_b16 v[158:159], v193 offset:17408
    s_waitcnt lgkmcnt(7)
    v_mfma_f32_32x32x16_bf16 v[80:95], v[140:143], v[148:151], v[80:95]
    ds_read_b64_tr_b16 v[160:161], v194 offset:16384
    ds_read_b64_tr_b16 v[162:163], v194 offset:17408
    s_waitcnt lgkmcnt(7)
    v_mfma_f32_32x32x16_bf16 v[96:111], v[144:147], v[148:151], v[96:111]
    ds_read_b64_tr_b16 v[164:165], v195 offset:16384
    ds_read_b64_tr_b16 v[166:167], v195 offset:17408
    s_waitcnt lgkmcnt(6)
    v_mfma_f32_32x32x16_bf16 v[48:63], v[152:155], v[168:171], v[48:63]
    ds_read_b128 v[128:131], v181 offset:0
    ds_read_b64_tr_b16 v[112:113], v192 offset:20480
    ds_read_b64_tr_b16 v[114:115], v192 offset:21504
    s_waitcnt lgkmcnt(7)
    v_mfma_f32_32x32x16_bf16 v[64:79], v[156:159], v[168:171], v[64:79]
    ds_read_b64_tr_b16 v[116:117], v193 offset:20480
    ds_read_b64_tr_b16 v[118:119], v193 offset:21504
    s_waitcnt lgkmcnt(7)
    v_mfma_f32_32x32x16_bf16 v[80:95], v[160:163], v[168:171], v[80:95]
    ds_read_b64_tr_b16 v[120:121], v194 offset:20480
    ds_read_b64_tr_b16 v[122:123], v194 offset:21504
    s_waitcnt lgkmcnt(7)
    v_mfma_f32_32x32x16_bf16 v[96:111], v[164:167], v[168:171], v[96:111]
    ds_read_b64_tr_b16 v[124:125], v195 offset:20480
    ds_read_b64_tr_b16 v[126:127], v195 offset:21504
    s_waitcnt lgkmcnt(6)
    v_mfma_f32_32x32x16_bf16 v[48:63], v[112:115], v[128:131], v[48:63]
    ds_read_b128 v[148:151], v182 offset:0
    ds_read_b64_tr_b16 v[132:133], v192 offset:24576
    ds_read_b64_tr_b16 v[134:135], v192 offset:25600
    s_waitcnt lgkmcnt(7)
    v_mfma_f32_32x32x16_bf16 v[64:79], v[116:119], v[128:131], v[64:79]
    ds_read_b64_tr_b16 v[136:137], v193 offset:24576
    ds_read_b64_tr_b16 v[138:139], v193 offset:25600
    s_waitcnt lgkmcnt(7)
    v_mfma_f32_32x32x16_bf16 v[80:95], v[120:123], v[128:131], v[80:95]
    ds_read_b64_tr_b16 v[140:141], v194 offset:24576
    ds_read_b64_tr_b16 v[142:143], v194 offset:25600
    s_waitcnt lgkmcnt(7)
    v_mfma_f32_32x32x16_bf16 v[96:111], v[124:127], v[128:131], v[96:111]
    ds_read_b64_tr_b16 v[144:145], v195 offset:24576
    ds_read_b64_tr_b16 v[146:147], v195 offset:25600
    s_waitcnt lgkmcnt(6)
    v_mfma_f32_32x32x16_bf16 v[48:63], v[132:135], v[148:151], v[48:63]
    ds_read_b128 v[168:171], v183 offset:0
    ds_read_b64_tr_b16 v[152:153], v192 offset:28672
    ds_read_b64_tr_b16 v[154:155], v192 offset:29696
    s_waitcnt lgkmcnt(7)
    v_mfma_f32_32x32x16_bf16 v[64:79], v[136:139], v[148:151], v[64:79]
    ds_read_b64_tr_b16 v[156:157], v193 offset:28672
    ds_read_b64_tr_b16 v[158:159], v193 offset:29696
    s_waitcnt lgkmcnt(7)
    v_mfma_f32_32x32x16_bf16 v[80:95], v[140:143], v[148:151], v[80:95]
    ds_read_b64_tr_b16 v[160:161], v194 offset:28672
    ds_read_b64_tr_b16 v[162:163], v194 offset:29696
    s_waitcnt lgkmcnt(7)
    v_mfma_f32_32x32x16_bf16 v[96:111], v[144:147], v[148:151], v[96:111]
    ds_read_b64_tr_b16 v[164:165], v195 offset:28672
    ds_read_b64_tr_b16 v[166:167], v195 offset:29696
    s_barrier
    s_waitcnt lgkmcnt(6)
    v_mfma_f32_32x32x16_bf16 v[48:63], v[152:155], v[168:171], v[48:63]
    ds_read_b128 v[128:131], v180 offset:32768
    ds_read_b64_tr_b16 v[112:113], v192 offset:49152
    ds_read_b64_tr_b16 v[114:115], v192 offset:50176
    s_waitcnt lgkmcnt(7)
    v_mfma_f32_32x32x16_bf16 v[64:79], v[156:159], v[168:171], v[64:79]
    ds_read_b64_tr_b16 v[116:117], v193 offset:49152
    ds_read_b64_tr_b16 v[118:119], v193 offset:50176
    s_waitcnt lgkmcnt(7)
    v_mfma_f32_32x32x16_bf16 v[80:95], v[160:163], v[168:171], v[80:95]
    ds_read_b64_tr_b16 v[120:121], v194 offset:49152
    ds_read_b64_tr_b16 v[122:123], v194 offset:50176
    s_waitcnt lgkmcnt(7)
    v_mfma_f32_32x32x16_bf16 v[96:111], v[164:167], v[168:171], v[96:111]
    ds_read_b64_tr_b16 v[124:125], v195 offset:49152
    ds_read_b64_tr_b16 v[126:127], v195 offset:50176
    s_waitcnt lgkmcnt(6)
    v_mfma_f32_32x32x16_bf16 v[48:63], v[112:115], v[128:131], v[48:63]
    ds_read_b128 v[148:151], v181 offset:32768
    ds_read_b64_tr_b16 v[132:133], v192 offset:53248
    ds_read_b64_tr_b16 v[134:135], v192 offset:54272
    s_waitcnt lgkmcnt(7)
    v_mfma_f32_32x32x16_bf16 v[64:79], v[116:119], v[128:131], v[64:79]
    ds_read_b64_tr_b16 v[136:137], v193 offset:53248
    ds_read_b64_tr_b16 v[138:139], v193 offset:54272
    s_waitcnt lgkmcnt(7)
    v_mfma_f32_32x32x16_bf16 v[80:95], v[120:123], v[128:131], v[80:95]
    ds_read_b64_tr_b16 v[140:141], v194 offset:53248
    ds_read_b64_tr_b16 v[142:143], v194 offset:54272
    s_waitcnt lgkmcnt(7)
    v_mfma_f32_32x32x16_bf16 v[96:111], v[124:127], v[128:131], v[96:111]
    ds_read_b64_tr_b16 v[144:145], v195 offset:53248
    ds_read_b64_tr_b16 v[146:147], v195 offset:54272
    s_waitcnt lgkmcnt(6)
    v_mfma_f32_32x32x16_bf16 v[48:63], v[132:135], v[148:151], v[48:63]
    ds_read_b128 v[168:171], v182 offset:32768
    ds_read_b64_tr_b16 v[152:153], v192 offset:57344
    ds_read_b64_tr_b16 v[154:155], v192 offset:58368
    s_waitcnt lgkmcnt(7)
    v_mfma_f32_32x32x16_bf16 v[64:79], v[136:139], v[148:151], v[64:79]
    ds_read_b64_tr_b16 v[156:157], v193 offset:57344
    ds_read_b64_tr_b16 v[158:159], v193 offset:58368
    s_waitcnt lgkmcnt(7)
    v_mfma_f32_32x32x16_bf16 v[80:95], v[140:143], v[148:151], v[80:95]
    ds_read_b64_tr_b16 v[160:161], v194 offset:57344
    ds_read_b64_tr_b16 v[162:163], v194 offset:58368
    s_waitcnt lgkmcnt(7)
    v_mfma_f32_32x32x16_bf16 v[96:111], v[144:147], v[148:151], v[96:111]
    ds_read_b64_tr_b16 v[164:165], v195 offset:57344
    ds_read_b64_tr_b16 v[166:167], v195 offset:58368
    s_waitcnt lgkmcnt(6)
    v_mfma_f32_32x32x16_bf16 v[48:63], v[152:155], v[168:171], v[48:63]
    ds_read_b128 v[128:131], v183 offset:32768
    ds_read_b64_tr_b16 v[112:113], v192 offset:61440
    ds_read_b64_tr_b16 v[114:115], v192 offset:62464
    s_waitcnt lgkmcnt(7)
    v_mfma_f32_32x32x16_bf16 v[64:79], v[156:159], v[168:171], v[64:79]
    ds_read_b64_tr_b16 v[116:117], v193 offset:61440
    ds_read_b64_tr_b16 v[118:119], v193 offset:62464
    s_waitcnt lgkmcnt(7)
    v_mfma_f32_32x32x16_bf16 v[80:95], v[160:163], v[168:171], v[80:95]
    ds_read_b64_tr_b16 v[120:121], v194 offset:61440
    ds_read_b64_tr_b16 v[122:123], v194 offset:62464
    s_waitcnt lgkmcnt(7)
    v_mfma_f32_32x32x16_bf16 v[96:111], v[164:167], v[168:171], v[96:111]
    ds_read_b64_tr_b16 v[124:125], v195 offset:61440
    ds_read_b64_tr_b16 v[126:127], v195 offset:62464
    s_barrier
    s_waitcnt lgkmcnt(6)
    v_mfma_f32_32x32x16_bf16 v[48:63], v[112:115], v[128:131], v[48:63]
    ds_read_b128 v[148:151], v184 offset:0
    ds_read_b64_tr_b16 v[132:133], v196 offset:16384
    ds_read_b64_tr_b16 v[134:135], v196 offset:17408
    s_waitcnt lgkmcnt(7)
    v_mfma_f32_32x32x16_bf16 v[64:79], v[116:119], v[128:131], v[64:79]
    ds_read_b64_tr_b16 v[136:137], v197 offset:16384
    ds_read_b64_tr_b16 v[138:139], v197 offset:17408
    s_waitcnt lgkmcnt(7)
    v_mfma_f32_32x32x16_bf16 v[80:95], v[120:123], v[128:131], v[80:95]
    ds_read_b64_tr_b16 v[140:141], v198 offset:16384
    ds_read_b64_tr_b16 v[142:143], v198 offset:17408
    s_waitcnt lgkmcnt(7)
    v_mfma_f32_32x32x16_bf16 v[96:111], v[124:127], v[128:131], v[96:111]
    ds_read_b64_tr_b16 v[144:145], v199 offset:16384
    ds_read_b64_tr_b16 v[146:147], v199 offset:17408
    s_waitcnt lgkmcnt(6)
    v_mfma_f32_32x32x16_bf16 v[48:63], v[132:135], v[148:151], v[48:63]
    ds_read_b128 v[168:171], v185 offset:0
    ds_read_b64_tr_b16 v[152:153], v196 offset:20480
    ds_read_b64_tr_b16 v[154:155], v196 offset:21504
    s_waitcnt lgkmcnt(7)
    v_mfma_f32_32x32x16_bf16 v[64:79], v[136:139], v[148:151], v[64:79]
    ds_read_b64_tr_b16 v[156:157], v197 offset:20480
    ds_read_b64_tr_b16 v[158:159], v197 offset:21504
    s_waitcnt lgkmcnt(7)
    v_mfma_f32_32x32x16_bf16 v[80:95], v[140:143], v[148:151], v[80:95]
    ds_read_b64_tr_b16 v[160:161], v198 offset:20480
    ds_read_b64_tr_b16 v[162:163], v198 offset:21504
    s_waitcnt lgkmcnt(7)
    v_mfma_f32_32x32x16_bf16 v[96:111], v[144:147], v[148:151], v[96:111]
    ds_read_b64_tr_b16 v[164:165], v199 offset:20480
    ds_read_b64_tr_b16 v[166:167], v199 offset:21504
    s_waitcnt lgkmcnt(6)
    v_mfma_f32_32x32x16_bf16 v[48:63], v[152:155], v[168:171], v[48:63]
    ds_read_b128 v[128:131], v186 offset:0
    ds_read_b64_tr_b16 v[112:113], v196 offset:24576
    ds_read_b64_tr_b16 v[114:115], v196 offset:25600
    s_waitcnt lgkmcnt(7)
    v_mfma_f32_32x32x16_bf16 v[64:79], v[156:159], v[168:171], v[64:79]
    ds_read_b64_tr_b16 v[116:117], v197 offset:24576
    ds_read_b64_tr_b16 v[118:119], v197 offset:25600
    s_waitcnt lgkmcnt(7)
    v_mfma_f32_32x32x16_bf16 v[80:95], v[160:163], v[168:171], v[80:95]
    ds_read_b64_tr_b16 v[120:121], v198 offset:24576
    ds_read_b64_tr_b16 v[122:123], v198 offset:25600
    s_waitcnt lgkmcnt(7)
    v_mfma_f32_32x32x16_bf16 v[96:111], v[164:167], v[168:171], v[96:111]
    ds_read_b64_tr_b16 v[124:125], v199 offset:24576
    ds_read_b64_tr_b16 v[126:127], v199 offset:25600
    s_waitcnt lgkmcnt(6)
    v_mfma_f32_32x32x16_bf16 v[48:63], v[112:115], v[128:131], v[48:63]
    ds_read_b128 v[148:151], v187 offset:0
    ds_read_b64_tr_b16 v[132:133], v196 offset:28672
    ds_read_b64_tr_b16 v[134:135], v196 offset:29696
    s_waitcnt lgkmcnt(7)
    v_mfma_f32_32x32x16_bf16 v[64:79], v[116:119], v[128:131], v[64:79]
    ds_read_b64_tr_b16 v[136:137], v197 offset:28672
    ds_read_b64_tr_b16 v[138:139], v197 offset:29696
    s_waitcnt lgkmcnt(7)
    v_mfma_f32_32x32x16_bf16 v[80:95], v[120:123], v[128:131], v[80:95]
    ds_read_b64_tr_b16 v[140:141], v198 offset:28672
    ds_read_b64_tr_b16 v[142:143], v198 offset:29696
    s_waitcnt lgkmcnt(7)
    v_mfma_f32_32x32x16_bf16 v[96:111], v[124:127], v[128:131], v[96:111]
    ds_read_b64_tr_b16 v[144:145], v199 offset:28672
    ds_read_b64_tr_b16 v[146:147], v199 offset:29696
    s_barrier
    s_waitcnt lgkmcnt(6)
    v_mfma_f32_32x32x16_bf16 v[48:63], v[132:135], v[148:151], v[48:63]
    ds_read_b128 v[168:171], v176 offset:0
    ds_read_b64_tr_b16 v[152:153], v188 offset:16384
    ds_read_b64_tr_b16 v[154:155], v188 offset:17408
    s_waitcnt lgkmcnt(7)
    v_mfma_f32_32x32x16_bf16 v[64:79], v[136:139], v[148:151], v[64:79]
    ds_read_b64_tr_b16 v[156:157], v189 offset:16384
    ds_read_b64_tr_b16 v[158:159], v189 offset:17408
    s_waitcnt lgkmcnt(7)
    v_mfma_f32_32x32x16_bf16 v[80:95], v[140:143], v[148:151], v[80:95]
    ds_read_b64_tr_b16 v[160:161], v190 offset:16384
    ds_read_b64_tr_b16 v[162:163], v190 offset:17408
    s_waitcnt lgkmcnt(7)
    v_mfma_f32_32x32x16_bf16 v[96:111], v[144:147], v[148:151], v[96:111]
    ds_read_b64_tr_b16 v[164:165], v191 offset:16384
    ds_read_b64_tr_b16 v[166:167], v191 offset:17408
    s_waitcnt lgkmcnt(6)
    v_mfma_f32_32x32x16_bf16 v[48:63], v[152:155], v[168:171], v[48:63]
    ds_read_b128 v[128:131], v177 offset:0
    ds_read_b64_tr_b16 v[112:113], v188 offset:20480
    ds_read_b64_tr_b16 v[114:115], v188 offset:21504
    s_waitcnt lgkmcnt(7)
    v_mfma_f32_32x32x16_bf16 v[64:79], v[156:159], v[168:171], v[64:79]
    ds_read_b64_tr_b16 v[116:117], v189 offset:20480
    ds_read_b64_tr_b16 v[118:119], v189 offset:21504
    s_waitcnt lgkmcnt(7)
    v_mfma_f32_32x32x16_bf16 v[80:95], v[160:163], v[168:171], v[80:95]
    ds_read_b64_tr_b16 v[120:121], v190 offset:20480
    ds_read_b64_tr_b16 v[122:123], v190 offset:21504
    s_waitcnt lgkmcnt(7)
    v_mfma_f32_32x32x16_bf16 v[96:111], v[164:167], v[168:171], v[96:111]
    ds_read_b64_tr_b16 v[124:125], v191 offset:20480
    ds_read_b64_tr_b16 v[126:127], v191 offset:21504
    s_waitcnt lgkmcnt(6)
    v_mfma_f32_32x32x16_bf16 v[48:63], v[112:115], v[128:131], v[48:63]
    ds_read_b128 v[148:151], v178 offset:0
    ds_read_b64_tr_b16 v[132:133], v188 offset:24576
    ds_read_b64_tr_b16 v[134:135], v188 offset:25600
    s_waitcnt lgkmcnt(7)
    v_mfma_f32_32x32x16_bf16 v[64:79], v[116:119], v[128:131], v[64:79]
    ds_read_b64_tr_b16 v[136:137], v189 offset:24576
    ds_read_b64_tr_b16 v[138:139], v189 offset:25600
    s_waitcnt lgkmcnt(7)
    v_mfma_f32_32x32x16_bf16 v[80:95], v[120:123], v[128:131], v[80:95]
    ds_read_b64_tr_b16 v[140:141], v190 offset:24576
    ds_read_b64_tr_b16 v[142:143], v190 offset:25600
    s_waitcnt lgkmcnt(7)
    v_mfma_f32_32x32x16_bf16 v[96:111], v[124:127], v[128:131], v[96:111]
    ds_read_b64_tr_b16 v[144:145], v191 offset:24576
    ds_read_b64_tr_b16 v[146:147], v191 offset:25600
    s_waitcnt lgkmcnt(6)
    v_mfma_f32_32x32x16_bf16 v[48:63], v[132:135], v[148:151], v[48:63]
    ds_read_b128 v[168:171], v179 offset:0
    ds_read_b64_tr_b16 v[152:153], v188 offset:28672
    ds_read_b64_tr_b16 v[154:155], v188 offset:29696
    s_waitcnt lgkmcnt(7)
    v_mfma_f32_32x32x16_bf16 v[64:79], v[136:139], v[148:151], v[64:79]
    ds_read_b64_tr_b16 v[156:157], v189 offset:28672
    ds_read_b64_tr_b16 v[158:159], v189 offset:29696
    s_waitcnt lgkmcnt(7)
    v_mfma_f32_32x32x16_bf16 v[80:95], v[140:143], v[148:151], v[80:95]
    ds_read_b64_tr_b16 v[160:161], v190 offset:28672
    ds_read_b64_tr_b16 v[162:163], v190 offset:29696
    s_waitcnt lgkmcnt(7)
    v_mfma_f32_32x32x16_bf16 v[96:111], v[144:147], v[148:151], v[96:111]
    ds_read_b64_tr_b16 v[164:165], v191 offset:28672
    ds_read_b64_tr_b16 v[166:167], v191 offset:29696
    s_barrier
    s_waitcnt lgkmcnt(6)
    v_mfma_f32_32x32x16_bf16 v[48:63], v[152:155], v[168:171], v[48:63]
    ds_read_b128 v[128:131], v176 offset:32768
    ds_read_b64_tr_b16 v[112:113], v188 offset:49152
    ds_read_b64_tr_b16 v[114:115], v188 offset:50176
    s_waitcnt lgkmcnt(7)
    v_mfma_f32_32x32x16_bf16 v[64:79], v[156:159], v[168:171], v[64:79]
    ds_read_b64_tr_b16 v[116:117], v189 offset:49152
    ds_read_b64_tr_b16 v[118:119], v189 offset:50176
    s_waitcnt lgkmcnt(7)
    v_mfma_f32_32x32x16_bf16 v[80:95], v[160:163], v[168:171], v[80:95]
    ds_read_b64_tr_b16 v[120:121], v190 offset:49152
    ds_read_b64_tr_b16 v[122:123], v190 offset:50176
    s_waitcnt lgkmcnt(7)
    v_mfma_f32_32x32x16_bf16 v[96:111], v[164:167], v[168:171], v[96:111]
    ds_read_b64_tr_b16 v[124:125], v191 offset:49152
    ds_read_b64_tr_b16 v[126:127], v191 offset:50176
    s_waitcnt lgkmcnt(6)
    v_mfma_f32_32x32x16_bf16 v[48:63], v[112:115], v[128:131], v[48:63]
    ds_read_b128 v[148:151], v177 offset:32768
    ds_read_b64_tr_b16 v[132:133], v188 offset:53248
    ds_read_b64_tr_b16 v[134:135], v188 offset:54272
    s_waitcnt lgkmcnt(7)
    v_mfma_f32_32x32x16_bf16 v[64:79], v[116:119], v[128:131], v[64:79]
    ds_read_b64_tr_b16 v[136:137], v189 offset:53248
    ds_read_b64_tr_b16 v[138:139], v189 offset:54272
    s_waitcnt lgkmcnt(7)
    v_mfma_f32_32x32x16_bf16 v[80:95], v[120:123], v[128:131], v[80:95]
    ds_read_b64_tr_b16 v[140:141], v190 offset:53248
    ds_read_b64_tr_b16 v[142:143], v190 offset:54272
    s_waitcnt lgkmcnt(7)
    v_mfma_f32_32x32x16_bf16 v[96:111], v[124:127], v[128:131], v[96:111]
    ds_read_b64_tr_b16 v[144:145], v191 offset:53248
    ds_read_b64_tr_b16 v[146:147], v191 offset:54272
    s_waitcnt lgkmcnt(6)
    v_mfma_f32_32x32x16_bf16 v[48:63], v[132:135], v[148:151], v[48:63]
    ds_read_b128 v[168:171], v178 offset:32768
    ds_read_b64_tr_b16 v[152:153], v188 offset:57344
    ds_read_b64_tr_b16 v[154:155], v188 offset:58368
    s_waitcnt lgkmcnt(7)
    v_mfma_f32_32x32x16_bf16 v[64:79], v[136:139], v[148:151], v[64:79]
    ds_read_b64_tr_b16 v[156:157], v189 offset:57344
    ds_read_b64_tr_b16 v[158:159], v189 offset:58368
    s_waitcnt lgkmcnt(7)
    v_mfma_f32_32x32x16_bf16 v[80:95], v[140:143], v[148:151], v[80:95]
    ds_read_b64_tr_b16 v[160:161], v190 offset:57344
    ds_read_b64_tr_b16 v[162:163], v190 offset:58368
    s_waitcnt lgkmcnt(7)
    v_mfma_f32_32x32x16_bf16 v[96:111], v[144:147], v[148:151], v[96:111]
    ds_read_b64_tr_b16 v[164:165], v191 offset:57344
    ds_read_b64_tr_b16 v[166:167], v191 offset:58368
    s_waitcnt lgkmcnt(6)
    v_mfma_f32_32x32x16_bf16 v[48:63], v[152:155], v[168:171], v[48:63]
    ds_read_b128 v[128:131], v179 offset:32768
    ds_read_b64_tr_b16 v[112:113], v188 offset:61440
    ds_read_b64_tr_b16 v[114:115], v188 offset:62464
    s_waitcnt lgkmcnt(7)
    v_mfma_f32_32x32x16_bf16 v[64:79], v[156:159], v[168:171], v[64:79]
    ds_read_b64_tr_b16 v[116:117], v189 offset:61440
    ds_read_b64_tr_b16 v[118:119], v189 offset:62464
    s_waitcnt lgkmcnt(7)
    v_mfma_f32_32x32x16_bf16 v[80:95], v[160:163], v[168:171], v[80:95]
    ds_read_b64_tr_b16 v[120:121], v190 offset:61440
    ds_read_b64_tr_b16 v[122:123], v190 offset:62464
    s_waitcnt lgkmcnt(7)
    v_mfma_f32_32x32x16_bf16 v[96:111], v[164:167], v[168:171], v[96:111]
    ds_read_b64_tr_b16 v[124:125], v191 offset:61440
    ds_read_b64_tr_b16 v[126:127], v191 offset:62464
    s_barrier
    s_waitcnt lgkmcnt(6)
    v_mfma_f32_32x32x16_bf16 v[48:63], v[112:115], v[128:131], v[48:63]
    ds_read_b128 v[148:151], v180 offset:0
    ds_read_b64_tr_b16 v[132:133], v192 offset:16384
    ds_read_b64_tr_b16 v[134:135], v192 offset:17408
    s_waitcnt lgkmcnt(7)
    v_mfma_f32_32x32x16_bf16 v[64:79], v[116:119], v[128:131], v[64:79]
    ds_read_b64_tr_b16 v[136:137], v193 offset:16384
    ds_read_b64_tr_b16 v[138:139], v193 offset:17408
    s_waitcnt lgkmcnt(7)
    v_mfma_f32_32x32x16_bf16 v[80:95], v[120:123], v[128:131], v[80:95]
    ds_read_b64_tr_b16 v[140:141], v194 offset:16384
    ds_read_b64_tr_b16 v[142:143], v194 offset:17408
    s_waitcnt lgkmcnt(7)
    v_mfma_f32_32x32x16_bf16 v[96:111], v[124:127], v[128:131], v[96:111]
    ds_read_b64_tr_b16 v[144:145], v195 offset:16384
    ds_read_b64_tr_b16 v[146:147], v195 offset:17408
    s_waitcnt lgkmcnt(6)
    v_mfma_f32_32x32x16_bf16 v[48:63], v[132:135], v[148:151], v[48:63]
    ds_read_b128 v[168:171], v181 offset:0
    ds_read_b64_tr_b16 v[152:153], v192 offset:20480
    ds_read_b64_tr_b16 v[154:155], v192 offset:21504
    s_waitcnt lgkmcnt(7)
    v_mfma_f32_32x32x16_bf16 v[64:79], v[136:139], v[148:151], v[64:79]
    ds_read_b64_tr_b16 v[156:157], v193 offset:20480
    ds_read_b64_tr_b16 v[158:159], v193 offset:21504
    s_waitcnt lgkmcnt(7)
    v_mfma_f32_32x32x16_bf16 v[80:95], v[140:143], v[148:151], v[80:95]
    ds_read_b64_tr_b16 v[160:161], v194 offset:20480
    ds_read_b64_tr_b16 v[162:163], v194 offset:21504
    s_waitcnt lgkmcnt(7)
    v_mfma_f32_32x32x16_bf16 v[96:111], v[144:147], v[148:151], v[96:111]
    ds_read_b64_tr_b16 v[164:165], v195 offset:20480
    ds_read_b64_tr_b16 v[166:167], v195 offset:21504
    s_waitcnt lgkmcnt(6)
    v_mfma_f32_32x32x16_bf16 v[48:63], v[152:155], v[168:171], v[48:63]
    ds_read_b128 v[128:131], v182 offset:0
    ds_read_b64_tr_b16 v[112:113], v192 offset:24576
    ds_read_b64_tr_b16 v[114:115], v192 offset:25600
    s_waitcnt lgkmcnt(7)
    v_mfma_f32_32x32x16_bf16 v[64:79], v[156:159], v[168:171], v[64:79]
    ds_read_b64_tr_b16 v[116:117], v193 offset:24576
    ds_read_b64_tr_b16 v[118:119], v193 offset:25600
    s_waitcnt lgkmcnt(7)
    v_mfma_f32_32x32x16_bf16 v[80:95], v[160:163], v[168:171], v[80:95]
    ds_read_b64_tr_b16 v[120:121], v194 offset:24576
    ds_read_b64_tr_b16 v[122:123], v194 offset:25600
    s_waitcnt lgkmcnt(7)
    v_mfma_f32_32x32x16_bf16 v[96:111], v[164:167], v[168:171], v[96:111]
    ds_read_b64_tr_b16 v[124:125], v195 offset:24576
    ds_read_b64_tr_b16 v[126:127], v195 offset:25600
    s_waitcnt lgkmcnt(6)
    v_mfma_f32_32x32x16_bf16 v[48:63], v[112:115], v[128:131], v[48:63]
    ds_read_b128 v[148:151], v183 offset:0
    ds_read_b64_tr_b16 v[132:133], v192 offset:28672
    ds_read_b64_tr_b16 v[134:135], v192 offset:29696
    s_waitcnt lgkmcnt(7)
    v_mfma_f32_32x32x16_bf16 v[64:79], v[116:119], v[128:131], v[64:79]
    ds_read_b64_tr_b16 v[136:137], v193 offset:28672
    ds_read_b64_tr_b16 v[138:139], v193 offset:29696
    s_waitcnt lgkmcnt(7)
    v_mfma_f32_32x32x16_bf16 v[80:95], v[120:123], v[128:131], v[80:95]
    ds_read_b64_tr_b16 v[140:141], v194 offset:28672
    ds_read_b64_tr_b16 v[142:143], v194 offset:29696
    s_waitcnt lgkmcnt(7)
    v_mfma_f32_32x32x16_bf16 v[96:111], v[124:127], v[128:131], v[96:111]
    ds_read_b64_tr_b16 v[144:145], v195 offset:28672
    ds_read_b64_tr_b16 v[146:147], v195 offset:29696
    s_barrier
    s_waitcnt lgkmcnt(6)
    v_mfma_f32_32x32x16_bf16 v[48:63], v[132:135], v[148:151], v[48:63]
    ds_read_b128 v[168:171], v180 offset:32768
    ds_read_b64_tr_b16 v[152:153], v192 offset:49152
    ds_read_b64_tr_b16 v[154:155], v192 offset:50176
    s_waitcnt lgkmcnt(7)
    v_mfma_f32_32x32x16_bf16 v[64:79], v[136:139], v[148:151], v[64:79]
    ds_read_b64_tr_b16 v[156:157], v193 offset:49152
    ds_read_b64_tr_b16 v[158:159], v193 offset:50176
    s_waitcnt lgkmcnt(7)
    v_mfma_f32_32x32x16_bf16 v[80:95], v[140:143], v[148:151], v[80:95]
    ds_read_b64_tr_b16 v[160:161], v194 offset:49152
    ds_read_b64_tr_b16 v[162:163], v194 offset:50176
    s_waitcnt lgkmcnt(7)
    v_mfma_f32_32x32x16_bf16 v[96:111], v[144:147], v[148:151], v[96:111]
    ds_read_b64_tr_b16 v[164:165], v195 offset:49152
    ds_read_b64_tr_b16 v[166:167], v195 offset:50176
    s_waitcnt lgkmcnt(6)
    v_mfma_f32_32x32x16_bf16 v[48:63], v[152:155], v[168:171], v[48:63]
    ds_read_b128 v[128:131], v181 offset:32768
    ds_read_b64_tr_b16 v[112:113], v192 offset:53248
    ds_read_b64_tr_b16 v[114:115], v192 offset:54272
    s_waitcnt lgkmcnt(7)
    v_mfma_f32_32x32x16_bf16 v[64:79], v[156:159], v[168:171], v[64:79]
    ds_read_b64_tr_b16 v[116:117], v193 offset:53248
    ds_read_b64_tr_b16 v[118:119], v193 offset:54272
    s_waitcnt lgkmcnt(7)
    v_mfma_f32_32x32x16_bf16 v[80:95], v[160:163], v[168:171], v[80:95]
    ds_read_b64_tr_b16 v[120:121], v194 offset:53248
    ds_read_b64_tr_b16 v[122:123], v194 offset:54272
    s_waitcnt lgkmcnt(7)
    v_mfma_f32_32x32x16_bf16 v[96:111], v[164:167], v[168:171], v[96:111]
    ds_read_b64_tr_b16 v[124:125], v195 offset:53248
    ds_read_b64_tr_b16 v[126:127], v195 offset:54272
    s_waitcnt lgkmcnt(6)
    v_mfma_f32_32x32x16_bf16 v[48:63], v[112:115], v[128:131], v[48:63]
    ds_read_b128 v[148:151], v182 offset:32768
    ds_read_b64_tr_b16 v[132:133], v192 offset:57344
    ds_read_b64_tr_b16 v[134:135], v192 offset:58368
    s_waitcnt lgkmcnt(7)
    v_mfma_f32_32x32x16_bf16 v[64:79], v[116:119], v[128:131], v[64:79]
    ds_read_b64_tr_b16 v[136:137], v193 offset:57344
    ds_read_b64_tr_b16 v[138:139], v193 offset:58368
    s_waitcnt lgkmcnt(7)
    v_mfma_f32_32x32x16_bf16 v[80:95], v[120:123], v[128:131], v[80:95]
    ds_read_b64_tr_b16 v[140:141], v194 offset:57344
    ds_read_b64_tr_b16 v[142:143], v194 offset:58368
    s_waitcnt lgkmcnt(7)
    v_mfma_f32_32x32x16_bf16 v[96:111], v[124:127], v[128:131], v[96:111]
    ds_read_b64_tr_b16 v[144:145], v195 offset:57344
    ds_read_b64_tr_b16 v[146:147], v195 offset:58368
    s_waitcnt lgkmcnt(6)
    v_mfma_f32_32x32x16_bf16 v[48:63], v[132:135], v[148:151], v[48:63]
    ds_read_b128 v[168:171], v183 offset:32768
    ds_read_b64_tr_b16 v[152:153], v192 offset:61440
    ds_read_b64_tr_b16 v[154:155], v192 offset:62464
    s_waitcnt lgkmcnt(7)
    v_mfma_f32_32x32x16_bf16 v[64:79], v[136:139], v[148:151], v[64:79]
    ds_read_b64_tr_b16 v[156:157], v193 offset:61440
    ds_read_b64_tr_b16 v[158:159], v193 offset:62464
    s_waitcnt lgkmcnt(7)
    v_mfma_f32_32x32x16_bf16 v[80:95], v[140:143], v[148:151], v[80:95]
    ds_read_b64_tr_b16 v[160:161], v194 offset:61440
    ds_read_b64_tr_b16 v[162:163], v194 offset:62464
    s_waitcnt lgkmcnt(7)
    v_mfma_f32_32x32x16_bf16 v[96:111], v[144:147], v[148:151], v[96:111]
    ds_read_b64_tr_b16 v[164:165], v195 offset:61440
    ds_read_b64_tr_b16 v[166:167], v195 offset:62464
    s_waitcnt lgkmcnt(6)
    v_mfma_f32_32x32x16_bf16 v[48:63], v[152:155], v[168:171], v[48:63]
    s_waitcnt lgkmcnt(4)
    v_mfma_f32_32x32x16_bf16 v[64:79], v[156:159], v[168:171], v[64:79]
    s_waitcnt lgkmcnt(2)
    v_mfma_f32_32x32x16_bf16 v[80:95], v[160:163], v[168:171], v[80:95]
    s_waitcnt lgkmcnt(0)
    v_mfma_f32_32x32x16_bf16 v[96:111], v[164:167], v[168:171], v[96:111]
    s_barrier
    ds_read_b128 a[0:3], v16 offset:0
    ds_read_b128 a[4:7], v17 offset:0
    ds_read_b128 a[8:11], v18 offset:0
    ds_read_b128 a[12:15], v19 offset:0
    ds_read_b128 a[16:19], v20 offset:0
    ds_read_b128 a[20:23], v21 offset:0
    ds_read_b128 a[24:27], v22 offset:0
    v_mul_f32 v48, s34, v48
    v_mul_f32 v49, s34, v49
    v_mul_f32 v50, s34, v50
    v_mul_f32 v51, s34, v51
    v_mul_f32 v52, s34, v52
    v_mul_f32 v53, s34, v53
    v_mul_f32 v54, s34, v54
    v_mul_f32 v55, s34, v55
    v_mul_f32 v56, s34, v56
    v_mul_f32 v57, s34, v57
    v_mul_f32 v58, s34, v58
    v_mul_f32 v59, s34, v59
    v_mul_f32 v60, s34, v60
    v_mul_f32 v61, s34, v61
    v_mul_f32 v62, s34, v62
    v_mul_f32 v63, s34, v63
    v_cvt_pk_bf16_f32 v112, v48, v49
    v_cvt_pk_bf16_f32 v113, v50, v51
    v_cvt_pk_bf16_f32 v114, v52, v53
    v_cvt_pk_bf16_f32 v115, v54, v55
    v_cvt_pk_bf16_f32 v116, v56, v57
    v_cvt_pk_bf16_f32 v117, v58, v59
    v_cvt_pk_bf16_f32 v118, v60, v61
    v_cvt_pk_bf16_f32 v119, v62, v63
    v_mul_f32 v64, s34, v64
    v_mul_f32 v65, s34, v65
    v_mul_f32 v66, s34, v66
    v_mul_f32 v67, s34, v67
    v_mul_f32 v68, s34, v68
    v_mul_f32 v69, s34, v69
    v_mul_f32 v70, s34, v70
    v_mul_f32 v71, s34, v71
    v_mul_f32 v72, s34, v72
    v_mul_f32 v73, s34, v73
    v_mul_f32 v74, s34, v74
    v_mul_f32 v75, s34, v75
    v_mul_f32 v76, s34, v76
    v_mul_f32 v77, s34, v77
    v_mul_f32 v78, s34, v78
    v_mul_f32 v79, s34, v79
    v_cvt_pk_bf16_f32 v120, v64, v65
    v_cvt_pk_bf16_f32 v121, v66, v67
    v_cvt_pk_bf16_f32 v122, v68, v69
    v_cvt_pk_bf16_f32 v123, v70, v71
    v_cvt_pk_bf16_f32 v124, v72, v73
    v_cvt_pk_bf16_f32 v125, v74, v75
    v_cvt_pk_bf16_f32 v126, v76, v77
    v_cvt_pk_bf16_f32 v127, v78, v79
    v_mul_f32 v80, s34, v80
    v_mul_f32 v81, s34, v81
    v_mul_f32 v82, s34, v82
    v_mul_f32 v83, s34, v83
    v_mul_f32 v84, s34, v84
    v_mul_f32 v85, s34, v85
    v_mul_f32 v86, s34, v86
    v_mul_f32 v87, s34, v87
    v_mul_f32 v88, s34, v88
    v_mul_f32 v89, s34, v89
    v_mul_f32 v90, s34, v90
    v_mul_f32 v91, s34, v91
    v_mul_f32 v92, s34, v92
    v_mul_f32 v93, s34, v93
    v_mul_f32 v94, s34, v94
    v_mul_f32 v95, s34, v95
    v_cvt_pk_bf16_f32 v128, v80, v81
    v_cvt_pk_bf16_f32 v129, v82, v83
    v_cvt_pk_bf16_f32 v130, v84, v85
    v_cvt_pk_bf16_f32 v131, v86, v87
    v_cvt_pk_bf16_f32 v132, v88, v89
    v_cvt_pk_bf16_f32 v133, v90, v91
    v_cvt_pk_bf16_f32 v134, v92, v93
    v_cvt_pk_bf16_f32 v135, v94, v95
    v_mul_f32 v96, s34, v96
    v_mul_f32 v97, s34, v97
    v_mul_f32 v98, s34, v98
    v_mul_f32 v99, s34, v99
    v_mul_f32 v100, s34, v100
    v_mul_f32 v101, s34, v101
    v_mul_f32 v102, s34, v102
    v_mul_f32 v103, s34, v103
    v_mul_f32 v104, s34, v104
    v_mul_f32 v105, s34, v105
    v_mul_f32 v106, s34, v106
    v_mul_f32 v107, s34, v107
    v_mul_f32 v108, s34, v108
    v_mul_f32 v109, s34, v109
    v_mul_f32 v110, s34, v110
    v_mul_f32 v111, s34, v111
    v_cvt_pk_bf16_f32 v136, v96, v97
    v_cvt_pk_bf16_f32 v137, v98, v99
    v_cvt_pk_bf16_f32 v138, v100, v101
    v_cvt_pk_bf16_f32 v139, v102, v103
    v_cvt_pk_bf16_f32 v140, v104, v105
    v_cvt_pk_bf16_f32 v141, v106, v107
    v_cvt_pk_bf16_f32 v142, v108, v109
    v_cvt_pk_bf16_f32 v143, v110, v111
    s_waitcnt lgkmcnt(3)
    v_mfma_f32_32x32x16_bf16 v[144:159], a[0:3], v[112:115], 0
    ds_read_b128 a[28:31], v23 offset:0
    v_mfma_f32_32x32x16_bf16 v[144:159], a[4:7], v[116:119], v[144:159]
    ds_read_b128 a[0:3], v16 offset:8192
    v_mfma_f32_32x32x16_bf16 v[144:159], a[8:11], v[120:123], v[144:159]
    ds_read_b128 a[4:7], v17 offset:8192
    v_mfma_f32_32x32x16_bf16 v[144:159], a[12:15], v[124:127], v[144:159]
    ds_read_b128 a[8:11], v18 offset:8192
    s_waitcnt lgkmcnt(3)
    v_mfma_f32_32x32x16_bf16 v[144:159], a[16:19], v[128:131], v[144:159]
    ds_read_b128 a[12:15], v19 offset:8192
    v_mfma_f32_32x32x16_bf16 v[144:159], a[20:23], v[132:135], v[144:159]
    ds_read_b128 a[16:19], v20 offset:8192
    v_mfma_f32_32x32x16_bf16 v[144:159], a[24:27], v[136:139], v[144:159]
    ds_read_b128 a[20:23], v21 offset:8192
    v_mfma_f32_32x32x16_bf16 v[144:159], a[28:31], v[140:143], v[144:159]
    ds_read_b128 a[24:27], v22 offset:8192
    s_nop 10
    v_max3_f32 v40, v144, v145, v146
    v_max3_f32 v47, v147, v148, v149
    v_max3_f32 v40, v40, v150, v151
    v_max3_f32 v47, v47, v152, v153
    v_max3_f32 v40, v40, v154, v155
    v_max3_f32 v47, v47, v156, v157
    v_max3_f32 v40, v40, v158, v159
    v_max_f32 v40, v40, v47
    v_mov_b32 v47, v40
    s_nop 1
    v_permlane32_swap_b32 v40, v47
    v_max_f32 v40, v40, v47
    v_sub_f32 v208, 0, v40
    v_mov_b32 v209, v208
    v_mov_b32 v210, v208
    v_mov_b32 v211, v208
    v_mov_b32 v212, v208
    v_mov_b32 v213, v208
    v_mov_b32 v214, v208
    v_mov_b32 v215, v208
    v_mov_b32 v216, v208
    v_mov_b32 v217, v208
    v_mov_b32 v218, v208
    v_mov_b32 v219, v208
    v_mov_b32 v220, v208
    v_mov_b32 v221, v208
    v_mov_b32 v222, v208
    v_mov_b32 v223, v208
    v_sub_f32 v144, v144, v40
    v_sub_f32 v145, v145, v40
    v_sub_f32 v146, v146, v40
    v_sub_f32 v147, v147, v40
    v_sub_f32 v148, v148, v40
    v_sub_f32 v149, v149, v40
    v_sub_f32 v150, v150, v40
    v_sub_f32 v151, v151, v40
    v_sub_f32 v152, v152, v40
    v_sub_f32 v153, v153, v40
    v_sub_f32 v154, v154, v40
    v_sub_f32 v155, v155, v40
    v_sub_f32 v156, v156, v40
    v_sub_f32 v157, v157, v40
    v_sub_f32 v158, v158, v40
    v_sub_f32 v159, v159, v40
    s_waitcnt lgkmcnt(3)
    v_mfma_f32_32x32x16_bf16 v[160:175], a[0:3], v[112:115], v[208:223]
    ds_read_b128 a[28:31], v23 offset:8192
    v_exp_f32 v192, v144
    v_exp_f32 v193, v145
    v_exp_f32 v194, v146
    v_exp_f32 v195, v147
    v_mfma_f32_32x32x16_bf16 v[160:175], a[4:7], v[116:119], v[160:175]
    s_barrier
    ds_read_b128 a[0:3], v16 offset:16384
    v_exp_f32 v196, v148
    v_exp_f32 v197, v149
    v_exp_f32 v198, v150
    v_mfma_f32_32x32x16_bf16 v[160:175], a[8:11], v[120:123], v[160:175]
    ds_read_b128 a[4:7], v17 offset:16384
    v_exp_f32 v199, v151
    v_add_f32 v44, v192, v193
    v_add_f32 v45, v194, v195
    v_cvt_pk_bf16_f32 v176, v192, v193
    v_cvt_pk_bf16_f32 v177, v194, v195
    v_exp_f32 v200, v152
    v_mfma_f32_32x32x16_bf16 v[160:175], a[12:15], v[124:127], v[160:175]
    ds_read_b128 a[8:11], v18 offset:16384
    v_exp_f32 v201, v153
    v_exp_f32 v202, v154
    v_exp_f32 v203, v155
    s_waitcnt lgkmcnt(3)
    v_mfma_f32_32x32x16_bf16 v[160:175], a[16:19], v[128:131], v[160:175]
    ds_read_b128 a[12:15], v19 offset:16384
    v_add_f32 v44, v44, v196
    v_add_f32 v45, v45, v197
    v_add_f32 v44, v44, v198
    v_add_f32 v45, v45, v199
    v_cvt_pk_bf16_f32 v178, v196, v197
    v_cvt_pk_bf16_f32 v179, v198, v199
    v_exp_f32 v204, v156
    v_mfma_f32_32x32x16_bf16 v[160:175], a[20:23], v[132:135], v[160:175]
    ds_read_b128 a[16:19], v20 offset:16384
    v_exp_f32 v205, v157
    v_exp_f32 v206, v158
    v_exp_f32 v207, v159
    v_mfma_f32_32x32x16_bf16 v[160:175], a[24:27], v[136:139], v[160:175]
    ds_read_b128 a[20:23], v21 offset:16384
    v_add_f32 v44, v44, v200
    v_add_f32 v45, v45, v201
    v_add_f32 v44, v44, v202
    v_add_f32 v45, v45, v203
    v_add_f32 v44, v44, v204
    v_add_f32 v45, v45, v205
    v_add_f32 v44, v44, v206
    v_mfma_f32_32x32x16_bf16 v[160:175], a[28:31], v[140:143], v[160:175]
    ds_read_b128 a[24:27], v22 offset:16384
    v_add_f32 v45, v45, v207
    v_add_f32 v44, v44, v45
    v_cmp_nge_f32 vcc, s37, v44
    v_cvt_pk_bf16_f32 v180, v200, v201
    v_cvt_pk_bf16_f32 v181, v202, v203
    v_cvt_pk_bf16_f32 v182, v204, v205
    v_cvt_pk_bf16_f32 v183, v206, v207
    s_cbranch_vccnz L_rare0
L_back0:
    v_mov_b32 v41, v44
    s_waitcnt lgkmcnt(3)
    v_mfma_f32_32x32x16_bf16 v[144:159], a[0:3], v[112:115], v[208:223]
    ds_read_b128 a[28:31], v23 offset:16384
    v_exp_f32 v192, v160
    v_exp_f32 v193, v161
    v_mfma_f32_32x32x16_bf16 v[144:159], a[4:7], v[116:119], v[144:159]
    ds_read_b64_tr_b16 a[0:1], v28 offset:0
    ds_read_b64_tr_b16 a[2:3], v28 offset:2048
    v_exp_f32 v194, v162
    v_exp_f32 v195, v163
    v_mfma_f32_32x32x16_bf16 v[144:159], a[8:11], v[120:123], v[144:159]
    ds_read_b64_tr_b16 a[4:5], v29 offset:0
    ds_read_b64_tr_b16 a[6:7], v29 offset:2048
    v_exp_f32 v196, v164
    v_mfma_f32_32x32x16_bf16 v[144:159], a[12:15], v[124:127], v[144:159]
    ds_read_b64_tr_b16 a[8:9], v30 offset:0
    ds_read_b64_tr_b16 a[10:11], v30 offset:2048
    v_exp_f32 v197, v165
    v_exp_f32 v198, v166
    s_waitcnt lgkmcnt(6)
    v_mfma_f32_32x32x16_bf16 v[144:159], a[16:19], v[128:131], v[144:159]
    ds_read_b64_tr_b16 a[12:13], v31 offset:0
    ds_read_b64_tr_b16 a[14:15], v31 offset:2048
    v_exp_f32 v199, v167
    v_add_f32 v44, v192, v193
    v_add_f32 v45, v194, v195
    v_mfma_f32_32x32x16_bf16 v[144:159], a[20:23], v[132:135], v[144:159]
    ds_read_b64_tr_b16 a[16:17], v28 offset:4096
    ds_read_b64_tr_b16 a[18:19], v28 offset:6144
    v_cvt_pk_bf16_f32 v184, v192, v193
    v_cvt_pk_bf16_f32 v185, v194, v195
    v_exp_f32 v200, v168
    v_mfma_f32_32x32x16_bf16 v[144:159], a[24:27], v[136:139], v[144:159]
    ds_read_b64_tr_b16 a[20:21], v29 offset:4096
    ds_read_b64_tr_b16 a[22:23], v29 offset:6144
    v_exp_f32 v201, v169
    v_mfma_f32_32x32x16_bf16 v[144:159], a[28:31], v[140:143], v[144:159]
    ds_read_b64_tr_b16 a[24:25], v30 offset:4096
    ds_read_b64_tr_b16 a[26:27], v30 offset:6144
    v_exp_f32 v202, v170
    v_exp_f32 v203, v171
    s_waitcnt lgkmcnt(6)
    v_mfma_f32_32x32x16_bf16 v[48:63], a[0:3], v[176:179], 0
    ds_read_b64_tr_b16 a[28:29], v31 offset:4096
    ds_read_b64_tr_b16 a[30:31], v31 offset:6144
    v_add_f32 v44, v44, v196
    v_add_f32 v45, v45, v197
    v_add_f32 v44, v44, v198
    v_add_f32 v45, v45, v199
    v_mfma_f32_32x32x16_bf16 v[64:79], a[4:7], v[176:179], 0
    ds_read_b128 a[0:3], v16 offset:24576
    v_cvt_pk_bf16_f32 v186, v196, v197
    v_cvt_pk_bf16_f32 v187, v198, v199
    v_exp_f32 v204, v172
    v_mfma_f32_32x32x16_bf16 v[80:95], a[8:11], v[176:179], 0
    ds_read_b128 a[4:7], v17 offset:24576
    v_exp_f32 v205, v173
    v_mfma_f32_32x32x16_bf16 v[96:111], a[12:15], v[176:179], 0
    ds_read_b128 a[8:11], v18 offset:24576
    v_exp_f32 v206, v174
    v_exp_f32 v207, v175
    s_waitcnt lgkmcnt(3)
    v_mfma_f32_32x32x16_bf16 v[48:63], a[16:19], v[180:183], v[48:63]
    ds_read_b128 a[12:15], v19 offset:24576
    v_add_f32 v44, v44, v200
    v_add_f32 v45, v45, v201
    v_add_f32 v44, v44, v202
    v_add_f32 v45, v45, v203
    v_mfma_f32_32x32x16_bf16 v[64:79], a[20:23], v[180:183], v[64:79]
    ds_read_b128 a[16:19], v20 offset:24576
    v_add_f32 v44, v44, v204
    v_add_f32 v45, v45, v205
    v_add_f32 v44, v44, v206
    v_mfma_f32_32x32x16_bf16 v[80:95], a[24:27], v[180:183], v[80:95]
    ds_read_b128 a[20:23], v21 offset:24576
    v_add_f32 v45, v45, v207
    v_add_f32 v44, v44, v45
    v_cmp_nge_f32 vcc, s37, v44
    v_cvt_pk_bf16_f32 v188, v200, v201
    v_mfma_f32_32x32x16_bf16 v[96:111], a[28:31], v[180:183], v[96:111]
    ds_read_b128 a[24:27], v22 offset:24576
    v_cvt_pk_bf16_f32 v189, v202, v203
    v_cvt_pk_bf16_f32 v190, v204, v205
    v_cvt_pk_bf16_f32 v191, v206, v207
    s_cbranch_vccnz L_rare1
L_back1:
    v_add_f32 v41, v41, v44
    v_mov_b32 v4, 4
    global_load_dword v2, v4, s[52:53]
    s_waitcnt lgkmcnt(3)
    v_mfma_f32_32x32x16_bf16 v[160:175], a[0:3], v[112:115], v[208:223]
    ds_read_b128 a[28:31], v23 offset:24576
    v_exp_f32 v192, v144
    v_exp_f32 v193, v145
    v_mfma_f32_32x32x16_bf16 v[160:175], a[4:7], v[116:119], v[160:175]
    ds_read_b64_tr_b16 a[0:1], v28 offset:8192
    ds_read_b64_tr_b16 a[2:3], v28 offset:10240
    v_exp_f32 v194, v146
    v_exp_f32 v195, v147
    v_mfma_f32_32x32x16_bf16 v[160:175], a[8:11], v[120:123], v[160:175]
    ds_read_b64_tr_b16 a[4:5], v29 offset:8192
    ds_read_b64_tr_b16 a[6:7], v29 offset:10240
    v_exp_f32 v196, v148
    v_mfma_f32_32x32x16_bf16 v[160:175], a[12:15], v[124:127], v[160:175]
    ds_read_b64_tr_b16 a[8:9], v30 offset:8192
    ds_read_b64_tr_b16 a[10:11], v30 offset:10240
    v_exp_f32 v197, v149
    v_exp_f32 v198, v150
    s_waitcnt lgkmcnt(6)
    v_mfma_f32_32x32x16_bf16 v[160:175], a[16:19], v[128:131], v[160:175]
    ds_read_b64_tr_b16 a[12:13], v31 offset:8192
    ds_read_b64_tr_b16 a[14:15], v31 offset:10240
    v_exp_f32 v199, v151
    v_add_f32 v44, v192, v193
    v_add_f32 v45, v194, v195
    v_mfma_f32_32x32x16_bf16 v[160:175], a[20:23], v[132:135], v[160:175]
    ds_read_b64_tr_b16 a[16:17], v28 offset:12288
    ds_read_b64_tr_b16 a[18:19], v28 offset:14336
    v_cvt_pk_bf16_f32 v176, v192, v193
    v_cvt_pk_bf16_f32 v177, v194, v195
    v_exp_f32 v200, v152
    v_mfma_f32_32x32x16_bf16 v[160:175], a[24:27], v[136:139], v[160:175]
    ds_read_b64_tr_b16 a[20:21], v29 offset:12288
    ds_read_b64_tr_b16 a[22:23], v29 offset:14336
    v_exp_f32 v201, v153
    v_mfma_f32_32x32x16_bf16 v[160:175], a[28:31], v[140:143], v[160:175]
    ds_read_b64_tr_b16 a[24:25], v30 offset:12288
    ds_read_b64_tr_b16 a[26:27], v30 offset:14336
    v_exp_f32 v202, v154
    v_exp_f32 v203, v155
    s_waitcnt lgkmcnt(6)
    v_mfma_f32_32x32x16_bf16 v[48:63], a[0:3], v[184:187], v[48:63]
    ds_read_b64_tr_b16 a[28:29], v31 offset:12288
    ds_read_b64_tr_b16 a[30:31], v31 offset:14336
    v_add_f32 v44, v44, v196
    v_add_f32 v45, v45, v197
    v_add_f32 v44, v44, v198
    v_add_f32 v45, v45, v199
    v_mfma_f32_32x32x16_bf16 v[64:79], a[4:7], v[184:187], v[64:79]
    s_barrier
    ds_read_b128 a[0:3], v16 offset:32768
    v_cvt_pk_bf16_f32 v178, v196, v197
    v_cvt_pk_bf16_f32 v179, v198, v199
    v_exp_f32 v204, v156
    v_mfma_f32_32x32x16_bf16 v[80:95], a[8:11], v[184:187], v[80:95]
    ds_read_b128 a[4:7], v17 offset:32768
    v_exp_f32 v205, v157
    v_mfma_f32_32x32x16_bf16 v[96:111], a[12:15], v[184:187], v[96:111]
    ds_read_b128 a[8:11], v18 offset:32768
    v_exp_f32 v206, v158
    v_exp_f32 v207, v159
    s_waitcnt lgkmcnt(3)
    v_mfma_f32_32x32x16_bf16 v[48:63], a[16:19], v[188:191], v[48:63]
    ds_read_b128 a[12:15], v19 offset:32768
    v_add_f32 v44, v44, v200
    v_add_f32 v45, v45, v201
    v_add_f32 v44, v44, v202
    v_add_f32 v45, v45, v203
    v_mfma_f32_32x32x16_bf16 v[64:79], a[20:23], v[188:191], v[64:79]
    ds_read_b128 a[16:19], v20 offset:32768
    v_add_f32 v44, v44, v204
    v_add_f32 v45, v45, v205
    v_add_f32 v44, v44, v206
    v_mfma_f32_32x32x16_bf16 v[80:95], a[24:27], v[188:191], v[80:95]
    ds_read_b128 a[20:23], v21 offset:32768
    v_add_f32 v45, v45, v207
    v_add_f32 v44, v44, v45
    v_cmp_nge_f32 vcc, s37, v44
    v_cvt_pk_bf16_f32 v180, v200, v201
    v_mfma_f32_32x32x16_bf16 v[96:111], a[28:31], v[188:191], v[96:111]
    ds_read_b128 a[24:27], v22 offset:32768
    v_cvt_pk_bf16_f32 v181, v202, v203
    v_cvt_pk_bf16_f32 v182, v204, v205
    v_cvt_pk_bf16_f32 v183, v206, v207
    s_cbranch_vccnz L_rare2
L_back2:
    v_add_f32 v41, v41, v44
    s_waitcnt lgkmcnt(3)
    v_mfma_f32_32x32x16_bf16 v[144:159], a[0:3], v[112:115], v[208:223]
    ds_read_b128 a[28:31], v23 offset:32768
    v_exp_f32 v192, v160
    v_exp_f32 v193, v161
    v_mfma_f32_32x32x16_bf16 v[144:159], a[4:7], v[116:119], v[144:159]
    ds_read_b64_tr_b16 a[0:1], v28 offset:16384
    ds_read_b64_tr_b16 a[2:3], v28 offset:18432
    v_exp_f32 v194, v162
    v_exp_f32 v195, v163
    v_mfma_f32_32x32x16_bf16 v[144:159], a[8:11], v[120:123], v[144:159]
    ds_read_b64_tr_b16 a[4:5], v29 offset:16384
    ds_read_b64_tr_b16 a[6:7], v29 offset:18432
    v_exp_f32 v196, v164
    v_mfma_f32_32x32x16_bf16 v[144:159], a[12:15], v[124:127], v[144:159]
    ds_read_b64_tr_b16 a[8:9], v30 offset:16384
    ds_read_b64_tr_b16 a[10:11], v30 offset:18432
    v_exp_f32 v197, v165
    v_exp_f32 v198, v166
    s_waitcnt lgkmcnt(6)
    v_mfma_f32_32x32x16_bf16 v[144:159], a[16:19], v[128:131], v[144:159]
    ds_read_b64_tr_b16 a[12:13], v31 offset:16384
    ds_read_b64_tr_b16 a[14:15], v31 offset:18432
    v_exp_f32 v199, v167
    v_add_f32 v44, v192, v193
    v_add_f32 v45, v194, v195
    v_mfma_f32_32x32x16_bf16 v[144:159], a[20:23], v[132:135], v[144:159]
    ds_read_b64_tr_b16 a[16:17], v28 offset:20480
    ds_read_b64_tr_b16 a[18:19], v28 offset:22528
    v_cvt_pk_bf16_f32 v184, v192, v193
    v_cvt_pk_bf16_f32 v185, v194, v195
    v_exp_f32 v200, v168
    v_mfma_f32_32x32x16_bf16 v[144:159], a[24:27], v[136:139], v[144:159]
    ds_read_b64_tr_b16 a[20:21], v29 offset:20480
    ds_read_b64_tr_b16 a[22:23], v29 offset:22528
    v_exp_f32 v201, v169
    v_mfma_f32_32x32x16_bf16 v[144:159], a[28:31], v[140:143], v[144:159]
    ds_read_b64_tr_b16 a[24:25], v30 offset:20480
    ds_read_b64_tr_b16 a[26:27], v30 offset:22528
    v_exp_f32 v202, v170
    v_exp_f32 v203, v171
    s_waitcnt lgkmcnt(6)
    v_mfma_f32_32x32x16_bf16 v[48:63], a[0:3], v[176:179], v[48:63]
    ds_read_b64_tr_b16 a[28:29], v31 offset:20480
    ds_read_b64_tr_b16 a[30:31], v31 offset:22528
    v_add_f32 v44, v44, v196
    v_add_f32 v45, v45, v197
    v_add_f32 v44, v44, v198
    v_add_f32 v45, v45, v199
    v_mfma_f32_32x32x16_bf16 v[64:79], a[4:7], v[176:179], v[64:79]
    ds_read_b128 a[0:3], v16 offset:40960
    v_cvt_pk_bf16_f32 v186, v196, v197
    v_cvt_pk_bf16_f32 v187, v198, v199
    v_exp_f32 v204, v172
    v_mfma_f32_32x32x16_bf16 v[80:95], a[8:11], v[176:179], v[80:95]
    ds_read_b128 a[4:7], v17 offset:40960
    v_exp_f32 v205, v173
    v_mfma_f32_32x32x16_bf16 v[96:111], a[12:15], v[176:179], v[96:111]
    ds_read_b128 a[8:11], v18 offset:40960
    v_exp_f32 v206, v174
    v_exp_f32 v207, v175
    s_waitcnt lgkmcnt(3)
    v_mfma_f32_32x32x16_bf16 v[48:63], a[16:19], v[180:183], v[48:63]
    ds_read_b128 a[12:15], v19 offset:40960
    v_add_f32 v44, v44, v200
    v_add_f32 v45, v45, v201
    v_add_f32 v44, v44, v202
    v_add_f32 v45, v45, v203
    v_mfma_f32_32x32x16_bf16 v[64:79], a[20:23], v[180:183], v[64:79]
    ds_read_b128 a[16:19], v20 offset:40960
    v_add_f32 v44, v44, v204
    v_add_f32 v45, v45, v205
    v_add_f32 v44, v44, v206
    v_mfma_f32_32x32x16_bf16 v[80:95], a[24:27], v[180:183], v[80:95]
    ds_read_b128 a[20:23], v21 offset:40960
    v_add_f32 v45, v45, v207
    v_add_f32 v44, v44, v45
    v_cmp_nge_f32 vcc, s37, v44
    v_cvt_pk_bf16_f32 v188, v200, v201
    v_mfma_f32_32x32x16_bf16 v[96:111], a[28:31], v[180:183], v[96:111]
    ds_read_b128 a[24:27], v22 offset:40960
    v_cvt_pk_bf16_f32 v189, v202, v203
    v_cvt_pk_bf16_f32 v190, v204, v205
    v_cvt_pk_bf16_f32 v191, v206, v207
    s_cbranch_vccnz L_rare3
L_back3:
    v_add_f32 v41, v41, v44
    s_waitcnt vmcnt(0)
    v_readfirstlane_b32 s58, v2
    s_nop 3
    s_cmp_lg_u32 s58, 0
    s_cbranch_scc1 L_nonok
    s_mov_b32 s32, 200000
L_nonpoll:
    global_load_dword v2, v4, s[52:53] sc1
    s_waitcnt vmcnt(0)
    v_readfirstlane_b32 s58, v2
    s_nop 3
    s_cmp_lg_u32 s58, 0
    s_cbranch_scc1 L_nonok
    s_sub_u32 s32, s32, 1
    s_cmp_lg_u32 s32, 0
    s_cbranch_scc1 L_nonpoll
L_nonok:
    s_nop 3
    s_cmp_lg_u32 s5, 0
    s_cbranch_scc1 L_noxw
    s_lshl_b32 s29, s39, 7
    s_add_u32 s29, s29, 65536
    v_mov_b32 v2, s58
    v_mov_b32 v3, s59
    buffer_store_dwordx2 v[2:3], off, s[20:23], s29 sc1
L_noxw:
    s_nop 1
    s_waitcnt lgkmcnt(3)
    v_mfma_f32_32x32x16_bf16 v[160:175], a[0:3], v[112:115], v[208:223]
    ds_read_b128 a[28:31], v23 offset:40960
    v_exp_f32 v192, v144
    v_exp_f32 v193, v145
    v_mfma_f32_32x32x16_bf16 v[160:175], a[4:7], v[116:119], v[160:175]
    ds_read_b64_tr_b16 a[0:1], v28 offset:24576
    ds_read_b64_tr_b16 a[2:3], v28 offset:26624
    v_exp_f32 v194, v146
    v_exp_f32 v195, v147
    v_mfma_f32_32x32x16_bf16 v[160:175], a[8:11], v[120:123], v[160:175]
    ds_read_b64_tr_b16 a[4:5], v29 offset:24576
    ds_read_b64_tr_b16 a[6:7], v29 offset:26624
    v_exp_f32 v196, v148
    v_mfma_f32_32x32x16_bf16 v[160:175], a[12:15], v[124:127], v[160:175]
    ds_read_b64_tr_b16 a[8:9], v30 offset:24576
    ds_read_b64_tr_b16 a[10:11], v30 offset:26624
    v_exp_f32 v197, v149
    v_exp_f32 v198, v150
    s_waitcnt lgkmcnt(6)
    v_mfma_f32_32x32x16_bf16 v[160:175], a[16:19], v[128:131], v[160:175]
    ds_read_b64_tr_b16 a[12:13], v31 offset:24576
    ds_read_b64_tr_b16 a[14:15], v31 offset:26624
    v_exp_f32 v199, v151
    v_add_f32 v44, v192, v193
    v_add_f32 v45, v194, v195
    v_mfma_f32_32x32x16_bf16 v[160:175], a[20:23], v[132:135], v[160:175]
    ds_read_b64_tr_b16 a[16:17], v28 offset:28672
    ds_read_b64_tr_b16 a[18:19], v28 offset:30720
    v_cvt_pk_bf16_f32 v176, v192, v193
    v_cvt_pk_bf16_f32 v177, v194, v195
    v_exp_f32 v200, v152
    v_mfma_f32_32x32x16_bf16 v[160:175], a[24:27], v[136:139], v[160:175]
    ds_read_b64_tr_b16 a[20:21], v29 offset:28672
    ds_read_b64_tr_b16 a[22:23], v29 offset:30720
    v_exp_f32 v201, v153
    v_mfma_f32_32x32x16_bf16 v[160:175], a[28:31], v[140:143], v[160:175]
    ds_read_b64_tr_b16 a[24:25], v30 offset:28672
    ds_read_b64_tr_b16 a[26:27], v30 offset:30720
    v_exp_f32 v202, v154
    v_exp_f32 v203, v155
    s_waitcnt lgkmcnt(6)
    v_mfma_f32_32x32x16_bf16 v[48:63], a[0:3], v[184:187], v[48:63]
    ds_read_b64_tr_b16 a[28:29], v31 offset:28672
    ds_read_b64_tr_b16 a[30:31], v31 offset:30720
    v_add_f32 v44, v44, v196
    v_add_f32 v45, v45, v197
    v_add_f32 v44, v44, v198
    v_add_f32 v45, v45, v199
    v_mfma_f32_32x32x16_bf16 v[64:79], a[4:7], v[184:187], v[64:79]
    s_barrier
    ds_read_b128 a[0:3], v16 offset:49152
    v_cvt_pk_bf16_f32 v178, v196, v197
    v_cvt_pk_bf16_f32 v179, v198, v199
    v_exp_f32 v204, v156
    v_mfma_f32_32x32x16_bf16 v[80:95], a[8:11], v[184:187], v[80:95]
    ds_read_b128 a[4:7], v17 offset:49152
    v_exp_f32 v205, v157
    v_mfma_f32_32x32x16_bf16 v[96:111], a[12:15], v[184:187], v[96:111]
    ds_read_b128 a[8:11], v18 offset:49152
    v_exp_f32 v206, v158
    v_exp_f32 v207, v159
    s_waitcnt lgkmcnt(3)
    v_mfma_f32_32x32x16_bf16 v[48:63], a[16:19], v[188:191], v[48:63]
    ds_read_b128 a[12:15], v19 offset:49152
    v_add_f32 v44, v44, v200
    v_add_f32 v45, v45, v201
    v_add_f32 v44, v44, v202
    v_add_f32 v45, v45, v203
    v_mfma_f32_32x32x16_bf16 v[64:79], a[20:23], v[188:191], v[64:79]
    ds_read_b128 a[16:19], v20 offset:49152
    v_add_f32 v44, v44, v204
    v_add_f32 v45, v45, v205
    v_add_f32 v44, v44, v206
    v_mfma_f32_32x32x16_bf16 v[80:95], a[24:27], v[188:191], v[80:95]
    ds_read_b128 a[20:23], v21 offset:49152
    v_add_f32 v45, v45, v207
    v_add_f32 v44, v44, v45
    v_cmp_nge_f32 vcc, s37, v44
    v_cvt_pk_bf16_f32 v180, v200, v201
    v_mfma_f32_32x32x16_bf16 v[96:111], a[28:31], v[188:191], v[96:111]
    ds_read_b128 a[24:27], v22 offset:49152
    v_cvt_pk_bf16_f32 v181, v202, v203
    v_cvt_pk_bf16_f32 v182, v204, v205
    v_cvt_pk_bf16_f32 v183, v206, v207
    s_cbranch_vccnz L_rare4
L_back4:
    v_add_f32 v41, v41, v44
    s_waitcnt lgkmcnt(3)
    v_mfma_f32_32x32x16_bf16 v[144:159], a[0:3], v[112:115], v[208:223]
    ds_read_b128 a[28:31], v23 offset:49152
    v_exp_f32 v192, v160
    v_exp_f32 v193, v161
    v_mfma_f32_32x32x16_bf16 v[144:159], a[4:7], v[116:119], v[144:159]
    ds_read_b64_tr_b16 a[0:1], v24 offset:0
    ds_read_b64_tr_b16 a[2:3], v24 offset:2048
    v_exp_f32 v194, v162
    v_exp_f32 v195, v163
    v_mfma_f32_32x32x16_bf16 v[144:159], a[8:11], v[120:123], v[144:159]
    ds_read_b64_tr_b16 a[4:5], v25 offset:0
    ds_read_b64_tr_b16 a[6:7], v25 offset:2048
    v_exp_f32 v196, v164
    v_mfma_f32_32x32x16_bf16 v[144:159], a[12:15], v[124:127], v[144:159]
    ds_read_b64_tr_b16 a[8:9], v26 offset:0
    ds_read_b64_tr_b16 a[10:11], v26 offset:2048
    v_exp_f32 v197, v165
    v_exp_f32 v198, v166
    s_waitcnt lgkmcnt(6)
    v_mfma_f32_32x32x16_bf16 v[144:159], a[16:19], v[128:131], v[144:159]
    ds_read_b64_tr_b16 a[12:13], v27 offset:0
    ds_read_b64_tr_b16 a[14:15], v27 offset:2048
    v_exp_f32 v199, v167
    v_add_f32 v44, v192, v193
    v_add_f32 v45, v194, v195
    v_mfma_f32_32x32x16_bf16 v[144:159], a[20:23], v[132:135], v[144:159]
    ds_read_b64_tr_b16 a[16:17], v24 offset:4096
    ds_read_b64_tr_b16 a[18:19], v24 offset:6144
    v_cvt_pk_bf16_f32 v184, v192, v193
    v_cvt_pk_bf16_f32 v185, v194, v195
    v_exp_f32 v200, v168
    v_mfma_f32_32x32x16_bf16 v[144:159], a[24:27], v[136:139], v[144:159]
    ds_read_b64_tr_b16 a[20:21], v25 offset:4096
    ds_read_b64_tr_b16 a[22:23], v25 offset:6144
    v_exp_f32 v201, v169
    v_mfma_f32_32x32x16_bf16 v[144:159], a[28:31], v[140:143], v[144:159]
    ds_read_b64_tr_b16 a[24:25], v26 offset:4096
    ds_read_b64_tr_b16 a[26:27], v26 offset:6144
    v_exp_f32 v202, v170
    v_exp_f32 v203, v171
    s_waitcnt lgkmcnt(6)
    v_mfma_f32_32x32x16_bf16 v[48:63], a[0:3], v[176:179], v[48:63]
    ds_read_b64_tr_b16 a[28:29], v27 offset:4096
    ds_read_b64_tr_b16 a[30:31], v27 offset:6144
    v_add_f32 v44, v44, v196
    v_add_f32 v45, v45, v197
    v_add_f32 v44, v44, v198
    v_add_f32 v45, v45, v199
    v_mfma_f32_32x32x16_bf16 v[64:79], a[4:7], v[176:179], v[64:79]
    ds_read_b128 a[0:3], v16 offset:57344
    v_cvt_pk_bf16_f32 v186, v196, v197
    v_cvt_pk_bf16_f32 v187, v198, v199
    v_exp_f32 v204, v172
    v_mfma_f32_32x32x16_bf16 v[80:95], a[8:11], v[176:179], v[80:95]
    ds_read_b128 a[4:7], v17 offset:57344
    v_exp_f32 v205, v173
    v_mfma_f32_32x32x16_bf16 v[96:111], a[12:15], v[176:179], v[96:111]
    ds_read_b128 a[8:11], v18 offset:57344
    v_exp_f32 v206, v174
    v_exp_f32 v207, v175
    s_waitcnt lgkmcnt(3)
    v_mfma_f32_32x32x16_bf16 v[48:63], a[16:19], v[180:183], v[48:63]
    ds_read_b128 a[12:15], v19 offset:57344
    v_add_f32 v44, v44, v200
    v_add_f32 v45, v45, v201
    v_add_f32 v44, v44, v202
    v_add_f32 v45, v45, v203
    v_mfma_f32_32x32x16_bf16 v[64:79], a[20:23], v[180:183], v[64:79]
    ds_read_b128 a[16:19], v20 offset:57344
    v_add_f32 v44, v44, v204
    v_add_f32 v45, v45, v205
    v_add_f32 v44, v44, v206
    v_mfma_f32_32x32x16_bf16 v[80:95], a[24:27], v[180:183], v[80:95]
    ds_read_b128 a[20:23], v21 offset:57344
    v_add_f32 v45, v45, v207
    v_add_f32 v44, v44, v45
    v_cmp_nge_f32 vcc, s37, v44
    v_cvt_pk_bf16_f32 v188, v200, v201
    v_mfma_f32_32x32x16_bf16 v[96:111], a[28:31], v[180:183], v[96:111]
    ds_read_b128 a[24:27], v22 offset:57344
    v_cvt_pk_bf16_f32 v189, v202, v203
    v_cvt_pk_bf16_f32 v190, v204, v205
    v_cvt_pk_bf16_f32 v191, v206, v207
    s_cbranch_vccnz L_rare5
L_back5:
    v_add_f32 v41, v41, v44
    s_waitcnt lgkmcnt(3)
    v_mfma_f32_32x32x16_bf16 v[160:175], a[0:3], v[112:115], v[208:223]
    ds_read_b128 a[28:31], v23 offset:57344
    v_exp_f32 v192, v144
    v_exp_f32 v193, v145
    v_mfma_f32_32x32x16_bf16 v[160:175], a[4:7], v[116:119], v[160:175]
    ds_read_b64_tr_b16 a[0:1], v24 offset:8192
    ds_read_b64_tr_b16 a[2:3], v24 offset:10240
    v_exp_f32 v194, v146
    v_exp_f32 v195, v147
    v_mfma_f32_32x32x16_bf16 v[160:175], a[8:11], v[120:123], v[160:175]
    ds_read_b64_tr_b16 a[4:5], v25 offset:8192
    ds_read_b64_tr_b16 a[6:7], v25 offset:10240
    v_exp_f32 v196, v148
    v_mfma_f32_32x32x16_bf16 v[160:175], a[12:15], v[124:127], v[160:175]
    ds_read_b64_tr_b16 a[8:9], v26 offset:8192
    ds_read_b64_tr_b16 a[10:11], v26 offset:10240
    v_exp_f32 v197, v149
    v_exp_f32 v198, v150
    s_waitcnt lgkmcnt(6)
    v_mfma_f32_32x32x16_bf16 v[160:175], a[16:19], v[128:131], v[160:175]
    ds_read_b64_tr_b16 a[12:13], v27 offset:8192
    ds_read_b64_tr_b16 a[14:15], v27 offset:10240
    v_exp_f32 v199, v151
    v_add_f32 v44, v192, v193
    v_add_f32 v45, v194, v195
    v_mfma_f32_32x32x16_bf16 v[160:175], a[20:23], v[132:135], v[160:175]
    ds_read_b64_tr_b16 a[16:17], v24 offset:12288
    ds_read_b64_tr_b16 a[18:19], v24 offset:14336
    v_cvt_pk_bf16_f32 v176, v192, v193
    v_cvt_pk_bf16_f32 v177, v194, v195
    v_exp_f32 v200, v152
    v_mfma_f32_32x32x16_bf16 v[160:175], a[24:27], v[136:139], v[160:175]
    ds_read_b64_tr_b16 a[20:21], v25 offset:12288
    ds_read_b64_tr_b16 a[22:23], v25 offset:14336
    v_exp_f32 v201, v153
    v_mfma_f32_32x32x16_bf16 v[160:175], a[28:31], v[140:143], v[160:175]
    ds_read_b64_tr_b16 a[24:25], v26 offset:12288
    ds_read_b64_tr_b16 a[26:27], v26 offset:14336
    v_exp_f32 v202, v154
    v_exp_f32 v203, v155
    s_waitcnt lgkmcnt(6)
    v_mfma_f32_32x32x16_bf16 v[48:63], a[0:3], v[184:187], v[48:63]
    ds_read_b64_tr_b16 a[28:29], v27 offset:12288
    ds_read_b64_tr_b16 a[30:31], v27 offset:14336
    v_add_f32 v44, v44, v196
    v_add_f32 v45, v45, v197
    v_add_f32 v44, v44, v198
    v_add_f32 v45, v45, v199
    v_mfma_f32_32x32x16_bf16 v[64:79], a[4:7], v[184:187], v[64:79]
    s_barrier
    ds_read_b128 a[0:3], v16 offset:0
    v_cvt_pk_bf16_f32 v178, v196, v197
    v_cvt_pk_bf16_f32 v179, v198, v199
    v_exp_f32 v204, v156
    v_mfma_f32_32x32x16_bf16 v[80:95], a[8:11], v[184:187], v[80:95]
    ds_read_b128 a[4:7], v17 offset:0
    v_exp_f32 v205, v157
    v_mfma_f32_32x32x16_bf16 v[96:111], a[12:15], v[184:187], v[96:111]
    ds_read_b128 a[8:11], v18 offset:0
    v_exp_f32 v206, v158
    v_exp_f32 v207, v159
    s_waitcnt lgkmcnt(3)
    v_mfma_f32_32x32x16_bf16 v[48:63], a[16:19], v[188:191], v[48:63]
    ds_read_b128 a[12:15], v19 offset:0
    v_add_f32 v44, v44, v200
    v_add_f32 v45, v45, v201
    v_add_f32 v44, v44, v202
    v_add_f32 v45, v45, v203
    v_mfma_f32_32x32x16_bf16 v[64:79], a[20:23], v[188:191], v[64:79]
    ds_read_b128 a[16:19], v20 offset:0
    v_add_f32 v44, v44, v204
    v_add_f32 v45, v45, v205
    v_add_f32 v44, v44, v206
    v_mfma_f32_32x32x16_bf16 v[80:95], a[24:27], v[188:191], v[80:95]
    ds_read_b128 a[20:23], v21 offset:0
    v_add_f32 v45, v45, v207
    v_add_f32 v44, v44, v45
    v_cmp_nge_f32 vcc, s37, v44
    v_cvt_pk_bf16_f32 v180, v200, v201
    v_mfma_f32_32x32x16_bf16 v[96:111], a[28:31], v[188:191], v[96:111]
    ds_read_b128 a[24:27], v22 offset:0
    v_cvt_pk_bf16_f32 v181, v202, v203
    v_cvt_pk_bf16_f32 v182, v204, v205
    v_cvt_pk_bf16_f32 v183, v206, v207
    s_cbranch_vccnz L_rare6
L_back6:
    v_add_f32 v41, v41, v44
    s_waitcnt lgkmcnt(3)
    v_mfma_f32_32x32x16_bf16 v[144:159], a[0:3], v[112:115], v[208:223]
    ds_read_b128 a[28:31], v23 offset:0
    v_exp_f32 v192, v160
    v_exp_f32 v193, v161
    v_mfma_f32_32x32x16_bf16 v[144:159], a[4:7], v[116:119], v[144:159]
    ds_read_b64_tr_b16 a[0:1], v24 offset:16384
    ds_read_b64_tr_b16 a[2:3], v24 offset:18432
    v_exp_f32 v194, v162
    v_exp_f32 v195, v163
    v_mfma_f32_32x32x16_bf16 v[144:159], a[8:11], v[120:123], v[144:159]
    ds_read_b64_tr_b16 a[4:5], v25 offset:16384
    ds_read_b64_tr_b16 a[6:7], v25 offset:18432
    v_exp_f32 v196, v164
    v_mfma_f32_32x32x16_bf16 v[144:159], a[12:15], v[124:127], v[144:159]
    ds_read_b64_tr_b16 a[8:9], v26 offset:16384
    ds_read_b64_tr_b16 a[10:11], v26 offset:18432
    v_exp_f32 v197, v165
    v_exp_f32 v198, v166
    s_waitcnt lgkmcnt(6)
    v_mfma_f32_32x32x16_bf16 v[144:159], a[16:19], v[128:131], v[144:159]
    ds_read_b64_tr_b16 a[12:13], v27 offset:16384
    ds_read_b64_tr_b16 a[14:15], v27 offset:18432
    v_exp_f32 v199, v167
    v_add_f32 v44, v192, v193
    v_add_f32 v45, v194, v195
    v_mfma_f32_32x32x16_bf16 v[144:159], a[20:23], v[132:135], v[144:159]
    ds_read_b64_tr_b16 a[16:17], v24 offset:20480
    ds_read_b64_tr_b16 a[18:19], v24 offset:22528
    v_cvt_pk_bf16_f32 v184, v192, v193
    v_cvt_pk_bf16_f32 v185, v194, v195
    v_exp_f32 v200, v168
    v_mfma_f32_32x32x16_bf16 v[144:159], a[24:27], v[136:139], v[144:159]
    ds_read_b64_tr_b16 a[20:21], v25 offset:20480
    ds_read_b64_tr_b16 a[22:23], v25 offset:22528
    v_exp_f32 v201, v169
    v_mfma_f32_32x32x16_bf16 v[144:159], a[28:31], v[140:143], v[144:159]
    ds_read_b64_tr_b16 a[24:25], v26 offset:20480
    ds_read_b64_tr_b16 a[26:27], v26 offset:22528
    v_exp_f32 v202, v170
    v_exp_f32 v203, v171
    s_waitcnt lgkmcnt(6)
    v_mfma_f32_32x32x16_bf16 v[48:63], a[0:3], v[176:179], v[48:63]
    ds_read_b64_tr_b16 a[28:29], v27 offset:20480
    ds_read_b64_tr_b16 a[30:31], v27 offset:22528
    v_add_f32 v44, v44, v196
    v_add_f32 v45, v45, v197
    v_add_f32 v44, v44, v198
    v_add_f32 v45, v45, v199
    v_mfma_f32_32x32x16_bf16 v[64:79], a[4:7], v[176:179], v[64:79]
    ds_read_b128 a[0:3], v16 offset:8192
    v_cvt_pk_bf16_f32 v186, v196, v197
    v_cvt_pk_bf16_f32 v187, v198, v199
    v_exp_f32 v204, v172
    v_mfma_f32_32x32x16_bf16 v[80:95], a[8:11], v[176:179], v[80:95]
    ds_read_b128 a[4:7], v17 offset:8192
    v_exp_f32 v205, v173
    v_mfma_f32_32x32x16_bf16 v[96:111], a[12:15], v[176:179], v[96:111]
    ds_read_b128 a[8:11], v18 offset:8192
    v_exp_f32 v206, v174
    v_exp_f32 v207, v175
    s_waitcnt lgkmcnt(3)
    v_mfma_f32_32x32x16_bf16 v[48:63], a[16:19], v[180:183], v[48:63]
    ds_read_b128 a[12:15], v19 offset:8192
    v_add_f32 v44, v44, v200
    v_add_f32 v45, v45, v201
    v_add_f32 v44, v44, v202
    v_add_f32 v45, v45, v203
    v_mfma_f32_32x32x16_bf16 v[64:79], a[20:23], v[180:183], v[64:79]
    ds_read_b128 a[16:19], v20 offset:8192
    v_add_f32 v44, v44, v204
    v_add_f32 v45, v45, v205
    v_add_f32 v44, v44, v206
    v_mfma_f32_32x32x16_bf16 v[80:95], a[24:27], v[180:183], v[80:95]
    ds_read_b128 a[20:23], v21 offset:8192
    v_add_f32 v45, v45, v207
    v_add_f32 v44, v44, v45
    v_cmp_nge_f32 vcc, s37, v44
    v_cvt_pk_bf16_f32 v188, v200, v201
    v_mfma_f32_32x32x16_bf16 v[96:111], a[28:31], v[180:183], v[96:111]
    ds_read_b128 a[24:27], v22 offset:8192
    v_cvt_pk_bf16_f32 v189, v202, v203
    v_cvt_pk_bf16_f32 v190, v204, v205
    v_cvt_pk_bf16_f32 v191, v206, v207
    s_cbranch_vccnz L_rare7
L_back7:
    v_add_f32 v41, v41, v44
    s_waitcnt lgkmcnt(3)
    v_mfma_f32_32x32x16_bf16 v[160:175], a[0:3], v[112:115], v[208:223]
    ds_read_b128 a[28:31], v23 offset:8192
    v_exp_f32 v192, v144
    v_exp_f32 v193, v145
    v_mfma_f32_32x32x16_bf16 v[160:175], a[4:7], v[116:119], v[160:175]
    ds_read_b64_tr_b16 a[0:1], v24 offset:24576
    ds_read_b64_tr_b16 a[2:3], v24 offset:26624
    v_exp_f32 v194, v146
    v_exp_f32 v195, v147
    v_mfma_f32_32x32x16_bf16 v[160:175], a[8:11], v[120:123], v[160:175]
    ds_read_b64_tr_b16 a[4:5], v25 offset:24576
    ds_read_b64_tr_b16 a[6:7], v25 offset:26624
    v_exp_f32 v196, v148
    v_mfma_f32_32x32x16_bf16 v[160:175], a[12:15], v[124:127], v[160:175]
    ds_read_b64_tr_b16 a[8:9], v26 offset:24576
    ds_read_b64_tr_b16 a[10:11], v26 offset:26624
    v_exp_f32 v197, v149
    v_exp_f32 v198, v150
    s_waitcnt lgkmcnt(6)
    v_mfma_f32_32x32x16_bf16 v[160:175], a[16:19], v[128:131], v[160:175]
    ds_read_b64_tr_b16 a[12:13], v27 offset:24576
    ds_read_b64_tr_b16 a[14:15], v27 offset:26624
    v_exp_f32 v199, v151
    v_add_f32 v44, v192, v193
    v_add_f32 v45, v194, v195
    v_mfma_f32_32x32x16_bf16 v[160:175], a[20:23], v[132:135], v[160:175]
    ds_read_b64_tr_b16 a[16:17], v24 offset:28672
    ds_read_b64_tr_b16 a[18:19], v24 offset:30720
    v_cvt_pk_bf16_f32 v176, v192, v193
    v_cvt_pk_bf16_f32 v177, v194, v195
    v_exp_f32 v200, v152
    v_mfma_f32_32x32x16_bf16 v[160:175], a[24:27], v[136:139], v[160:175]
    ds_read_b64_tr_b16 a[20:21], v25 offset:28672
    ds_read_b64_tr_b16 a[22:23], v25 offset:30720
    v_exp_f32 v201, v153
    v_mfma_f32_32x32x16_bf16 v[160:175], a[28:31], v[140:143], v[160:175]
    ds_read_b64_tr_b16 a[24:25], v26 offset:28672
    ds_read_b64_tr_b16 a[26:27], v26 offset:30720
    v_exp_f32 v202, v154
    v_exp_f32 v203, v155
    s_waitcnt lgkmcnt(6)
    v_mfma_f32_32x32x16_bf16 v[48:63], a[0:3], v[184:187], v[48:63]
    ds_read_b64_tr_b16 a[28:29], v27 offset:28672
    ds_read_b64_tr_b16 a[30:31], v27 offset:30720
    v_add_f32 v44, v44, v196
    v_add_f32 v45, v45, v197
    v_add_f32 v44, v44, v198
    v_add_f32 v45, v45, v199
    v_mfma_f32_32x32x16_bf16 v[64:79], a[4:7], v[184:187], v[64:79]
    s_barrier
    ds_read_b128 a[0:3], v16 offset:16384
    v_cvt_pk_bf16_f32 v178, v196, v197
    v_cvt_pk_bf16_f32 v179, v198, v199
    v_exp_f32 v204, v156
    v_mfma_f32_32x32x16_bf16 v[80:95], a[8:11], v[184:187], v[80:95]
    ds_read_b128 a[4:7], v17 offset:16384
    v_exp_f32 v205, v157
    v_mfma_f32_32x32x16_bf16 v[96:111], a[12:15], v[184:187], v[96:111]
    ds_read_b128 a[8:11], v18 offset:16384
    v_exp_f32 v206, v158
    v_exp_f32 v207, v159
    s_waitcnt lgkmcnt(3)
    v_mfma_f32_32x32x16_bf16 v[48:63], a[16:19], v[188:191], v[48:63]
    ds_read_b128 a[12:15], v19 offset:16384
    v_add_f32 v44, v44, v200
    v_add_f32 v45, v45, v201
    v_add_f32 v44, v44, v202
    v_add_f32 v45, v45, v203
    v_mfma_f32_32x32x16_bf16 v[64:79], a[20:23], v[188:191], v[64:79]
    ds_read_b128 a[16:19], v20 offset:16384
    v_add_f32 v44, v44, v204
    v_add_f32 v45, v45, v205
    v_add_f32 v44, v44, v206
    v_mfma_f32_32x32x16_bf16 v[80:95], a[24:27], v[188:191], v[80:95]
    ds_read_b128 a[20:23], v21 offset:16384
    v_add_f32 v45, v45, v207
    v_add_f32 v44, v44, v45
    v_cmp_nge_f32 vcc, s37, v44
    v_cvt_pk_bf16_f32 v180, v200, v201
    v_mfma_f32_32x32x16_bf16 v[96:111], a[28:31], v[188:191], v[96:111]
    ds_read_b128 a[24:27], v22 offset:16384
    v_cvt_pk_bf16_f32 v181, v202, v203
    v_cvt_pk_bf16_f32 v182, v204, v205
    v_cvt_pk_bf16_f32 v183, v206, v207
    s_cbranch_vccnz L_rare8
L_back8:
    v_add_f32 v41, v41, v44
    s_waitcnt lgkmcnt(3)
    v_mfma_f32_32x32x16_bf16 v[144:159], a[0:3], v[112:115], v[208:223]
    ds_read_b128 a[28:31], v23 offset:16384
    v_exp_f32 v192, v160
    v_exp_f32 v193, v161
    v_mfma_f32_32x32x16_bf16 v[144:159], a[4:7], v[116:119], v[144:159]
    ds_read_b64_tr_b16 a[0:1], v24 offset:32768
    ds_read_b64_tr_b16 a[2:3], v24 offset:34816
    v_exp_f32 v194, v162
    v_exp_f32 v195, v163
    v_mfma_f32_32x32x16_bf16 v[144:159], a[8:11], v[120:123], v[144:159]
    ds_read_b64_tr_b16 a[4:5], v25 offset:32768
    ds_read_b64_tr_b16 a[6:7], v25 offset:34816
    v_exp_f32 v196, v164
    v_mfma_f32_32x32x16_bf16 v[144:159], a[12:15], v[124:127], v[144:159]
    ds_read_b64_tr_b16 a[8:9], v26 offset:32768
    ds_read_b64_tr_b16 a[10:11], v26 offset:34816
    v_exp_f32 v197, v165
    v_exp_f32 v198, v166
    s_waitcnt lgkmcnt(6)
    v_mfma_f32_32x32x16_bf16 v[144:159], a[16:19], v[128:131], v[144:159]
    ds_read_b64_tr_b16 a[12:13], v27 offset:32768
    ds_read_b64_tr_b16 a[14:15], v27 offset:34816
    v_exp_f32 v199, v167
    v_add_f32 v44, v192, v193
    v_add_f32 v45, v194, v195
    v_mfma_f32_32x32x16_bf16 v[144:159], a[20:23], v[132:135], v[144:159]
    ds_read_b64_tr_b16 a[16:17], v24 offset:36864
    ds_read_b64_tr_b16 a[18:19], v24 offset:38912
    v_cvt_pk_bf16_f32 v184, v192, v193
    v_cvt_pk_bf16_f32 v185, v194, v195
    v_exp_f32 v200, v168
    v_mfma_f32_32x32x16_bf16 v[144:159], a[24:27], v[136:139], v[144:159]
    ds_read_b64_tr_b16 a[20:21], v25 offset:36864
    ds_read_b64_tr_b16 a[22:23], v25 offset:38912
    v_exp_f32 v201, v169
    v_mfma_f32_32x32x16_bf16 v[144:159], a[28:31], v[140:143], v[144:159]
    ds_read_b64_tr_b16 a[24:25], v26 offset:36864
    ds_read_b64_tr_b16 a[26:27], v26 offset:38912
    v_exp_f32 v202, v170
    v_exp_f32 v203, v171
    s_waitcnt lgkmcnt(6)
    v_mfma_f32_32x32x16_bf16 v[48:63], a[0:3], v[176:179], v[48:63]
    ds_read_b64_tr_b16 a[28:29], v27 offset:36864
    ds_read_b64_tr_b16 a[30:31], v27 offset:38912
    v_add_f32 v44, v44, v196
    v_add_f32 v45, v45, v197
    v_add_f32 v44, v44, v198
    v_add_f32 v45, v45, v199
    v_mfma_f32_32x32x16_bf16 v[64:79], a[4:7], v[176:179], v[64:79]
    ds_read_b128 a[0:3], v16 offset:24576
    v_cvt_pk_bf16_f32 v186, v196, v197
    v_cvt_pk_bf16_f32 v187, v198, v199
    v_exp_f32 v204, v172
    v_mfma_f32_32x32x16_bf16 v[80:95], a[8:11], v[176:179], v[80:95]
    ds_read_b128 a[4:7], v17 offset:24576
    v_exp_f32 v205, v173
    v_mfma_f32_32x32x16_bf16 v[96:111], a[12:15], v[176:179], v[96:111]
    ds_read_b128 a[8:11], v18 offset:24576
    v_exp_f32 v206, v174
    v_exp_f32 v207, v175
    s_waitcnt lgkmcnt(3)
    v_mfma_f32_32x32x16_bf16 v[48:63], a[16:19], v[180:183], v[48:63]
    ds_read_b128 a[12:15], v19 offset:24576
    v_add_f32 v44, v44, v200
    v_add_f32 v45, v45, v201
    v_add_f32 v44, v44, v202
    v_add_f32 v45, v45, v203
    v_mfma_f32_32x32x16_bf16 v[64:79], a[20:23], v[180:183], v[64:79]
    ds_read_b128 a[16:19], v20 offset:24576
    v_add_f32 v44, v44, v204
    v_add_f32 v45, v45, v205
    v_add_f32 v44, v44, v206
    v_mfma_f32_32x32x16_bf16 v[80:95], a[24:27], v[180:183], v[80:95]
    ds_read_b128 a[20:23], v21 offset:24576
    v_add_f32 v45, v45, v207
    v_add_f32 v44, v44, v45
    v_cmp_nge_f32 vcc, s37, v44
    v_cvt_pk_bf16_f32 v188, v200, v201
    v_mfma_f32_32x32x16_bf16 v[96:111], a[28:31], v[180:183], v[96:111]
    ds_read_b128 a[24:27], v22 offset:24576
    v_cvt_pk_bf16_f32 v189, v202, v203
    v_cvt_pk_bf16_f32 v190, v204, v205
    v_cvt_pk_bf16_f32 v191, v206, v207
    s_cbranch_vccnz L_rare9
L_back9:
    v_add_f32 v41, v41, v44
    s_waitcnt lgkmcnt(3)
    v_mfma_f32_32x32x16_bf16 v[160:175], a[0:3], v[112:115], v[208:223]
    ds_read_b128 a[28:31], v23 offset:24576
    v_exp_f32 v192, v144
    v_exp_f32 v193, v145
    v_mfma_f32_32x32x16_bf16 v[160:175], a[4:7], v[116:119], v[160:175]
    ds_read_b64_tr_b16 a[0:1], v24 offset:40960
    ds_read_b64_tr_b16 a[2:3], v24 offset:43008
    v_exp_f32 v194, v146
    v_exp_f32 v195, v147
    v_mfma_f32_32x32x16_bf16 v[160:175], a[8:11], v[120:123], v[160:175]
    ds_read_b64_tr_b16 a[4:5], v25 offset:40960
    ds_read_b64_tr_b16 a[6:7], v25 offset:43008
    v_exp_f32 v196, v148
    v_mfma_f32_32x32x16_bf16 v[160:175], a[12:15], v[124:127], v[160:175]
    ds_read_b64_tr_b16 a[8:9], v26 offset:40960
    ds_read_b64_tr_b16 a[10:11], v26 offset:43008
    v_exp_f32 v197, v149
    v_exp_f32 v198, v150
    s_waitcnt lgkmcnt(6)
    v_mfma_f32_32x32x16_bf16 v[160:175], a[16:19], v[128:131], v[160:175]
    ds_read_b64_tr_b16 a[12:13], v27 offset:40960
    ds_read_b64_tr_b16 a[14:15], v27 offset:43008
    v_exp_f32 v199, v151
    v_add_f32 v44, v192, v193
    v_add_f32 v45, v194, v195
    v_mfma_f32_32x32x16_bf16 v[160:175], a[20:23], v[132:135], v[160:175]
    ds_read_b64_tr_b16 a[16:17], v24 offset:45056
    ds_read_b64_tr_b16 a[18:19], v24 offset:47104
    v_cvt_pk_bf16_f32 v176, v192, v193
    v_cvt_pk_bf16_f32 v177, v194, v195
    v_exp_f32 v200, v152
    v_mfma_f32_32x32x16_bf16 v[160:175], a[24:27], v[136:139], v[160:175]
    ds_read_b64_tr_b16 a[20:21], v25 offset:45056
    ds_read_b64_tr_b16 a[22:23], v25 offset:47104
    v_exp_f32 v201, v153
    v_mfma_f32_32x32x16_bf16 v[160:175], a[28:31], v[140:143], v[160:175]
    ds_read_b64_tr_b16 a[24:25], v26 offset:45056
    ds_read_b64_tr_b16 a[26:27], v26 offset:47104
    v_exp_f32 v202, v154
    v_exp_f32 v203, v155
    s_waitcnt lgkmcnt(6)
    v_mfma_f32_32x32x16_bf16 v[48:63], a[0:3], v[184:187], v[48:63]
    ds_read_b64_tr_b16 a[28:29], v27 offset:45056
    ds_read_b64_tr_b16 a[30:31], v27 offset:47104
    v_add_f32 v44, v44, v196
    v_add_f32 v45, v45, v197
    v_add_f32 v44, v44, v198
    v_add_f32 v45, v45, v199
    v_mfma_f32_32x32x16_bf16 v[64:79], a[4:7], v[184:187], v[64:79]
    s_barrier
    ds_read_b128 a[0:3], v16 offset:32768
    v_cvt_pk_bf16_f32 v178, v196, v197
    v_cvt_pk_bf16_f32 v179, v198, v199
    v_exp_f32 v204, v156
    v_mfma_f32_32x32x16_bf16 v[80:95], a[8:11], v[184:187], v[80:95]
    ds_read_b128 a[4:7], v17 offset:32768
    v_exp_f32 v205, v157
    v_mfma_f32_32x32x16_bf16 v[96:111], a[12:15], v[184:187], v[96:111]
    ds_read_b128 a[8:11], v18 offset:32768
    v_exp_f32 v206, v158
    v_exp_f32 v207, v159
    s_waitcnt lgkmcnt(3)
    v_mfma_f32_32x32x16_bf16 v[48:63], a[16:19], v[188:191], v[48:63]
    ds_read_b128 a[12:15], v19 offset:32768
    v_add_f32 v44, v44, v200
    v_add_f32 v45, v45, v201
    v_add_f32 v44, v44, v202
    v_add_f32 v45, v45, v203
    v_mfma_f32_32x32x16_bf16 v[64:79], a[20:23], v[188:191], v[64:79]
    ds_read_b128 a[16:19], v20 offset:32768
    v_add_f32 v44, v44, v204
    v_add_f32 v45, v45, v205
    v_add_f32 v44, v44, v206
    v_mfma_f32_32x32x16_bf16 v[80:95], a[24:27], v[188:191], v[80:95]
    ds_read_b128 a[20:23], v21 offset:32768
    v_add_f32 v45, v45, v207
    v_add_f32 v44, v44, v45
    v_cmp_nge_f32 vcc, s37, v44
    v_cvt_pk_bf16_f32 v180, v200, v201
    v_mfma_f32_32x32x16_bf16 v[96:111], a[28:31], v[188:191], v[96:111]
    ds_read_b128 a[24:27], v22 offset:32768
    v_cvt_pk_bf16_f32 v181, v202, v203
    v_cvt_pk_bf16_f32 v182, v204, v205
    v_cvt_pk_bf16_f32 v183, v206, v207
    s_cbranch_vccnz L_rare10
L_back10:
    v_add_f32 v41, v41, v44
    s_and_b32 s29, s39, 0xfffffffc
    v_and_b32 v4, 3, v1
    v_add_u32 v4, s29, v4
    v_lshlrev_b32 v4, 7, v4
    v_add_u32 v4, 65536, v4
    buffer_load_dwordx2 v[2:3], v4, s[20:23], 0 offen sc1
    s_waitcnt lgkmcnt(3)
    v_mfma_f32_32x32x16_bf16 v[144:159], a[0:3], v[112:115], v[208:223]
    ds_read_b128 a[28:31], v23 offset:32768
    v_exp_f32 v192, v160
    v_exp_f32 v193, v161
    v_mfma_f32_32x32x16_bf16 v[144:159], a[4:7], v[116:119], v[144:159]
    ds_read_b64_tr_b16 a[0:1], v24 offset:49152
    ds_read_b64_tr_b16 a[2:3], v24 offset:51200
    v_exp_f32 v194, v162
    v_exp_f32 v195, v163
    v_mfma_f32_32x32x16_bf16 v[144:159], a[8:11], v[120:123], v[144:159]
    ds_read_b64_tr_b16 a[4:5], v25 offset:49152
    ds_read_b64_tr_b16 a[6:7], v25 offset:51200
    v_exp_f32 v196, v164
    v_mfma_f32_32x32x16_bf16 v[144:159], a[12:15], v[124:127], v[144:159]
    ds_read_b64_tr_b16 a[8:9], v26 offset:49152
    ds_read_b64_tr_b16 a[10:11], v26 offset:51200
    v_exp_f32 v197, v165
    v_exp_f32 v198, v166
    s_waitcnt lgkmcnt(6)
    v_mfma_f32_32x32x16_bf16 v[144:159], a[16:19], v[128:131], v[144:159]
    ds_read_b64_tr_b16 a[12:13], v27 offset:49152
    ds_read_b64_tr_b16 a[14:15], v27 offset:51200
    v_exp_f32 v199, v167
    v_add_f32 v44, v192, v193
    v_add_f32 v45, v194, v195
    v_mfma_f32_32x32x16_bf16 v[144:159], a[20:23], v[132:135], v[144:159]
    ds_read_b64_tr_b16 a[16:17], v24 offset:53248
    ds_read_b64_tr_b16 a[18:19], v24 offset:55296
    v_cvt_pk_bf16_f32 v184, v192, v193
    v_cvt_pk_bf16_f32 v185, v194, v195
    v_exp_f32 v200, v168
    v_mfma_f32_32x32x16_bf16 v[144:159], a[24:27], v[136:139], v[144:159]
    ds_read_b64_tr_b16 a[20:21], v25 offset:53248
    ds_read_b64_tr_b16 a[22:23], v25 offset:55296
    v_exp_f32 v201, v169
    v_mfma_f32_32x32x16_bf16 v[144:159], a[28:31], v[140:143], v[144:159]
    ds_read_b64_tr_b16 a[24:25], v26 offset:53248
    ds_read_b64_tr_b16 a[26:27], v26 offset:55296
    v_exp_f32 v202, v170
    v_exp_f32 v203, v171
    s_waitcnt lgkmcnt(6)
    v_mfma_f32_32x32x16_bf16 v[48:63], a[0:3], v[176:179], v[48:63]
    ds_read_b64_tr_b16 a[28:29], v27 offset:53248
    ds_read_b64_tr_b16 a[30:31], v27 offset:55296
    v_add_f32 v44, v44, v196
    v_add_f32 v45, v45, v197
    v_add_f32 v44, v44, v198
    v_add_f32 v45, v45, v199
    v_mfma_f32_32x32x16_bf16 v[64:79], a[4:7], v[176:179], v[64:79]
    ds_read_b128 a[0:3], v16 offset:40960
    v_cvt_pk_bf16_f32 v186, v196, v197
    v_cvt_pk_bf16_f32 v187, v198, v199
    v_exp_f32 v204, v172
    v_mfma_f32_32x32x16_bf16 v[80:95], a[8:11], v[176:179], v[80:95]
    ds_read_b128 a[4:7], v17 offset:40960
    v_exp_f32 v205, v173
    v_mfma_f32_32x32x16_bf16 v[96:111], a[12:15], v[176:179], v[96:111]
    ds_read_b128 a[8:11], v18 offset:40960
    v_exp_f32 v206, v174
    v_exp_f32 v207, v175
    s_waitcnt lgkmcnt(3)
    v_mfma_f32_32x32x16_bf16 v[48:63], a[16:19], v[180:183], v[48:63]
    ds_read_b128 a[12:15], v19 offset:40960
    v_add_f32 v44, v44, v200
    v_add_f32 v45, v45, v201
    v_add_f32 v44, v44, v202
    v_add_f32 v45, v45, v203
    v_mfma_f32_32x32x16_bf16 v[64:79], a[20:23], v[180:183], v[64:79]
    ds_read_b128 a[16:19], v20 offset:40960
    v_add_f32 v44, v44, v204
    v_add_f32 v45, v45, v205
    v_add_f32 v44, v44, v206
    v_mfma_f32_32x32x16_bf16 v[80:95], a[24:27], v[180:183], v[80:95]
    ds_read_b128 a[20:23], v21 offset:40960
    v_add_f32 v45, v45, v207
    v_add_f32 v44, v44, v45
    v_cmp_nge_f32 vcc, s37, v44
    v_cvt_pk_bf16_f32 v188, v200, v201
    v_mfma_f32_32x32x16_bf16 v[96:111], a[28:31], v[180:183], v[96:111]
    ds_read_b128 a[24:27], v22 offset:40960
    v_cvt_pk_bf16_f32 v189, v202, v203
    v_cvt_pk_bf16_f32 v190, v204, v205
    v_cvt_pk_bf16_f32 v191, v206, v207
    s_cbranch_vccnz L_rare11
L_back11:
    v_add_f32 v41, v41, v44
    s_waitcnt lgkmcnt(3)
    v_mfma_f32_32x32x16_bf16 v[160:175], a[0:3], v[112:115], v[208:223]
    ds_read_b128 a[28:31], v23 offset:40960
    v_exp_f32 v192, v144
    v_exp_f32 v193, v145
    v_mfma_f32_32x32x16_bf16 v[160:175], a[4:7], v[116:119], v[160:175]
    ds_read_b64_tr_b16 a[0:1], v24 offset:57344
    ds_read_b64_tr_b16 a[2:3], v24 offset:59392
    v_exp_f32 v194, v146
    v_exp_f32 v195, v147
    v_mfma_f32_32x32x16_bf16 v[160:175], a[8:11], v[120:123], v[160:175]
    ds_read_b64_tr_b16 a[4:5], v25 offset:57344
    ds_read_b64_tr_b16 a[6:7], v25 offset:59392
    v_exp_f32 v196, v148
    v_mfma_f32_32x32x16_bf16 v[160:175], a[12:15], v[124:127], v[160:175]
    ds_read_b64_tr_b16 a[8:9], v26 offset:57344
    ds_read_b64_tr_b16 a[10:11], v26 offset:59392
    v_exp_f32 v197, v149
    v_exp_f32 v198, v150
    s_waitcnt lgkmcnt(6)
    v_mfma_f32_32x32x16_bf16 v[160:175], a[16:19], v[128:131], v[160:175]
    ds_read_b64_tr_b16 a[12:13], v27 offset:57344
    ds_read_b64_tr_b16 a[14:15], v27 offset:59392
    v_exp_f32 v199, v151
    v_add_f32 v44, v192, v193
    v_add_f32 v45, v194, v195
    v_mfma_f32_32x32x16_bf16 v[160:175], a[20:23], v[132:135], v[160:175]
    ds_read_b64_tr_b16 a[16:17], v24 offset:61440
    ds_read_b64_tr_b16 a[18:19], v24 offset:63488
    v_cvt_pk_bf16_f32 v176, v192, v193
    v_cvt_pk_bf16_f32 v177, v194, v195
    v_exp_f32 v200, v152
    v_mfma_f32_32x32x16_bf16 v[160:175], a[24:27], v[136:139], v[160:175]
    ds_read_b64_tr_b16 a[20:21], v25 offset:61440
    ds_read_b64_tr_b16 a[22:23], v25 offset:63488
    v_exp_f32 v201, v153
    v_mfma_f32_32x32x16_bf16 v[160:175], a[28:31], v[140:143], v[160:175]
    ds_read_b64_tr_b16 a[24:25], v26 offset:61440
    ds_read_b64_tr_b16 a[26:27], v26 offset:63488
    v_exp_f32 v202, v154
    v_exp_f32 v203, v155
    s_waitcnt lgkmcnt(6)
    v_mfma_f32_32x32x16_bf16 v[48:63], a[0:3], v[184:187], v[48:63]
    ds_read_b64_tr_b16 a[28:29], v27 offset:61440
    ds_read_b64_tr_b16 a[30:31], v27 offset:63488
    v_add_f32 v44, v44, v196
    v_add_f32 v45, v45, v197
    v_add_f32 v44, v44, v198
    v_add_f32 v45, v45, v199
    v_mfma_f32_32x32x16_bf16 v[64:79], a[4:7], v[184:187], v[64:79]
    s_barrier
    ds_read_b128 a[0:3], v16 offset:49152
    v_cvt_pk_bf16_f32 v178, v196, v197
    v_cvt_pk_bf16_f32 v179, v198, v199
    v_exp_f32 v204, v156
    v_mfma_f32_32x32x16_bf16 v[80:95], a[8:11], v[184:187], v[80:95]
    ds_read_b128 a[4:7], v17 offset:49152
    v_exp_f32 v205, v157
    v_mfma_f32_32x32x16_bf16 v[96:111], a[12:15], v[184:187], v[96:111]
    ds_read_b128 a[8:11], v18 offset:49152
    v_exp_f32 v206, v158
    v_exp_f32 v207, v159
    s_waitcnt lgkmcnt(3)
    v_mfma_f32_32x32x16_bf16 v[48:63], a[16:19], v[188:191], v[48:63]
    ds_read_b128 a[12:15], v19 offset:49152
    v_add_f32 v44, v44, v200
    v_add_f32 v45, v45, v201
    v_add_f32 v44, v44, v202
    v_add_f32 v45, v45, v203
    v_mfma_f32_32x32x16_bf16 v[64:79], a[20:23], v[188:191], v[64:79]
    ds_read_b128 a[16:19], v20 offset:49152
    v_add_f32 v44, v44, v204
    v_add_f32 v45, v45, v205
    v_add_f32 v44, v44, v206
    v_mfma_f32_32x32x16_bf16 v[80:95], a[24:27], v[188:191], v[80:95]
    ds_read_b128 a[20:23], v21 offset:49152
    v_add_f32 v45, v45, v207
    v_add_f32 v44, v44, v45
    v_cmp_nge_f32 vcc, s37, v44
    v_cvt_pk_bf16_f32 v180, v200, v201
    v_mfma_f32_32x32x16_bf16 v[96:111], a[28:31], v[188:191], v[96:111]
    ds_read_b128 a[24:27], v22 offset:49152
    v_cvt_pk_bf16_f32 v181, v202, v203
    v_cvt_pk_bf16_f32 v182, v204, v205
    v_cvt_pk_bf16_f32 v183, v206, v207
    s_cbranch_vccnz L_rare12
L_back12:
    v_add_f32 v41, v41, v44
    s_waitcnt lgkmcnt(3)
    v_mfma_f32_32x32x16_bf16 v[144:159], a[0:3], v[112:115], v[208:223]
    ds_read_b128 a[28:31], v23 offset:49152
    v_exp_f32 v192, v160
    v_exp_f32 v193, v161
    v_mfma_f32_32x32x16_bf16 v[144:159], a[4:7], v[116:119], v[144:159]
    ds_read_b64_tr_b16 a[0:1], v28 offset:0
    ds_read_b64_tr_b16 a[2:3], v28 offset:2048
    v_exp_f32 v194, v162
    v_exp_f32 v195, v163
    v_mfma_f32_32x32x16_bf16 v[144:159], a[8:11], v[120:123], v[144:159]
    ds_read_b64_tr_b16 a[4:5], v29 offset:0
    ds_read_b64_tr_b16 a[6:7], v29 offset:2048
    v_exp_f32 v196, v164
    v_mfma_f32_32x32x16_bf16 v[144:159], a[12:15], v[124:127], v[144:159]
    ds_read_b64_tr_b16 a[8:9], v30 offset:0
    ds_read_b64_tr_b16 a[10:11], v30 offset:2048
    v_exp_f32 v197, v165
    v_exp_f32 v198, v166
    s_waitcnt lgkmcnt(6)
    v_mfma_f32_32x32x16_bf16 v[144:159], a[16:19], v[128:131], v[144:159]
    ds_read_b64_tr_b16 a[12:13], v31 offset:0
    ds_read_b64_tr_b16 a[14:15], v31 offset:2048
    v_exp_f32 v199, v167
    v_add_f32 v44, v192, v193
    v_add_f32 v45, v194, v195
    v_mfma_f32_32x32x16_bf16 v[144:159], a[20:23], v[132:135], v[144:159]
    ds_read_b64_tr_b16 a[16:17], v28 offset:4096
    ds_read_b64_tr_b16 a[18:19], v28 offset:6144
    v_cvt_pk_bf16_f32 v184, v192, v193
    v_cvt_pk_bf16_f32 v185, v194, v195
    v_exp_f32 v200, v168
    v_mfma_f32_32x32x16_bf16 v[144:159], a[24:27], v[136:139], v[144:159]
    ds_read_b64_tr_b16 a[20:21], v29 offset:4096
    ds_read_b64_tr_b16 a[22:23], v29 offset:6144
    v_exp_f32 v201, v169
    v_mfma_f32_32x32x16_bf16 v[144:159], a[28:31], v[140:143], v[144:159]
    ds_read_b64_tr_b16 a[24:25], v30 offset:4096
    ds_read_b64_tr_b16 a[26:27], v30 offset:6144
    v_exp_f32 v202, v170
    v_exp_f32 v203, v171
    s_waitcnt lgkmcnt(6)
    v_mfma_f32_32x32x16_bf16 v[48:63], a[0:3], v[176:179], v[48:63]
    ds_read_b64_tr_b16 a[28:29], v31 offset:4096
    ds_read_b64_tr_b16 a[30:31], v31 offset:6144
    v_add_f32 v44, v44, v196
    v_add_f32 v45, v45, v197
    v_add_f32 v44, v44, v198
    v_add_f32 v45, v45, v199
    v_mfma_f32_32x32x16_bf16 v[64:79], a[4:7], v[176:179], v[64:79]
    ds_read_b128 a[0:3], v16 offset:57344
    v_cvt_pk_bf16_f32 v186, v196, v197
    v_cvt_pk_bf16_f32 v187, v198, v199
    v_exp_f32 v204, v172
    v_mfma_f32_32x32x16_bf16 v[80:95], a[8:11], v[176:179], v[80:95]
    ds_read_b128 a[4:7], v17 offset:57344
    v_exp_f32 v205, v173
    v_mfma_f32_32x32x16_bf16 v[96:111], a[12:15], v[176:179], v[96:111]
    ds_read_b128 a[8:11], v18 offset:57344
    v_exp_f32 v206, v174
    v_exp_f32 v207, v175
    s_waitcnt lgkmcnt(3)
    v_mfma_f32_32x32x16_bf16 v[48:63], a[16:19], v[180:183], v[48:63]
    ds_read_b128 a[12:15], v19 offset:57344
    v_add_f32 v44, v44, v200
    v_add_f32 v45, v45, v201
    v_add_f32 v44, v44, v202
    v_add_f32 v45, v45, v203
    v_mfma_f32_32x32x16_bf16 v[64:79], a[20:23], v[180:183], v[64:79]
    ds_read_b128 a[16:19], v20 offset:57344
    v_add_f32 v44, v44, v204
    v_add_f32 v45, v45, v205
    v_add_f32 v44, v44, v206
    v_mfma_f32_32x32x16_bf16 v[80:95], a[24:27], v[180:183], v[80:95]
    ds_read_b128 a[20:23], v21 offset:57344
    v_add_f32 v45, v45, v207
    v_add_f32 v44, v44, v45
    v_cmp_nge_f32 vcc, s37, v44
    v_cvt_pk_bf16_f32 v188, v200, v201
    v_mfma_f32_32x32x16_bf16 v[96:111], a[28:31], v[180:183], v[96:111]
    ds_read_b128 a[24:27], v22 offset:57344
    v_cvt_pk_bf16_f32 v189, v202, v203
    v_cvt_pk_bf16_f32 v190, v204, v205
    v_cvt_pk_bf16_f32 v191, v206, v207
    s_cbranch_vccnz L_rare13
L_back13:
    v_add_f32 v41, v41, v44
    s_waitcnt vmcnt(0)
    v_cmp_ne_u32 vcc, s58, v2
    s_nop 1
    s_nop 1
    s_cmp_eq_u64 vcc, 0
    s_cselect_b32 s7, 1, 0
    v_cmp_ne_u32 vcc, s59, v3
    s_nop 1
    s_nop 1
    s_cmp_eq_u64 vcc, 0
    s_cselect_b32 s7, s7, 0
    s_waitcnt lgkmcnt(3)
    v_mfma_f32_32x32x16_bf16 v[160:175], a[0:3], v[112:115], v[208:223]
    ds_read_b128 a[28:31], v23 offset:57344
    v_exp_f32 v192, v144
    v_exp_f32 v193, v145
    v_mfma_f32_32x32x16_bf16 v[160:175], a[4:7], v[116:119], v[160:175]
    ds_read_b64_tr_b16 a[0:1], v28 offset:8192
    ds_read_b64_tr_b16 a[2:3], v28 offset:10240
    v_exp_f32 v194, v146
    v_exp_f32 v195, v147
    v_mfma_f32_32x32x16_bf16 v[160:175], a[8:11], v[120:123], v[160:175]
    ds_read_b64_tr_b16 a[4:5], v29 offset:8192
    ds_read_b64_tr_b16 a[6:7], v29 offset:10240
    v_exp_f32 v196, v148
    v_mfma_f32_32x32x16_bf16 v[160:175], a[12:15], v[124:127], v[160:175]
    ds_read_b64_tr_b16 a[8:9], v30 offset:8192
    ds_read_b64_tr_b16 a[10:11], v30 offset:10240
    v_exp_f32 v197, v149
    v_exp_f32 v198, v150
    s_waitcnt lgkmcnt(6)
    v_mfma_f32_32x32x16_bf16 v[160:175], a[16:19], v[128:131], v[160:175]
    ds_read_b64_tr_b16 a[12:13], v31 offset:8192
    ds_read_b64_tr_b16 a[14:15], v31 offset:10240
    v_exp_f32 v199, v151
    v_add_f32 v44, v192, v193
    v_add_f32 v45, v194, v195
    v_mfma_f32_32x32x16_bf16 v[160:175], a[20:23], v[132:135], v[160:175]
    ds_read_b64_tr_b16 a[16:17], v28 offset:12288
    ds_read_b64_tr_b16 a[18:19], v28 offset:14336
    v_cvt_pk_bf16_f32 v176, v192, v193
    v_cvt_pk_bf16_f32 v177, v194, v195
    v_exp_f32 v200, v152
    v_mfma_f32_32x32x16_bf16 v[160:175], a[24:27], v[136:139], v[160:175]
    ds_read_b64_tr_b16 a[20:21], v29 offset:12288
    ds_read_b64_tr_b16 a[22:23], v29 offset:14336
    v_exp_f32 v201, v153
    v_mfma_f32_32x32x16_bf16 v[160:175], a[28:31], v[140:143], v[160:175]
    ds_read_b64_tr_b16 a[24:25], v30 offset:12288
    ds_read_b64_tr_b16 a[26:27], v30 offset:14336
    v_exp_f32 v202, v154
    v_exp_f32 v203, v155
    s_waitcnt lgkmcnt(6)
    v_mfma_f32_32x32x16_bf16 v[48:63], a[0:3], v[184:187], v[48:63]
    ds_read_b64_tr_b16 a[28:29], v31 offset:12288
    ds_read_b64_tr_b16 a[30:31], v31 offset:14336
    v_add_f32 v44, v44, v196
    v_add_f32 v45, v45, v197
    v_add_f32 v44, v44, v198
    v_add_f32 v45, v45, v199
    v_mfma_f32_32x32x16_bf16 v[64:79], a[4:7], v[184:187], v[64:79]
    s_barrier
    ds_read_b64_tr_b16 a[0:1], v28 offset:16384
    ds_read_b64_tr_b16 a[2:3], v28 offset:18432
    v_cvt_pk_bf16_f32 v178, v196, v197
    v_cvt_pk_bf16_f32 v179, v198, v199
    v_exp_f32 v204, v156
    v_mfma_f32_32x32x16_bf16 v[80:95], a[8:11], v[184:187], v[80:95]
    ds_read_b64_tr_b16 a[4:5], v29 offset:16384
    ds_read_b64_tr_b16 a[6:7], v29 offset:18432
    v_exp_f32 v205, v157
    v_mfma_f32_32x32x16_bf16 v[96:111], a[12:15], v[184:187], v[96:111]
    ds_read_b64_tr_b16 a[8:9], v30 offset:16384
    ds_read_b64_tr_b16 a[10:11], v30 offset:18432
    v_exp_f32 v206, v158
    v_exp_f32 v207, v159
    s_waitcnt lgkmcnt(6)
    v_mfma_f32_32x32x16_bf16 v[48:63], a[16:19], v[188:191], v[48:63]
    ds_read_b64_tr_b16 a[12:13], v31 offset:16384
    ds_read_b64_tr_b16 a[14:15], v31 offset:18432
    v_add_f32 v44, v44, v200
    v_add_f32 v45, v45, v201
    v_add_f32 v44, v44, v202
    v_add_f32 v45, v45, v203
    v_mfma_f32_32x32x16_bf16 v[64:79], a[20:23], v[188:191], v[64:79]
    ds_read_b64_tr_b16 a[16:17], v28 offset:20480
    ds_read_b64_tr_b16 a[18:19], v28 offset:22528
    v_add_f32 v44, v44, v204
    v_add_f32 v45, v45, v205
    v_add_f32 v44, v44, v206
    v_mfma_f32_32x32x16_bf16 v[80:95], a[24:27], v[188:191], v[80:95]
    ds_read_b64_tr_b16 a[20:21], v29 offset:20480
    ds_read_b64_tr_b16 a[22:23], v29 offset:22528
    v_add_f32 v45, v45, v207
    v_add_f32 v44, v44, v45
    v_cmp_nge_f32 vcc, s37, v44
    v_cvt_pk_bf16_f32 v180, v200, v201
    v_mfma_f32_32x32x16_bf16 v[96:111], a[28:31], v[188:191], v[96:111]
    ds_read_b64_tr_b16 a[24:25], v30 offset:20480
    ds_read_b64_tr_b16 a[26:27], v30 offset:22528
    v_cvt_pk_bf16_f32 v181, v202, v203
    v_cvt_pk_bf16_f32 v182, v204, v205
    v_cvt_pk_bf16_f32 v183, v206, v207
    s_cbranch_vccnz L_rare14
L_back14:
    v_add_f32 v41, v41, v44
    s_waitcnt lgkmcnt(6)
    v_mfma_f32_32x32x16_bf16 v[48:63], a[0:3], v[176:179], v[48:63]
    ds_read_b64_tr_b16 a[28:29], v31 offset:20480
    ds_read_b64_tr_b16 a[30:31], v31 offset:22528
    v_exp_f32 v192, v160
    v_exp_f32 v193, v161
    v_exp_f32 v194, v162
    v_exp_f32 v195, v163
    v_mfma_f32_32x32x16_bf16 v[64:79], a[4:7], v[176:179], v[64:79]
    ds_read_b64_tr_b16 a[0:1], v28 offset:24576
    ds_read_b64_tr_b16 a[2:3], v28 offset:26624
    v_exp_f32 v196, v164
    v_exp_f32 v197, v165
    v_exp_f32 v198, v166
    v_mfma_f32_32x32x16_bf16 v[80:95], a[8:11], v[176:179], v[80:95]
    ds_read_b64_tr_b16 a[4:5], v29 offset:24576
    ds_read_b64_tr_b16 a[6:7], v29 offset:26624
    v_exp_f32 v199, v167
    v_add_f32 v44, v192, v193
    v_add_f32 v45, v194, v195
    v_cvt_pk_bf16_f32 v184, v192, v193
    v_cvt_pk_bf16_f32 v185, v194, v195
    v_exp_f32 v200, v168
    v_mfma_f32_32x32x16_bf16 v[96:111], a[12:15], v[176:179], v[96:111]
    ds_read_b64_tr_b16 a[8:9], v30 offset:24576
    ds_read_b64_tr_b16 a[10:11], v30 offset:26624
    v_exp_f32 v201, v169
    v_exp_f32 v202, v170
    v_exp_f32 v203, v171
    s_waitcnt lgkmcnt(6)
    v_mfma_f32_32x32x16_bf16 v[48:63], a[16:19], v[180:183], v[48:63]
    ds_read_b64_tr_b16 a[12:13], v31 offset:24576
    ds_read_b64_tr_b16 a[14:15], v31 offset:26624
    v_add_f32 v44, v44, v196
    v_add_f32 v45, v45, v197
    v_add_f32 v44, v44, v198
    v_add_f32 v45, v45, v199
    v_cvt_pk_bf16_f32 v186, v196, v197
    v_cvt_pk_bf16_f32 v187, v198, v199
    v_exp_f32 v204, v172
    v_mfma_f32_32x32x16_bf16 v[64:79], a[20:23], v[180:183], v[64:79]
    ds_read_b64_tr_b16 a[16:17], v28 offset:28672
    ds_read_b64_tr_b16 a[18:19], v28 offset:30720
    v_exp_f32 v205, v173
    v_exp_f32 v206, v174
    v_exp_f32 v207, v175
    v_mfma_f32_32x32x16_bf16 v[80:95], a[24:27], v[180:183], v[80:95]
    ds_read_b64_tr_b16 a[20:21], v29 offset:28672
    ds_read_b64_tr_b16 a[22:23], v29 offset:30720
    v_add_f32 v44, v44, v200
    v_add_f32 v45, v45, v201
    v_add_f32 v44, v44, v202
    v_add_f32 v45, v45, v203
    v_add_f32 v44, v44, v204
    v_add_f32 v45, v45, v205
    v_add_f32 v44, v44, v206
    v_mfma_f32_32x32x16_bf16 v[96:111], a[28:31], v[180:183], v[96:111]
    ds_read_b64_tr_b16 a[24:25], v30 offset:28672
    ds_read_b64_tr_b16 a[26:27], v30 offset:30720
    v_add_f32 v45, v45, v207
    v_add_f32 v44, v44, v45
    v_cmp_nge_f32 vcc, s37, v44
    v_cvt_pk_bf16_f32 v188, v200, v201
    v_cvt_pk_bf16_f32 v189, v202, v203
    v_cvt_pk_bf16_f32 v190, v204, v205
    v_cvt_pk_bf16_f32 v191, v206, v207
    s_cbranch_vccnz L_rare15
L_back15:
    v_add_f32 v41, v41, v44
    s_waitcnt lgkmcnt(6)
    v_mfma_f32_32x32x16_bf16 v[48:63], a[0:3], v[184:187], v[48:63]
    ds_read_b64_tr_b16 a[28:29], v31 offset:28672
    ds_read_b64_tr_b16 a[30:31], v31 offset:30720
    v_mfma_f32_32x32x16_bf16 v[64:79], a[4:7], v[184:187], v[64:79]
    v_mfma_f32_32x32x16_bf16 v[80:95], a[8:11], v[184:187], v[80:95]
    v_mfma_f32_32x32x16_bf16 v[96:111], a[12:15], v[184:187], v[96:111]
    s_waitcnt lgkmcnt(0)
    v_mfma_f32_32x32x16_bf16 v[48:63], a[16:19], v[188:191], v[48:63]
    v_mfma_f32_32x32x16_bf16 v[64:79], a[20:23], v[188:191], v[64:79]
    v_mfma_f32_32x32x16_bf16 v[80:95], a[24:27], v[188:191], v[80:95]
    v_mfma_f32_32x32x16_bf16 v[96:111], a[28:31], v[188:191], v[96:111]
    v_mov_b32 v7, v41
    s_nop 1
    v_permlane32_swap_b32 v41, v7
    v_add_f32 v6, v41, v7
    v_rcp_f32 v6, v6
    s_nop 0
    v_mov_b32 v4, v6
    v_mov_b32 v5, v6
    v_lshlrev_b32 v12, 4, v1
    s_lshl_b32 s29, s5, 13
    v_add_u32 v12, s29, v12
    s_mov_b32 s30, 4096
    v_pk_mul_f32 v[48:49], v[48:49], v[4:5]
    v_pk_mul_f32 v[50:51], v[50:51], v[4:5]
    v_pk_mul_f32 v[52:53], v[52:53], v[4:5]
    v_pk_mul_f32 v[54:55], v[54:55], v[4:5]
    v_pk_mul_f32 v[56:57], v[56:57], v[4:5]
    v_pk_mul_f32 v[58:59], v[58:59], v[4:5]
    v_pk_mul_f32 v[60:61], v[60:61], v[4:5]
    v_pk_mul_f32 v[62:63], v[62:63], v[4:5]
    v_cvt_pk_bf16_f32 v16, v48, v49
    v_cvt_pk_bf16_f32 v17, v50, v51
    v_cvt_pk_bf16_f32 v18, v56, v57
    v_cvt_pk_bf16_f32 v19, v58, v59
    v_cvt_pk_bf16_f32 v20, v52, v53
    v_cvt_pk_bf16_f32 v21, v54, v55
    v_cvt_pk_bf16_f32 v22, v60, v61
    v_cvt_pk_bf16_f32 v23, v62, v63
    v_permlane32_swap_b32 v16, v20
    v_permlane32_swap_b32 v17, v21
    v_permlane32_swap_b32 v18, v22
    v_permlane32_swap_b32 v19, v23
    v_permlane16_swap_b32 v16, v20
    v_permlane16_swap_b32 v17, v21
    v_permlane16_swap_b32 v18, v22
    v_permlane16_swap_b32 v19, v23
    s_nop 1
    buffer_store_dwordx4 v[16:19], v12, s[24:27], 0 offen offset:0 sc1
    buffer_store_dwordx4 v[20:23], v12, s[24:27], s30 offen offset:0 sc1
    v_pk_mul_f32 v[64:65], v[64:65], v[4:5]
    v_pk_mul_f32 v[66:67], v[66:67], v[4:5]
    v_pk_mul_f32 v[68:69], v[68:69], v[4:5]
    v_pk_mul_f32 v[70:71], v[70:71], v[4:5]
    v_pk_mul_f32 v[72:73], v[72:73], v[4:5]
    v_pk_mul_f32 v[74:75], v[74:75], v[4:5]
    v_pk_mul_f32 v[76:77], v[76:77], v[4:5]
    v_pk_mul_f32 v[78:79], v[78:79], v[4:5]
    v_cvt_pk_bf16_f32 v24, v64, v65
    v_cvt_pk_bf16_f32 v25, v66, v67
    v_cvt_pk_bf16_f32 v26, v72, v73
    v_cvt_pk_bf16_f32 v27, v74, v75
    v_cvt_pk_bf16_f32 v28, v68, v69
    v_cvt_pk_bf16_f32 v29, v70, v71
    v_cvt_pk_bf16_f32 v30, v76, v77
    v_cvt_pk_bf16_f32 v31, v78, v79
    v_permlane32_swap_b32 v24, v28
    v_permlane32_swap_b32 v25, v29
    v_permlane32_swap_b32 v26, v30
    v_permlane32_swap_b32 v27, v31
    v_permlane16_swap_b32 v24, v28
    v_permlane16_swap_b32 v25, v29
    v_permlane16_swap_b32 v26, v30
    v_permlane16_swap_b32 v27, v31
    s_nop 1
    buffer_store_dwordx4 v[24:27], v12, s[24:27], 0 offen offset:1024 sc1
    buffer_store_dwordx4 v[28:31], v12, s[24:27], s30 offen offset:1024 sc1
    v_pk_mul_f32 v[80:81], v[80:81], v[4:5]
    v_pk_mul_f32 v[82:83], v[82:83], v[4:5]
    v_pk_mul_f32 v[84:85], v[84:85], v[4:5]
    v_pk_mul_f32 v[86:87], v[86:87], v[4:5]
    v_pk_mul_f32 v[88:89], v[88:89], v[4:5]
    v_pk_mul_f32 v[90:91], v[90:91], v[4:5]
    v_pk_mul_f32 v[92:93], v[92:93], v[4:5]
    v_pk_mul_f32 v[94:95], v[94:95], v[4:5]
    v_cvt_pk_bf16_f32 v32, v80, v81
    v_cvt_pk_bf16_f32 v33, v82, v83
    v_cvt_pk_bf16_f32 v34, v88, v89
    v_cvt_pk_bf16_f32 v35, v90, v91
    v_cvt_pk_bf16_f32 v36, v84, v85
    v_cvt_pk_bf16_f32 v37, v86, v87
    v_cvt_pk_bf16_f32 v38, v92, v93
    v_cvt_pk_bf16_f32 v39, v94, v95
    v_permlane32_swap_b32 v32, v36
    v_permlane32_swap_b32 v33, v37
    v_permlane32_swap_b32 v34, v38
    v_permlane32_swap_b32 v35, v39
    v_permlane16_swap_b32 v32, v36
    v_permlane16_swap_b32 v33, v37
    v_permlane16_swap_b32 v34, v38
    v_permlane16_swap_b32 v35, v39
    s_nop 1
    buffer_store_dwordx4 v[32:35], v12, s[24:27], 0 offen offset:2048 sc1
    buffer_store_dwordx4 v[36:39], v12, s[24:27], s30 offen offset:2048 sc1
    v_pk_mul_f32 v[96:97], v[96:97], v[4:5]
    v_pk_mul_f32 v[98:99], v[98:99], v[4:5]
    v_pk_mul_f32 v[100:101], v[100:101], v[4:5]
    v_pk_mul_f32 v[102:103], v[102:103], v[4:5]
    v_pk_mul_f32 v[104:105], v[104:105], v[4:5]
    v_pk_mul_f32 v[106:107], v[106:107], v[4:5]
    v_pk_mul_f32 v[108:109], v[108:109], v[4:5]
    v_pk_mul_f32 v[110:111], v[110:111], v[4:5]
    v_cvt_pk_bf16_f32 v40, v96, v97
    v_cvt_pk_bf16_f32 v41, v98, v99
    v_cvt_pk_bf16_f32 v42, v104, v105
    v_cvt_pk_bf16_f32 v43, v106, v107
    v_cvt_pk_bf16_f32 v44, v100, v101
    v_cvt_pk_bf16_f32 v45, v102, v103
    v_cvt_pk_bf16_f32 v46, v108, v109
    v_cvt_pk_bf16_f32 v47, v110, v111
    v_permlane32_swap_b32 v40, v44
    v_permlane32_swap_b32 v41, v45
    v_permlane32_swap_b32 v42, v46
    v_permlane32_swap_b32 v43, v47
    v_permlane16_swap_b32 v40, v44
    v_permlane16_swap_b32 v41, v45
    v_permlane16_swap_b32 v42, v46
    v_permlane16_swap_b32 v43, v47
    s_nop 1
    buffer_store_dwordx4 v[40:43], v12, s[24:27], 0 offen offset:3072 sc1
    buffer_store_dwordx4 v[44:47], v12, s[24:27], s30 offen offset:3072 sc1
    s_and_b32 s6, s4, 3
    s_lshr_b32 s29, s4, 2
    s_lshl_b32 s30, s3, 5
    s_lshl_b32 s31, s29, 2
    s_add_u32 s30, s30, s31
    s_lshl_b32 s30, s30, 15
    s_add_u32 s12, s54, s30
    s_addc_u32 s13, s55, 0
    s_mov_b32 s14, 131072
    s_mov_b32 s15, 0x20000
    s_lshl_b32 s30, s3, 2
    s_add_u32 s30, s30, s6
    s_lshl_b32 s30, s30, 3
    s_add_u32 s30, s30, s29
    s_mul_i32 s30, s30, 36864
    s_add_u32 s30, s30, 8388608
    s_add_u32 s16, s54, s30
    s_addc_u32 s17, s55, 0
    s_mov_b32 s18, 36864
    s_mov_b32 s19, 0x20000
    v_and_b32 v2, 15, v1
    v_lshrrev_b32 v3, 4, v1
    v_lshrrev_b32 v4, 2, v2
    v_and_b32 v5, 3, v2
    v_lshl_add_u32 v4, v3, 2, v4
    v_mul_u32_u24 v4, 288, v4
    v_lshl_add_u32 v4, v5, 3, v4
    v_add_u32 v8, 73728, v4
    v_add_u32 v9, 0, v4
    v_add_u32 v10, 36864, v4
    v_add_u32 v11, 110592, v4
    v_lshlrev_b32 v13, 4, v1
    s_mul_i32 s29, s5, 9216
    v_add_u32 v13, s29, v13
    s_barrier
    ds_read_b64_tr_b16 v[144:145], v8 offset:0
    ds_read_b64_tr_b16 v[146:147], v8 offset:4608
    ds_read_b64_tr_b16 v[148:149], v8 offset:32
    ds_read_b64_tr_b16 v[150:151], v8 offset:4640
    ds_read_b64_tr_b16 v[152:153], v8 offset:64
    ds_read_b64_tr_b16 v[154:155], v8 offset:4672
    ds_read_b64_tr_b16 v[156:157], v8 offset:96
    ds_read_b64_tr_b16 v[158:159], v8 offset:4704
    s_waitcnt lgkmcnt(6)
    v_mfma_f32_16x16x32_bf16 v[168:171], v[144:147], v[16:19], 0
    ds_read_b64_tr_b16 v[160:161], v8 offset:128
    ds_read_b64_tr_b16 v[162:163], v8 offset:4736
    v_mfma_f32_16x16x32_bf16 v[172:175], v[144:147], v[20:23], 0
    s_waitcnt lgkmcnt(6)
    v_mfma_f32_16x16x32_bf16 v[176:179], v[148:151], v[16:19], 0
    ds_read_b64_tr_b16 v[164:165], v8 offset:160
    ds_read_b64_tr_b16 v[166:167], v8 offset:4768
    v_mfma_f32_16x16x32_bf16 v[180:183], v[148:151], v[20:23], 0
    s_waitcnt lgkmcnt(6)
    v_mfma_f32_16x16x32_bf16 v[184:187], v[152:155], v[16:19], 0
    ds_read_b64_tr_b16 v[144:145], v8 offset:192
    ds_read_b64_tr_b16 v[146:147], v8 offset:4800
    v_mfma_f32_16x16x32_bf16 v[188:191], v[152:155], v[20:23], 0
    s_waitcnt lgkmcnt(6)
    v_mfma_f32_16x16x32_bf16 v[192:195], v[156:159], v[16:19], 0
    ds_read_b64_tr_b16 v[148:149], v8 offset:224
    ds_read_b64_tr_b16 v[150:151], v8 offset:4832
    v_mfma_f32_16x16x32_bf16 v[196:199], v[156:159], v[20:23], 0
    s_waitcnt lgkmcnt(6)
    v_mfma_f32_16x16x32_bf16 v[200:203], v[160:163], v[16:19], 0
    ds_read_b64_tr_b16 v[152:153], v8 offset:256
    ds_read_b64_tr_b16 v[154:155], v8 offset:4864
    v_mfma_f32_16x16x32_bf16 v[204:207], v[160:163], v[20:23], 0
    s_waitcnt lgkmcnt(6)
    v_mfma_f32_16x16x32_bf16 v[208:211], v[164:167], v[16:19], 0
    ds_read_b64_tr_b16 v[156:157], v8 offset:9216
    ds_read_b64_tr_b16 v[158:159], v8 offset:13824
    v_mfma_f32_16x16x32_bf16 v[212:215], v[164:167], v[20:23], 0
    s_waitcnt lgkmcnt(6)
    v_mfma_f32_16x16x32_bf16 v[216:219], v[144:147], v[16:19], 0
    ds_read_b64_tr_b16 v[160:161], v8 offset:9248
    ds_read_b64_tr_b16 v[162:163], v8 offset:13856
    v_mfma_f32_16x16x32_bf16 v[220:223], v[144:147], v[20:23], 0
    s_waitcnt lgkmcnt(6)
    v_mfma_f32_16x16x32_bf16 a[0:3], v[148:151], v[16:19], 0
    ds_read_b64_tr_b16 v[164:165], v8 offset:9280
    ds_read_b64_tr_b16 v[166:167], v8 offset:13888
    v_mfma_f32_16x16x32_bf16 a[4:7], v[148:151], v[20:23], 0
    s_waitcnt lgkmcnt(6)
    v_mfma_f32_16x16x32_bf16 a[8:11], v[152:155], v[16:19], 0
    ds_read_b64_tr_b16 v[144:145], v8 offset:9312
    ds_read_b64_tr_b16 v[146:147], v8 offset:13920
    v_mfma_f32_16x16x32_bf16 a[12:15], v[152:155], v[20:23], 0
    s_waitcnt lgkmcnt(6)
    v_mfma_f32_16x16x32_bf16 v[168:171], v[156:159], v[24:27], v[168:171]
    ds_read_b64_tr_b16 v[148:149], v8 offset:9344
    ds_read_b64_tr_b16 v[150:151], v8 offset:13952
    v_mfma_f32_16x16x32_bf16 v[172:175], v[156:159], v[28:31], v[172:175]
    s_waitcnt lgkmcnt(6)
    v_mfma_f32_16x16x32_bf16 v[176:179], v[160:163], v[24:27], v[176:179]
    ds_read_b64_tr_b16 v[152:153], v8 offset:9376
    ds_read_b64_tr_b16 v[154:155], v8 offset:13984
    v_mfma_f32_16x16x32_bf16 v[180:183], v[160:163], v[28:31], v[180:183]
    s_waitcnt lgkmcnt(6)
    v_mfma_f32_16x16x32_bf16 v[184:187], v[164:167], v[24:27], v[184:187]
    ds_read_b64_tr_b16 v[156:157], v8 offset:9408
    ds_read_b64_tr_b16 v[158:159], v8 offset:14016
    v_mfma_f32_16x16x32_bf16 v[188:191], v[164:167], v[28:31], v[188:191]
    s_waitcnt lgkmcnt(6)
    v_mfma_f32_16x16x32_bf16 v[192:195], v[144:147], v[24:27], v[192:195]
    ds_read_b64_tr_b16 v[160:161], v8 offset:9440
    ds_read_b64_tr_b16 v[162:163], v8 offset:14048
    v_mfma_f32_16x16x32_bf16 v[196:199], v[144:147], v[28:31], v[196:199]
    s_waitcnt lgkmcnt(6)
    v_mfma_f32_16x16x32_bf16 v[200:203], v[148:151], v[24:27], v[200:203]
    ds_read_b64_tr_b16 v[164:165], v8 offset:9472
    ds_read_b64_tr_b16 v[166:167], v8 offset:14080
    v_mfma_f32_16x16x32_bf16 v[204:207], v[148:151], v[28:31], v[204:207]
    s_waitcnt lgkmcnt(6)
    v_mfma_f32_16x16x32_bf16 v[208:211], v[152:155], v[24:27], v[208:211]
    ds_read_b64_tr_b16 v[144:145], v8 offset:18432
    ds_read_b64_tr_b16 v[146:147], v8 offset:23040
    v_mfma_f32_16x16x32_bf16 v[212:215], v[152:155], v[28:31], v[212:215]
    s_waitcnt lgkmcnt(6)
    v_mfma_f32_16x16x32_bf16 v[216:219], v[156:159], v[24:27], v[216:219]
    ds_read_b64_tr_b16 v[148:149], v8 offset:18464
    ds_read_b64_tr_b16 v[150:151], v8 offset:23072
    v_mfma_f32_16x16x32_bf16 v[220:223], v[156:159], v[28:31], v[220:223]
    s_waitcnt vmcnt(0)
    s_barrier
    s_cmp_lg_u32 s5, 0
    s_cbranch_scc1 L_nopub1
    s_lshl_b32 s29, s39, 7
    v_mov_b32 v3, s58
    s_cmp_lg_u32 s7, 0
    s_cbranch_scc1 L_pub1f
    buffer_store_dword v3, off, s[20:23], s29 sc1
    s_branch L_nopub1
L_pub1f:
    buffer_store_dword v3, off, s[20:23], s29
L_nopub1:
    s_nop 1
    s_waitcnt lgkmcnt(6)
    v_mfma_f32_16x16x32_bf16 a[0:3], v[160:163], v[24:27], a[0:3]
    ds_read_b64_tr_b16 v[152:153], v8 offset:18496
    ds_read_b64_tr_b16 v[154:155], v8 offset:23104
    v_mfma_f32_16x16x32_bf16 a[4:7], v[160:163], v[28:31], a[4:7]
    s_waitcnt lgkmcnt(6)
    v_mfma_f32_16x16x32_bf16 a[8:11], v[164:167], v[24:27], a[8:11]
    ds_read_b64_tr_b16 v[156:157], v8 offset:18528
    ds_read_b64_tr_b16 v[158:159], v8 offset:23136
    v_mfma_f32_16x16x32_bf16 a[12:15], v[164:167], v[28:31], a[12:15]
    s_waitcnt lgkmcnt(6)
    v_mfma_f32_16x16x32_bf16 v[168:171], v[144:147], v[32:35], v[168:171]
    ds_read_b64_tr_b16 v[160:161], v8 offset:18560
    ds_read_b64_tr_b16 v[162:163], v8 offset:23168
    v_mfma_f32_16x16x32_bf16 v[172:175], v[144:147], v[36:39], v[172:175]
    s_waitcnt lgkmcnt(6)
    v_mfma_f32_16x16x32_bf16 v[176:179], v[148:151], v[32:35], v[176:179]
    ds_read_b64_tr_b16 v[164:165], v8 offset:18592
    ds_read_b64_tr_b16 v[166:167], v8 offset:23200
    v_mfma_f32_16x16x32_bf16 v[180:183], v[148:151], v[36:39], v[180:183]
    s_and_b32 s29, s39, 0xfffffffc
    v_and_b32 v4, 3, v1
    v_add_u32 v4, s29, v4
    v_lshlrev_b32 v4, 7, v4
    s_mov_b32 s32, 200000
L_poll_f1:
    buffer_load_dword v2, v4, s[20:23], 0 offen sc1
    s_waitcnt vmcnt(0)
    v_cmp_ne_u32 vcc, s58, v2
    s_nop 1
    s_cbranch_vccz L_polld_f1
    s_sub_u32 s32, s32, 1
    s_cmp_eq_u32 s32, 0
    s_cbranch_scc1 L_polld_f1
    s_branch L_poll_f1
L_polld_f1:
    s_add_u32 s29, s6, 1
    s_and_b32 s29, s29, 3
    s_lshl_b32 s29, s29, 15
    s_add_u32 s30, s29, 4096
    buffer_load_dwordx4 v[48:51], v12, s[12:15], s29 offen offset:0 sc1
    buffer_load_dwordx4 v[52:55], v12, s[12:15], s30 offen offset:0 sc1
    buffer_load_dwordx4 v[56:59], v12, s[12:15], s29 offen offset:1024 sc1
    buffer_load_dwordx4 v[60:63], v12, s[12:15], s30 offen offset:1024 sc1
    buffer_load_dwordx4 v[64:67], v12, s[12:15], s29 offen offset:2048 sc1
    buffer_load_dwordx4 v[68:71], v12, s[12:15], s30 offen offset:2048 sc1
    buffer_load_dwordx4 v[72:75], v12, s[12:15], s29 offen offset:3072 sc1
    buffer_load_dwordx4 v[76:79], v12, s[12:15], s30 offen offset:3072 sc1
    s_waitcnt lgkmcnt(6)
    v_mfma_f32_16x16x32_bf16 v[184:187], v[152:155], v[32:35], v[184:187]
    ds_read_b64_tr_b16 v[144:145], v8 offset:18624
    ds_read_b64_tr_b16 v[146:147], v8 offset:23232
    v_mfma_f32_16x16x32_bf16 v[188:191], v[152:155], v[36:39], v[188:191]
    s_waitcnt lgkmcnt(6)
    v_mfma_f32_16x16x32_bf16 v[192:195], v[156:159], v[32:35], v[192:195]
    ds_read_b64_tr_b16 v[148:149], v8 offset:18656
    ds_read_b64_tr_b16 v[150:151], v8 offset:23264
    v_mfma_f32_16x16x32_bf16 v[196:199], v[156:159], v[36:39], v[196:199]
    s_waitcnt lgkmcnt(6)
    v_mfma_f32_16x16x32_bf16 v[200:203], v[160:163], v[32:35], v[200:203]
    ds_read_b64_tr_b16 v[152:153], v8 offset:18688
    ds_read_b64_tr_b16 v[154:155], v8 offset:23296
    v_mfma_f32_16x16x32_bf16 v[204:207], v[160:163], v[36:39], v[204:207]
    s_waitcnt lgkmcnt(6)
    v_mfma_f32_16x16x32_bf16 v[208:211], v[164:167], v[32:35], v[208:211]
    ds_read_b64_tr_b16 v[156:157], v8 offset:27648
    ds_read_b64_tr_b16 v[158:159], v8 offset:32256
    v_mfma_f32_16x16x32_bf16 v[212:215], v[164:167], v[36:39], v[212:215]
    s_waitcnt lgkmcnt(6)
    v_mfma_f32_16x16x32_bf16 v[216:219], v[144:147], v[32:35], v[216:219]
    ds_read_b64_tr_b16 v[160:161], v8 offset:27680
    ds_read_b64_tr_b16 v[162:163], v8 offset:32288
    v_mfma_f32_16x16x32_bf16 v[220:223], v[144:147], v[36:39], v[220:223]
    s_waitcnt lgkmcnt(6)
    v_mfma_f32_16x16x32_bf16 a[0:3], v[148:151], v[32:35], a[0:3]
    ds_read_b64_tr_b16 v[164:165], v8 offset:27712
    ds_read_b64_tr_b16 v[166:167], v8 offset:32320
    v_mfma_f32_16x16x32_bf16 a[4:7], v[148:151], v[36:39], a[4:7]
    s_waitcnt lgkmcnt(6)
    v_mfma_f32_16x16x32_bf16 a[8:11], v[152:155], v[32:35], a[8:11]
    ds_read_b64_tr_b16 v[144:145], v8 offset:27744
    ds_read_b64_tr_b16 v[146:147], v8 offset:32352
    v_mfma_f32_16x16x32_bf16 a[12:15], v[152:155], v[36:39], a[12:15]
    s_waitcnt lgkmcnt(6)
    v_mfma_f32_16x16x32_bf16 v[168:171], v[156:159], v[40:43], v[168:171]
    ds_read_b64_tr_b16 v[148:149], v8 offset:27776
    ds_read_b64_tr_b16 v[150:151], v8 offset:32384
    v_mfma_f32_16x16x32_bf16 v[172:175], v[156:159], v[44:47], v[172:175]
    s_waitcnt lgkmcnt(6)
    v_mfma_f32_16x16x32_bf16 v[176:179], v[160:163], v[40:43], v[176:179]
    ds_read_b64_tr_b16 v[152:153], v8 offset:27808
    ds_read_b64_tr_b16 v[154:155], v8 offset:32416
    v_mfma_f32_16x16x32_bf16 v[180:183], v[160:163], v[44:47], v[180:183]
    s_waitcnt lgkmcnt(6)
    v_mfma_f32_16x16x32_bf16 v[184:187], v[164:167], v[40:43], v[184:187]
    ds_read_b64_tr_b16 v[156:157], v8 offset:27840
    ds_read_b64_tr_b16 v[158:159], v8 offset:32448
    v_mfma_f32_16x16x32_bf16 v[188:191], v[164:167], v[44:47], v[188:191]
    s_waitcnt lgkmcnt(6)
    v_mfma_f32_16x16x32_bf16 v[192:195], v[144:147], v[40:43], v[192:195]
    ds_read_b64_tr_b16 v[160:161], v8 offset:27872
    ds_read_b64_tr_b16 v[162:163], v8 offset:32480
    v_mfma_f32_16x16x32_bf16 v[196:199], v[144:147], v[44:47], v[196:199]
    s_waitcnt lgkmcnt(6)
    v_mfma_f32_16x16x32_bf16 v[200:203], v[148:151], v[40:43], v[200:203]
    ds_read_b64_tr_b16 v[164:165], v8 offset:27904
    ds_read_b64_tr_b16 v[166:167], v8 offset:32512
    v_mfma_f32_16x16x32_bf16 v[204:207], v[148:151], v[44:47], v[204:207]
    s_waitcnt lgkmcnt(6)
    v_mfma_f32_16x16x32_bf16 v[208:211], v[152:155], v[40:43], v[208:211]
    s_barrier
    ds_read_b64_tr_b16 v[144:145], v9 offset:0
    ds_read_b64_tr_b16 v[146:147], v9 offset:4608
    v_mfma_f32_16x16x32_bf16 v[212:215], v[152:155], v[44:47], v[212:215]
    s_waitcnt lgkmcnt(6)
    v_mfma_f32_16x16x32_bf16 v[216:219], v[156:159], v[40:43], v[216:219]
    ds_read_b64_tr_b16 v[148:149], v9 offset:32
    ds_read_b64_tr_b16 v[150:151], v9 offset:4640
    v_mfma_f32_16x16x32_bf16 v[220:223], v[156:159], v[44:47], v[220:223]
    s_waitcnt lgkmcnt(6)
    v_mfma_f32_16x16x32_bf16 a[0:3], v[160:163], v[40:43], a[0:3]
    ds_read_b64_tr_b16 v[152:153], v9 offset:64
    ds_read_b64_tr_b16 v[154:155], v9 offset:4672
    v_mfma_f32_16x16x32_bf16 a[4:7], v[160:163], v[44:47], a[4:7]
    s_waitcnt lgkmcnt(6)
    v_mfma_f32_16x16x32_bf16 a[8:11], v[164:167], v[40:43], a[8:11]
    ds_read_b64_tr_b16 v[156:157], v9 offset:96
    ds_read_b64_tr_b16 v[158:159], v9 offset:4704
    v_mfma_f32_16x16x32_bf16 a[12:15], v[164:167], v[44:47], a[12:15]
    s_waitcnt lgkmcnt(6)
    s_waitcnt vmcnt(7)
    v_mfma_f32_16x16x32_bf16 v[168:171], v[144:147], v[48:51], v[168:171]
    ds_read_b64_tr_b16 v[160:161], v9 offset:128
    ds_read_b64_tr_b16 v[162:163], v9 offset:4736
    s_waitcnt vmcnt(6)
    v_mfma_f32_16x16x32_bf16 v[172:175], v[144:147], v[52:55], v[172:175]
    s_waitcnt lgkmcnt(6)
    v_mfma_f32_16x16x32_bf16 v[176:179], v[148:151], v[48:51], v[176:179]
    ds_read_b64_tr_b16 v[164:165], v9 offset:160
    ds_read_b64_tr_b16 v[166:167], v9 offset:4768
    v_mfma_f32_16x16x32_bf16 v[180:183], v[148:151], v[52:55], v[180:183]
    s_add_u32 s29, s6, 2
    s_and_b32 s29, s29, 3
    s_lshl_b32 s29, s29, 15
    s_add_u32 s30, s29, 4096
    buffer_load_dwordx4 v[80:83], v12, s[12:15], s29 offen offset:0 sc1
    buffer_load_dwordx4 v[84:87], v12, s[12:15], s30 offen offset:0 sc1
    buffer_load_dwordx4 v[88:91], v12, s[12:15], s29 offen offset:1024 sc1
    buffer_load_dwordx4 v[92:95], v12, s[12:15], s30 offen offset:1024 sc1
    buffer_load_dwordx4 v[96:99], v12, s[12:15], s29 offen offset:2048 sc1
    buffer_load_dwordx4 v[100:103], v12, s[12:15], s30 offen offset:2048 sc1
    buffer_load_dwordx4 v[104:107], v12, s[12:15], s29 offen offset:3072 sc1
    buffer_load_dwordx4 v[108:111], v12, s[12:15], s30 offen offset:3072 sc1
    s_waitcnt lgkmcnt(6)
    v_mfma_f32_16x16x32_bf16 v[184:187], v[152:155], v[48:51], v[184:187]
    ds_read_b64_tr_b16 v[144:145], v9 offset:192
    ds_read_b64_tr_b16 v[146:147], v9 offset:4800
    v_mfma_f32_16x16x32_bf16 v[188:191], v[152:155], v[52:55], v[188:191]
    s_waitcnt lgkmcnt(6)
    v_mfma_f32_16x16x32_bf16 v[192:195], v[156:159], v[48:51], v[192:195]
    ds_read_b64_tr_b16 v[148:149], v9 offset:224
    ds_read_b64_tr_b16 v[150:151], v9 offset:4832
    v_mfma_f32_16x16x32_bf16 v[196:199], v[156:159], v[52:55], v[196:199]
    s_waitcnt lgkmcnt(6)
    v_mfma_f32_16x16x32_bf16 v[200:203], v[160:163], v[48:51], v[200:203]
    ds_read_b64_tr_b16 v[152:153], v9 offset:256
    ds_read_b64_tr_b16 v[154:155], v9 offset:4864
    v_mfma_f32_16x16x32_bf16 v[204:207], v[160:163], v[52:55], v[204:207]
    s_waitcnt lgkmcnt(6)
    v_mfma_f32_16x16x32_bf16 v[208:211], v[164:167], v[48:51], v[208:211]
    ds_read_b64_tr_b16 v[156:157], v9 offset:9216
    ds_read_b64_tr_b16 v[158:159], v9 offset:13824
    v_mfma_f32_16x16x32_bf16 v[212:215], v[164:167], v[52:55], v[212:215]
    s_waitcnt lgkmcnt(6)
    v_mfma_f32_16x16x32_bf16 v[216:219], v[144:147], v[48:51], v[216:219]
    ds_read_b64_tr_b16 v[160:161], v9 offset:9248
    ds_read_b64_tr_b16 v[162:163], v9 offset:13856
    v_mfma_f32_16x16x32_bf16 v[220:223], v[144:147], v[52:55], v[220:223]
    s_waitcnt lgkmcnt(6)
    v_mfma_f32_16x16x32_bf16 a[0:3], v[148:151], v[48:51], a[0:3]
    ds_read_b64_tr_b16 v[164:165], v9 offset:9280
    ds_read_b64_tr_b16 v[166:167], v9 offset:13888
    v_mfma_f32_16x16x32_bf16 a[4:7], v[148:151], v[52:55], a[4:7]
    s_waitcnt lgkmcnt(6)
    v_mfma_f32_16x16x32_bf16 a[8:11], v[152:155], v[48:51], a[8:11]
    ds_read_b64_tr_b16 v[144:145], v9 offset:9312
    ds_read_b64_tr_b16 v[146:147], v9 offset:13920
    v_mfma_f32_16x16x32_bf16 a[12:15], v[152:155], v[52:55], a[12:15]
    s_waitcnt lgkmcnt(6)
    s_waitcnt vmcnt(13)
    v_mfma_f32_16x16x32_bf16 v[168:171], v[156:159], v[56:59], v[168:171]
    ds_read_b64_tr_b16 v[148:149], v9 offset:9344
    ds_read_b64_tr_b16 v[150:151], v9 offset:13952
    s_waitcnt vmcnt(12)
    v_mfma_f32_16x16x32_bf16 v[172:175], v[156:159], v[60:63], v[172:175]
    s_waitcnt lgkmcnt(6)
    v_mfma_f32_16x16x32_bf16 v[176:179], v[160:163], v[56:59], v[176:179]
    ds_read_b64_tr_b16 v[152:153], v9 offset:9376
    ds_read_b64_tr_b16 v[154:155], v9 offset:13984
    v_mfma_f32_16x16x32_bf16 v[180:183], v[160:163], v[60:63], v[180:183]
    s_waitcnt lgkmcnt(6)
    v_mfma_f32_16x16x32_bf16 v[184:187], v[164:167], v[56:59], v[184:187]
    ds_read_b64_tr_b16 v[156:157], v9 offset:9408
    ds_read_b64_tr_b16 v[158:159], v9 offset:14016
    v_mfma_f32_16x16x32_bf16 v[188:191], v[164:167], v[60:63], v[188:191]
    s_add_u32 s29, s6, 3
    s_and_b32 s29, s29, 3
    s_lshl_b32 s29, s29, 15
    s_add_u32 s30, s29, 4096
    buffer_load_dwordx4 v[112:115], v12, s[12:15], s29 offen offset:0 sc1
    buffer_load_dwordx4 v[116:119], v12, s[12:15], s30 offen offset:0 sc1
    buffer_load_dwordx4 v[120:123], v12, s[12:15], s29 offen offset:1024 sc1
    buffer_load_dwordx4 v[124:127], v12, s[12:15], s30 offen offset:1024 sc1
    buffer_load_dwordx4 v[128:131], v12, s[12:15], s29 offen offset:2048 sc1
    buffer_load_dwordx4 v[132:135], v12, s[12:15], s30 offen offset:2048 sc1
    buffer_load_dwordx4 v[136:139], v12, s[12:15], s29 offen offset:3072 sc1
    buffer_load_dwordx4 v[140:143], v12, s[12:15], s30 offen offset:3072 sc1
    s_barrier
    s_waitcnt lgkmcnt(6)
    v_mfma_f32_16x16x32_bf16 v[192:195], v[144:147], v[56:59], v[192:195]
    ds_read_b64_tr_b16 v[160:161], v9 offset:9440
    ds_read_b64_tr_b16 v[162:163], v9 offset:14048
    v_mfma_f32_16x16x32_bf16 v[196:199], v[144:147], v[60:63], v[196:199]
    s_waitcnt lgkmcnt(6)
    v_mfma_f32_16x16x32_bf16 v[200:203], v[148:151], v[56:59], v[200:203]
    ds_read_b64_tr_b16 v[164:165], v9 offset:9472
    ds_read_b64_tr_b16 v[166:167], v9 offset:14080
    v_mfma_f32_16x16x32_bf16 v[204:207], v[148:151], v[60:63], v[204:207]
    s_waitcnt lgkmcnt(6)
    v_mfma_f32_16x16x32_bf16 v[208:211], v[152:155], v[56:59], v[208:211]
    ds_read_b64_tr_b16 v[144:145], v9 offset:18432
    ds_read_b64_tr_b16 v[146:147], v9 offset:23040
    v_mfma_f32_16x16x32_bf16 v[212:215], v[152:155], v[60:63], v[212:215]
    s_waitcnt lgkmcnt(6)
    v_mfma_f32_16x16x32_bf16 v[216:219], v[156:159], v[56:59], v[216:219]
    ds_read_b64_tr_b16 v[148:149], v9 offset:18464
    ds_read_b64_tr_b16 v[150:151], v9 offset:23072
    v_mfma_f32_16x16x32_bf16 v[220:223], v[156:159], v[60:63], v[220:223]
    s_waitcnt lgkmcnt(6)
    v_mfma_f32_16x16x32_bf16 a[0:3], v[160:163], v[56:59], a[0:3]
    ds_read_b64_tr_b16 v[152:153], v9 offset:18496
    ds_read_b64_tr_b16 v[154:155], v9 offset:23104
    v_mfma_f32_16x16x32_bf16 a[4:7], v[160:163], v[60:63], a[4:7]
    s_waitcnt lgkmcnt(6)
    v_mfma_f32_16x16x32_bf16 a[8:11], v[164:167], v[56:59], a[8:11]
    ds_read_b64_tr_b16 v[156:157], v9 offset:18528
    ds_read_b64_tr_b16 v[158:159], v9 offset:23136
    v_mfma_f32_16x16x32_bf16 a[12:15], v[164:167], v[60:63], a[12:15]
    s_waitcnt lgkmcnt(6)
    s_waitcnt vmcnt(19)
    v_mfma_f32_16x16x32_bf16 v[168:171], v[144:147], v[64:67], v[168:171]
    ds_read_b64_tr_b16 v[160:161], v9 offset:18560
    ds_read_b64_tr_b16 v[162:163], v9 offset:23168
    s_waitcnt vmcnt(18)
    v_mfma_f32_16x16x32_bf16 v[172:175], v[144:147], v[68:71], v[172:175]
    s_waitcnt lgkmcnt(6)
    v_mfma_f32_16x16x32_bf16 v[176:179], v[148:151], v[64:67], v[176:179]
    ds_read_b64_tr_b16 v[164:165], v9 offset:18592
    ds_read_b64_tr_b16 v[166:167], v9 offset:23200
    v_mfma_f32_16x16x32_bf16 v[180:183], v[148:151], v[68:71], v[180:183]
    s_waitcnt lgkmcnt(6)
    v_mfma_f32_16x16x32_bf16 v[184:187], v[152:155], v[64:67], v[184:187]
    ds_read_b64_tr_b16 v[144:145], v9 offset:18624
    ds_read_b64_tr_b16 v[146:147], v9 offset:23232
    v_mfma_f32_16x16x32_bf16 v[188:191], v[152:155], v[68:71], v[188:191]
    s_waitcnt lgkmcnt(6)
    v_mfma_f32_16x16x32_bf16 v[192:195], v[156:159], v[64:67], v[192:195]
    ds_read_b64_tr_b16 v[148:149], v9 offset:18656
    ds_read_b64_tr_b16 v[150:151], v9 offset:23264
    v_mfma_f32_16x16x32_bf16 v[196:199], v[156:159], v[68:71], v[196:199]
    s_waitcnt lgkmcnt(6)
    v_mfma_f32_16x16x32_bf16 v[200:203], v[160:163], v[64:67], v[200:203]
    ds_read_b64_tr_b16 v[152:153], v9 offset:18688
    ds_read_b64_tr_b16 v[154:155], v9 offset:23296
    v_mfma_f32_16x16x32_bf16 v[204:207], v[160:163], v[68:71], v[204:207]
    s_waitcnt lgkmcnt(6)
    v_mfma_f32_16x16x32_bf16 v[208:211], v[164:167], v[64:67], v[208:211]
    ds_read_b64_tr_b16 v[156:157], v9 offset:27648
    ds_read_b64_tr_b16 v[158:159], v9 offset:32256
    v_mfma_f32_16x16x32_bf16 v[212:215], v[164:167], v[68:71], v[212:215]
    s_waitcnt lgkmcnt(6)
    v_mfma_f32_16x16x32_bf16 v[216:219], v[144:147], v[64:67], v[216:219]
    ds_read_b64_tr_b16 v[160:161], v9 offset:27680
    ds_read_b64_tr_b16 v[162:163], v9 offset:32288
    v_mfma_f32_16x16x32_bf16 v[220:223], v[144:147], v[68:71], v[220:223]
    s_waitcnt lgkmcnt(6)
    v_mfma_f32_16x16x32_bf16 a[0:3], v[148:151], v[64:67], a[0:3]
    ds_read_b64_tr_b16 v[164:165], v9 offset:27712
    ds_read_b64_tr_b16 v[166:167], v9 offset:32320
    v_mfma_f32_16x16x32_bf16 a[4:7], v[148:151], v[68:71], a[4:7]
    s_waitcnt lgkmcnt(6)
    v_mfma_f32_16x16x32_bf16 a[8:11], v[152:155], v[64:67], a[8:11]
    ds_read_b64_tr_b16 v[144:145], v9 offset:27744
    ds_read_b64_tr_b16 v[146:147], v9 offset:32352
    v_mfma_f32_16x16x32_bf16 a[12:15], v[152:155], v[68:71], a[12:15]
    s_waitcnt lgkmcnt(6)
    s_waitcnt vmcnt(17)
    v_mfma_f32_16x16x32_bf16 v[168:171], v[156:159], v[72:75], v[168:171]
    ds_read_b64_tr_b16 v[148:149], v9 offset:27776
    ds_read_b64_tr_b16 v[150:151], v9 offset:32384
    s_waitcnt vmcnt(16)
    v_mfma_f32_16x16x32_bf16 v[172:175], v[156:159], v[76:79], v[172:175]
    s_waitcnt lgkmcnt(6)
    v_mfma_f32_16x16x32_bf16 v[176:179], v[160:163], v[72:75], v[176:179]
    ds_read_b64_tr_b16 v[152:153], v9 offset:27808
    ds_read_b64_tr_b16 v[154:155], v9 offset:32416
    v_mfma_f32_16x16x32_bf16 v[180:183], v[160:163], v[76:79], v[180:183]
    s_waitcnt lgkmcnt(6)
    v_mfma_f32_16x16x32_bf16 v[184:187], v[164:167], v[72:75], v[184:187]
    ds_read_b64_tr_b16 v[156:157], v9 offset:27840
    ds_read_b64_tr_b16 v[158:159], v9 offset:32448
    v_mfma_f32_16x16x32_bf16 v[188:191], v[164:167], v[76:79], v[188:191]
    s_waitcnt lgkmcnt(6)
    v_mfma_f32_16x16x32_bf16 v[192:195], v[144:147], v[72:75], v[192:195]
    ds_read_b64_tr_b16 v[160:161], v9 offset:27872
    ds_read_b64_tr_b16 v[162:163], v9 offset:32480
    v_mfma_f32_16x16x32_bf16 v[196:199], v[144:147], v[76:79], v[196:199]
    s_waitcnt lgkmcnt(6)
    v_mfma_f32_16x16x32_bf16 v[200:203], v[148:151], v[72:75], v[200:203]
    ds_read_b64_tr_b16 v[164:165], v9 offset:27904
    ds_read_b64_tr_b16 v[166:167], v9 offset:32512
    v_mfma_f32_16x16x32_bf16 v[204:207], v[148:151], v[76:79], v[204:207]
    s_waitcnt lgkmcnt(6)
    v_mfma_f32_16x16x32_bf16 v[208:211], v[152:155], v[72:75], v[208:211]
    s_barrier
    ds_read_b64_tr_b16 v[144:145], v10 offset:0
    ds_read_b64_tr_b16 v[146:147], v10 offset:4608
    v_mfma_f32_16x16x32_bf16 v[212:215], v[152:155], v[76:79], v[212:215]
    s_waitcnt lgkmcnt(6)
    v_mfma_f32_16x16x32_bf16 v[216:219], v[156:159], v[72:75], v[216:219]
    ds_read_b64_tr_b16 v[148:149], v10 offset:32
    ds_read_b64_tr_b16 v[150:151], v10 offset:4640
    v_mfma_f32_16x16x32_bf16 v[220:223], v[156:159], v[76:79], v[220:223]
    s_waitcnt lgkmcnt(6)
    v_mfma_f32_16x16x32_bf16 a[0:3], v[160:163], v[72:75], a[0:3]
    ds_read_b64_tr_b16 v[152:153], v10 offset:64
    ds_read_b64_tr_b16 v[154:155], v10 offset:4672
    v_mfma_f32_16x16x32_bf16 a[4:7], v[160:163], v[76:79], a[4:7]
    s_waitcnt lgkmcnt(6)
    v_mfma_f32_16x16x32_bf16 a[8:11], v[164:167], v[72:75], a[8:11]
    ds_read_b64_tr_b16 v[156:157], v10 offset:96
    ds_read_b64_tr_b16 v[158:159], v10 offset:4704
    v_mfma_f32_16x16x32_bf16 a[12:15], v[164:167], v[76:79], a[12:15]
    s_waitcnt lgkmcnt(6)
    s_waitcnt vmcnt(15)
    v_mfma_f32_16x16x32_bf16 v[168:171], v[144:147], v[80:83], v[168:171]
    ds_read_b64_tr_b16 v[160:161], v10 offset:128
    ds_read_b64_tr_b16 v[162:163], v10 offset:4736
    s_waitcnt vmcnt(14)
    v_mfma_f32_16x16x32_bf16 v[172:175], v[144:147], v[84:87], v[172:175]
    s_waitcnt lgkmcnt(6)
    v_mfma_f32_16x16x32_bf16 v[176:179], v[148:151], v[80:83], v[176:179]
    ds_read_b64_tr_b16 v[164:165], v10 offset:160
    ds_read_b64_tr_b16 v[166:167], v10 offset:4768
    v_mfma_f32_16x16x32_bf16 v[180:183], v[148:151], v[84:87], v[180:183]
    s_waitcnt lgkmcnt(6)
    v_mfma_f32_16x16x32_bf16 v[184:187], v[152:155], v[80:83], v[184:187]
    ds_read_b64_tr_b16 v[144:145], v10 offset:192
    ds_read_b64_tr_b16 v[146:147], v10 offset:4800
    v_mfma_f32_16x16x32_bf16 v[188:191], v[152:155], v[84:87], v[188:191]
    s_waitcnt lgkmcnt(6)
    v_mfma_f32_16x16x32_bf16 v[192:195], v[156:159], v[80:83], v[192:195]
    ds_read_b64_tr_b16 v[148:149], v10 offset:224
    ds_read_b64_tr_b16 v[150:151], v10 offset:4832
    v_mfma_f32_16x16x32_bf16 v[196:199], v[156:159], v[84:87], v[196:199]
    s_waitcnt lgkmcnt(6)
    v_mfma_f32_16x16x32_bf16 v[200:203], v[160:163], v[80:83], v[200:203]
    ds_read_b64_tr_b16 v[152:153], v10 offset:256
    ds_read_b64_tr_b16 v[154:155], v10 offset:4864
    v_mfma_f32_16x16x32_bf16 v[204:207], v[160:163], v[84:87], v[204:207]
    s_waitcnt lgkmcnt(6)
    v_mfma_f32_16x16x32_bf16 v[208:211], v[164:167], v[80:83], v[208:211]
    ds_read_b64_tr_b16 v[156:157], v10 offset:9216
    ds_read_b64_tr_b16 v[158:159], v10 offset:13824
    v_mfma_f32_16x16x32_bf16 v[212:215], v[164:167], v[84:87], v[212:215]
    s_waitcnt lgkmcnt(6)
    v_mfma_f32_16x16x32_bf16 v[216:219], v[144:147], v[80:83], v[216:219]
    ds_read_b64_tr_b16 v[160:161], v10 offset:9248
    ds_read_b64_tr_b16 v[162:163], v10 offset:13856
    v_mfma_f32_16x16x32_bf16 v[220:223], v[144:147], v[84:87], v[220:223]
    s_waitcnt lgkmcnt(6)
    v_mfma_f32_16x16x32_bf16 a[0:3], v[148:151], v[80:83], a[0:3]
    ds_read_b64_tr_b16 v[164:165], v10 offset:9280
    ds_read_b64_tr_b16 v[166:167], v10 offset:13888
    v_mfma_f32_16x16x32_bf16 a[4:7], v[148:151], v[84:87], a[4:7]
    s_waitcnt lgkmcnt(6)
    v_mfma_f32_16x16x32_bf16 a[8:11], v[152:155], v[80:83], a[8:11]
    ds_read_b64_tr_b16 v[144:145], v10 offset:9312
    ds_read_b64_tr_b16 v[146:147], v10 offset:13920
    v_mfma_f32_16x16x32_bf16 a[12:15], v[152:155], v[84:87], a[12:15]
    s_waitcnt lgkmcnt(6)
    s_waitcnt vmcnt(13)
    v_mfma_f32_16x16x32_bf16 v[168:171], v[156:159], v[88:91], v[168:171]
    ds_read_b64_tr_b16 v[148:149], v10 offset:9344
    ds_read_b64_tr_b16 v[150:151], v10 offset:13952
    s_waitcnt vmcnt(12)
    v_mfma_f32_16x16x32_bf16 v[172:175], v[156:159], v[92:95], v[172:175]
    s_waitcnt lgkmcnt(6)
    v_mfma_f32_16x16x32_bf16 v[176:179], v[160:163], v[88:91], v[176:179]
    ds_read_b64_tr_b16 v[152:153], v10 offset:9376
    ds_read_b64_tr_b16 v[154:155], v10 offset:13984
    v_mfma_f32_16x16x32_bf16 v[180:183], v[160:163], v[92:95], v[180:183]
    s_waitcnt lgkmcnt(6)
    v_mfma_f32_16x16x32_bf16 v[184:187], v[164:167], v[88:91], v[184:187]
    ds_read_b64_tr_b16 v[156:157], v10 offset:9408
    ds_read_b64_tr_b16 v[158:159], v10 offset:14016
    v_mfma_f32_16x16x32_bf16 v[188:191], v[164:167], v[92:95], v[188:191]
    s_waitcnt lgkmcnt(6)
    v_mfma_f32_16x16x32_bf16 v[192:195], v[144:147], v[88:91], v[192:195]
    ds_read_b64_tr_b16 v[160:161], v10 offset:9440
    ds_read_b64_tr_b16 v[162:163], v10 offset:14048
    v_mfma_f32_16x16x32_bf16 v[196:199], v[144:147], v[92:95], v[196:199]
    s_waitcnt lgkmcnt(6)
    v_mfma_f32_16x16x32_bf16 v[200:203], v[148:151], v[88:91], v[200:203]
    ds_read_b64_tr_b16 v[164:165], v10 offset:9472
    ds_read_b64_tr_b16 v[166:167], v10 offset:14080
    v_mfma_f32_16x16x32_bf16 v[204:207], v[148:151], v[92:95], v[204:207]
    s_waitcnt lgkmcnt(6)
    v_mfma_f32_16x16x32_bf16 v[208:211], v[152:155], v[88:91], v[208:211]
    ds_read_b64_tr_b16 v[144:145], v10 offset:18432
    ds_read_b64_tr_b16 v[146:147], v10 offset:23040
    v_mfma_f32_16x16x32_bf16 v[212:215], v[152:155], v[92:95], v[212:215]
    s_waitcnt lgkmcnt(6)
    v_mfma_f32_16x16x32_bf16 v[216:219], v[156:159], v[88:91], v[216:219]
    ds_read_b64_tr_b16 v[148:149], v10 offset:18464
    ds_read_b64_tr_b16 v[150:151], v10 offset:23072
    v_mfma_f32_16x16x32_bf16 v[220:223], v[156:159], v[92:95], v[220:223]
    s_waitcnt lgkmcnt(6)
    v_mfma_f32_16x16x32_bf16 a[0:3], v[160:163], v[88:91], a[0:3]
    ds_read_b64_tr_b16 v[152:153], v10 offset:18496
    ds_read_b64_tr_b16 v[154:155], v10 offset:23104
    v_mfma_f32_16x16x32_bf16 a[4:7], v[160:163], v[92:95], a[4:7]
    s_waitcnt lgkmcnt(6)
    v_mfma_f32_16x16x32_bf16 a[8:11], v[164:167], v[88:91], a[8:11]
    ds_read_b64_tr_b16 v[156:157], v10 offset:18528
    ds_read_b64_tr_b16 v[158:159], v10 offset:23136
    v_mfma_f32_16x16x32_bf16 a[12:15], v[164:167], v[92:95], a[12:15]
    s_waitcnt lgkmcnt(6)
    s_waitcnt vmcnt(11)
    v_mfma_f32_16x16x32_bf16 v[168:171], v[144:147], v[96:99], v[168:171]
    ds_read_b64_tr_b16 v[160:161], v10 offset:18560
    ds_read_b64_tr_b16 v[162:163], v10 offset:23168
    s_waitcnt vmcnt(10)
    v_mfma_f32_16x16x32_bf16 v[172:175], v[144:147], v[100:103], v[172:175]
    s_waitcnt lgkmcnt(6)
    v_mfma_f32_16x16x32_bf16 v[176:179], v[148:151], v[96:99], v[176:179]
    ds_read_b64_tr_b16 v[164:165], v10 offset:18592
    ds_read_b64_tr_b16 v[166:167], v10 offset:23200
    v_mfma_f32_16x16x32_bf16 v[180:183], v[148:151], v[100:103], v[180:183]
    s_waitcnt lgkmcnt(6)
    v_mfma_f32_16x16x32_bf16 v[184:187], v[152:155], v[96:99], v[184:187]
    ds_read_b64_tr_b16 v[144:145], v10 offset:18624
    ds_read_b64_tr_b16 v[146:147], v10 offset:23232
    v_mfma_f32_16x16x32_bf16 v[188:191], v[152:155], v[100:103], v[188:191]
    s_waitcnt lgkmcnt(6)
    v_mfma_f32_16x16x32_bf16 v[192:195], v[156:159], v[96:99], v[192:195]
    ds_read_b64_tr_b16 v[148:149], v10 offset:18656
    ds_read_b64_tr_b16 v[150:151], v10 offset:23264
    v_mfma_f32_16x16x32_bf16 v[196:199], v[156:159], v[100:103], v[196:199]
    s_waitcnt lgkmcnt(6)
    v_mfma_f32_16x16x32_bf16 v[200:203], v[160:163], v[96:99], v[200:203]
    ds_read_b64_tr_b16 v[152:153], v10 offset:18688
    ds_read_b64_tr_b16 v[154:155], v10 offset:23296
    v_mfma_f32_16x16x32_bf16 v[204:207], v[160:163], v[100:103], v[204:207]
    s_waitcnt lgkmcnt(6)
    v_mfma_f32_16x16x32_bf16 v[208:211], v[164:167], v[96:99], v[208:211]
    ds_read_b64_tr_b16 v[156:157], v10 offset:27648
    ds_read_b64_tr_b16 v[158:159], v10 offset:32256
    v_mfma_f32_16x16x32_bf16 v[212:215], v[164:167], v[100:103], v[212:215]
    s_waitcnt lgkmcnt(6)
    v_mfma_f32_16x16x32_bf16 v[216:219], v[144:147], v[96:99], v[216:219]
    ds_read_b64_tr_b16 v[160:161], v10 offset:27680
    ds_read_b64_tr_b16 v[162:163], v10 offset:32288
    v_mfma_f32_16x16x32_bf16 v[220:223], v[144:147], v[100:103], v[220:223]
    s_waitcnt lgkmcnt(6)
    v_mfma_f32_16x16x32_bf16 a[0:3], v[148:151], v[96:99], a[0:3]
    ds_read_b64_tr_b16 v[164:165], v10 offset:27712
    ds_read_b64_tr_b16 v[166:167], v10 offset:32320
    v_mfma_f32_16x16x32_bf16 a[4:7], v[148:151], v[100:103], a[4:7]
    s_waitcnt lgkmcnt(6)
    v_mfma_f32_16x16x32_bf16 a[8:11], v[152:155], v[96:99], a[8:11]
    ds_read_b64_tr_b16 v[144:145], v10 offset:27744
    ds_read_b64_tr_b16 v[146:147], v10 offset:32352
    v_mfma_f32_16x16x32_bf16 a[12:15], v[152:155], v[100:103], a[12:15]
    s_waitcnt lgkmcnt(6)
    s_waitcnt vmcnt(9)
    v_mfma_f32_16x16x32_bf16 v[168:171], v[156:159], v[104:107], v[168:171]
    ds_read_b64_tr_b16 v[148:149], v10 offset:27776
    ds_read_b64_tr_b16 v[150:151], v10 offset:32384
    s_waitcnt vmcnt(8)
    v_mfma_f32_16x16x32_bf16 v[172:175], v[156:159], v[108:111], v[172:175]
    s_waitcnt lgkmcnt(6)
    v_mfma_f32_16x16x32_bf16 v[176:179], v[160:163], v[104:107], v[176:179]
    ds_read_b64_tr_b16 v[152:153], v10 offset:27808
    ds_read_b64_tr_b16 v[154:155], v10 offset:32416
    v_mfma_f32_16x16x32_bf16 v[180:183], v[160:163], v[108:111], v[180:183]
    s_waitcnt lgkmcnt(6)
    v_mfma_f32_16x16x32_bf16 v[184:187], v[164:167], v[104:107], v[184:187]
    ds_read_b64_tr_b16 v[156:157], v10 offset:27840
    ds_read_b64_tr_b16 v[158:159], v10 offset:32448
    v_mfma_f32_16x16x32_bf16 v[188:191], v[164:167], v[108:111], v[188:191]
    s_waitcnt lgkmcnt(6)
    v_mfma_f32_16x16x32_bf16 v[192:195], v[144:147], v[104:107], v[192:195]
    ds_read_b64_tr_b16 v[160:161], v10 offset:27872
    ds_read_b64_tr_b16 v[162:163], v10 offset:32480
    v_mfma_f32_16x16x32_bf16 v[196:199], v[144:147], v[108:111], v[196:199]
    s_waitcnt lgkmcnt(6)
    v_mfma_f32_16x16x32_bf16 v[200:203], v[148:151], v[104:107], v[200:203]
    ds_read_b64_tr_b16 v[164:165], v10 offset:27904
    ds_read_b64_tr_b16 v[166:167], v10 offset:32512
    v_mfma_f32_16x16x32_bf16 v[204:207], v[148:151], v[108:111], v[204:207]
    s_waitcnt lgkmcnt(6)
    v_mfma_f32_16x16x32_bf16 v[208:211], v[152:155], v[104:107], v[208:211]
    s_barrier
    ds_read_b64_tr_b16 v[144:145], v11 offset:0
    ds_read_b64_tr_b16 v[146:147], v11 offset:4608
    v_mfma_f32_16x16x32_bf16 v[212:215], v[152:155], v[108:111], v[212:215]
    s_waitcnt lgkmcnt(6)
    v_mfma_f32_16x16x32_bf16 v[216:219], v[156:159], v[104:107], v[216:219]
    ds_read_b64_tr_b16 v[148:149], v11 offset:9216
    ds_read_b64_tr_b16 v[150:151], v11 offset:13824
    v_mfma_f32_16x16x32_bf16 v[220:223], v[156:159], v[108:111], v[220:223]
    s_waitcnt lgkmcnt(6)
    v_mfma_f32_16x16x32_bf16 a[0:3], v[160:163], v[104:107], a[0:3]
    ds_read_b64_tr_b16 v[152:153], v11 offset:18432
    ds_read_b64_tr_b16 v[154:155], v11 offset:23040
    v_mfma_f32_16x16x32_bf16 a[4:7], v[160:163], v[108:111], a[4:7]
    s_waitcnt lgkmcnt(6)
    v_mfma_f32_16x16x32_bf16 a[8:11], v[164:167], v[104:107], a[8:11]
    ds_read_b64_tr_b16 v[156:157], v11 offset:27648
    ds_read_b64_tr_b16 v[158:159], v11 offset:32256
    v_mfma_f32_16x16x32_bf16 a[12:15], v[164:167], v[108:111], a[12:15]
    s_waitcnt lgkmcnt(6)
    s_waitcnt vmcnt(7)
    v_mfma_f32_16x16x32_bf16 v[168:171], v[144:147], v[112:115], v[168:171]
    ds_read_b64_tr_b16 v[160:161], v11 offset:32
    ds_read_b64_tr_b16 v[162:163], v11 offset:4640
    s_waitcnt vmcnt(6)
    v_mfma_f32_16x16x32_bf16 v[172:175], v[144:147], v[116:119], v[172:175]
    s_waitcnt lgkmcnt(6)
    s_waitcnt vmcnt(5)
    v_mfma_f32_16x16x32_bf16 v[168:171], v[148:151], v[120:123], v[168:171]
    ds_read_b64_tr_b16 v[164:165], v11 offset:9248
    ds_read_b64_tr_b16 v[166:167], v11 offset:13856
    s_waitcnt vmcnt(4)
    v_mfma_f32_16x16x32_bf16 v[172:175], v[148:151], v[124:127], v[172:175]
    s_waitcnt lgkmcnt(6)
    s_waitcnt vmcnt(3)
    v_mfma_f32_16x16x32_bf16 v[168:171], v[152:155], v[128:131], v[168:171]
    ds_read_b64_tr_b16 v[144:145], v11 offset:18464
    ds_read_b64_tr_b16 v[146:147], v11 offset:23072
    s_waitcnt vmcnt(2)
    v_mfma_f32_16x16x32_bf16 v[172:175], v[152:155], v[132:135], v[172:175]
    s_waitcnt lgkmcnt(6)
    s_waitcnt vmcnt(1)
    v_mfma_f32_16x16x32_bf16 v[168:171], v[156:159], v[136:139], v[168:171]
    ds_read_b64_tr_b16 v[148:149], v11 offset:27680
    ds_read_b64_tr_b16 v[150:151], v11 offset:32288
    s_waitcnt vmcnt(0)
    v_mfma_f32_16x16x32_bf16 v[172:175], v[156:159], v[140:143], v[172:175]
    s_waitcnt lgkmcnt(6)
    v_mfma_f32_16x16x32_bf16 v[176:179], v[160:163], v[112:115], v[176:179]
    ds_read_b64_tr_b16 v[152:153], v11 offset:64
    ds_read_b64_tr_b16 v[154:155], v11 offset:4672
    v_mfma_f32_16x16x32_bf16 v[180:183], v[160:163], v[116:119], v[180:183]
    s_waitcnt lgkmcnt(6)
    v_mfma_f32_16x16x32_bf16 v[176:179], v[164:167], v[120:123], v[176:179]
    ds_read_b64_tr_b16 v[156:157], v11 offset:9280
    ds_read_b64_tr_b16 v[158:159], v11 offset:13888
    v_mfma_f32_16x16x32_bf16 v[180:183], v[164:167], v[124:127], v[180:183]
    v_cvt_pk_bf16_f32 v16, v168, v169
    v_cvt_pk_bf16_f32 v17, v170, v171
    v_cvt_pk_bf16_f32 v18, v172, v173
    v_cvt_pk_bf16_f32 v19, v174, v175
    buffer_store_dwordx4 v[16:19], v13, s[16:19], 0 offen offset:0 sc1
    s_waitcnt lgkmcnt(6)
    v_mfma_f32_16x16x32_bf16 v[176:179], v[144:147], v[128:131], v[176:179]
    ds_read_b64_tr_b16 v[160:161], v11 offset:18496
    ds_read_b64_tr_b16 v[162:163], v11 offset:23104
    v_mfma_f32_16x16x32_bf16 v[180:183], v[144:147], v[132:135], v[180:183]
    s_waitcnt lgkmcnt(6)
    v_mfma_f32_16x16x32_bf16 v[176:179], v[148:151], v[136:139], v[176:179]
    ds_read_b64_tr_b16 v[164:165], v11 offset:27712
    ds_read_b64_tr_b16 v[166:167], v11 offset:32320
    v_mfma_f32_16x16x32_bf16 v[180:183], v[148:151], v[140:143], v[180:183]
    s_waitcnt lgkmcnt(6)
    v_mfma_f32_16x16x32_bf16 v[184:187], v[152:155], v[112:115], v[184:187]
    ds_read_b64_tr_b16 v[144:145], v11 offset:96
    ds_read_b64_tr_b16 v[146:147], v11 offset:4704
    v_mfma_f32_16x16x32_bf16 v[188:191], v[152:155], v[116:119], v[188:191]
    s_waitcnt lgkmcnt(6)
    v_mfma_f32_16x16x32_bf16 v[184:187], v[156:159], v[120:123], v[184:187]
    ds_read_b64_tr_b16 v[148:149], v11 offset:9312
    ds_read_b64_tr_b16 v[150:151], v11 offset:13920
    v_mfma_f32_16x16x32_bf16 v[188:191], v[156:159], v[124:127], v[188:191]
    v_cvt_pk_bf16_f32 v28, v176, v177
    v_cvt_pk_bf16_f32 v29, v178, v179
    v_cvt_pk_bf16_f32 v30, v180, v181
    v_cvt_pk_bf16_f32 v31, v182, v183
    buffer_store_dwordx4 v[28:31], v13, s[16:19], 0 offen offset:1024 sc1
    s_waitcnt lgkmcnt(6)
    v_mfma_f32_16x16x32_bf16 v[184:187], v[160:163], v[128:131], v[184:187]
    ds_read_b64_tr_b16 v[152:153], v11 offset:18528
    ds_read_b64_tr_b16 v[154:155], v11 offset:23136
    v_mfma_f32_16x16x32_bf16 v[188:191], v[160:163], v[132:135], v[188:191]
    s_waitcnt lgkmcnt(6)
    v_mfma_f32_16x16x32_bf16 v[184:187], v[164:167], v[136:139], v[184:187]
    ds_read_b64_tr_b16 v[156:157], v11 offset:27744
    ds_read_b64_tr_b16 v[158:159], v11 offset:32352
    v_mfma_f32_16x16x32_bf16 v[188:191], v[164:167], v[140:143], v[188:191]
    s_waitcnt lgkmcnt(6)
    v_mfma_f32_16x16x32_bf16 v[192:195], v[144:147], v[112:115], v[192:195]
    ds_read_b64_tr_b16 v[160:161], v11 offset:128
    ds_read_b64_tr_b16 v[162:163], v11 offset:4736
    v_mfma_f32_16x16x32_bf16 v[196:199], v[144:147], v[116:119], v[196:199]
    s_waitcnt lgkmcnt(6)
    v_mfma_f32_16x16x32_bf16 v[192:195], v[148:151], v[120:123], v[192:195]
    ds_read_b64_tr_b16 v[164:165], v11 offset:9344
    ds_read_b64_tr_b16 v[166:167], v11 offset:13952
    v_mfma_f32_16x16x32_bf16 v[196:199], v[148:151], v[124:127], v[196:199]
    v_cvt_pk_bf16_f32 v16, v184, v185
    v_cvt_pk_bf16_f32 v17, v186, v187
    v_cvt_pk_bf16_f32 v18, v188, v189
    v_cvt_pk_bf16_f32 v19, v190, v191
    buffer_store_dwordx4 v[16:19], v13, s[16:19], 0 offen offset:2048 sc1
    s_waitcnt lgkmcnt(6)
    v_mfma_f32_16x16x32_bf16 v[192:195], v[152:155], v[128:131], v[192:195]
    ds_read_b64_tr_b16 v[144:145], v11 offset:18560
    ds_read_b64_tr_b16 v[146:147], v11 offset:23168
    v_mfma_f32_16x16x32_bf16 v[196:199], v[152:155], v[132:135], v[196:199]
    s_waitcnt lgkmcnt(6)
    v_mfma_f32_16x16x32_bf16 v[192:195], v[156:159], v[136:139], v[192:195]
    ds_read_b64_tr_b16 v[148:149], v11 offset:27776
    ds_read_b64_tr_b16 v[150:151], v11 offset:32384
    v_mfma_f32_16x16x32_bf16 v[196:199], v[156:159], v[140:143], v[196:199]
    s_waitcnt lgkmcnt(6)
    v_mfma_f32_16x16x32_bf16 v[200:203], v[160:163], v[112:115], v[200:203]
    ds_read_b64_tr_b16 v[152:153], v11 offset:160
    ds_read_b64_tr_b16 v[154:155], v11 offset:4768
    v_mfma_f32_16x16x32_bf16 v[204:207], v[160:163], v[116:119], v[204:207]
    s_waitcnt lgkmcnt(6)
    v_mfma_f32_16x16x32_bf16 v[200:203], v[164:167], v[120:123], v[200:203]
    ds_read_b64_tr_b16 v[156:157], v11 offset:9376
    ds_read_b64_tr_b16 v[158:159], v11 offset:13984
    v_mfma_f32_16x16x32_bf16 v[204:207], v[164:167], v[124:127], v[204:207]
    v_cvt_pk_bf16_f32 v28, v192, v193
    v_cvt_pk_bf16_f32 v29, v194, v195
    v_cvt_pk_bf16_f32 v30, v196, v197
    v_cvt_pk_bf16_f32 v31, v198, v199
    buffer_store_dwordx4 v[28:31], v13, s[16:19], 0 offen offset:3072 sc1
    s_waitcnt lgkmcnt(6)
    v_mfma_f32_16x16x32_bf16 v[200:203], v[144:147], v[128:131], v[200:203]
    ds_read_b64_tr_b16 v[160:161], v11 offset:18592
    ds_read_b64_tr_b16 v[162:163], v11 offset:23200
    v_mfma_f32_16x16x32_bf16 v[204:207], v[144:147], v[132:135], v[204:207]
    s_waitcnt lgkmcnt(6)
    v_mfma_f32_16x16x32_bf16 v[200:203], v[148:151], v[136:139], v[200:203]
    ds_read_b64_tr_b16 v[164:165], v11 offset:27808
    ds_read_b64_tr_b16 v[166:167], v11 offset:32416
    v_mfma_f32_16x16x32_bf16 v[204:207], v[148:151], v[140:143], v[204:207]
    s_waitcnt lgkmcnt(6)
    v_mfma_f32_16x16x32_bf16 v[208:211], v[152:155], v[112:115], v[208:211]
    ds_read_b64_tr_b16 v[144:145], v11 offset:192
    ds_read_b64_tr_b16 v[146:147], v11 offset:4800
    v_mfma_f32_16x16x32_bf16 v[212:215], v[152:155], v[116:119], v[212:215]
    s_waitcnt lgkmcnt(6)
    v_mfma_f32_16x16x32_bf16 v[208:211], v[156:159], v[120:123], v[208:211]
    ds_read_b64_tr_b16 v[148:149], v11 offset:9408
    ds_read_b64_tr_b16 v[150:151], v11 offset:14016
    v_mfma_f32_16x16x32_bf16 v[212:215], v[156:159], v[124:127], v[212:215]
    v_cvt_pk_bf16_f32 v16, v200, v201
    v_cvt_pk_bf16_f32 v17, v202, v203
    v_cvt_pk_bf16_f32 v18, v204, v205
    v_cvt_pk_bf16_f32 v19, v206, v207
    s_mov_b32 s35, 4096
    buffer_store_dwordx4 v[16:19], v13, s[16:19], s35 offen offset:0 sc1
    s_waitcnt lgkmcnt(6)
    v_mfma_f32_16x16x32_bf16 v[208:211], v[160:163], v[128:131], v[208:211]
    ds_read_b64_tr_b16 v[152:153], v11 offset:18624
    ds_read_b64_tr_b16 v[154:155], v11 offset:23232
    v_mfma_f32_16x16x32_bf16 v[212:215], v[160:163], v[132:135], v[212:215]
    s_waitcnt lgkmcnt(6)
    v_mfma_f32_16x16x32_bf16 v[208:211], v[164:167], v[136:139], v[208:211]
    ds_read_b64_tr_b16 v[156:157], v11 offset:27840
    ds_read_b64_tr_b16 v[158:159], v11 offset:32448
    v_mfma_f32_16x16x32_bf16 v[212:215], v[164:167], v[140:143], v[212:215]
    s_waitcnt lgkmcnt(6)
    v_mfma_f32_16x16x32_bf16 v[216:219], v[144:147], v[112:115], v[216:219]
    ds_read_b64_tr_b16 v[160:161], v11 offset:224
    ds_read_b64_tr_b16 v[162:163], v11 offset:4832
    v_mfma_f32_16x16x32_bf16 v[220:223], v[144:147], v[116:119], v[220:223]
    s_waitcnt lgkmcnt(6)
    v_mfma_f32_16x16x32_bf16 v[216:219], v[148:151], v[120:123], v[216:219]
    ds_read_b64_tr_b16 v[164:165], v11 offset:9440
    ds_read_b64_tr_b16 v[166:167], v11 offset:14048
    v_mfma_f32_16x16x32_bf16 v[220:223], v[148:151], v[124:127], v[220:223]
    v_cvt_pk_bf16_f32 v28, v208, v209
    v_cvt_pk_bf16_f32 v29, v210, v211
    v_cvt_pk_bf16_f32 v30, v212, v213
    v_cvt_pk_bf16_f32 v31, v214, v215
    s_mov_b32 s35, 4096
    buffer_store_dwordx4 v[28:31], v13, s[16:19], s35 offen offset:1024 sc1
    s_waitcnt lgkmcnt(6)
    v_mfma_f32_16x16x32_bf16 v[216:219], v[152:155], v[128:131], v[216:219]
    ds_read_b64_tr_b16 v[144:145], v11 offset:18656
    ds_read_b64_tr_b16 v[146:147], v11 offset:23264
    v_mfma_f32_16x16x32_bf16 v[220:223], v[152:155], v[132:135], v[220:223]
    s_waitcnt lgkmcnt(6)
    v_mfma_f32_16x16x32_bf16 v[216:219], v[156:159], v[136:139], v[216:219]
    ds_read_b64_tr_b16 v[148:149], v11 offset:27872
    ds_read_b64_tr_b16 v[150:151], v11 offset:32480
    v_mfma_f32_16x16x32_bf16 v[220:223], v[156:159], v[140:143], v[220:223]
    s_waitcnt lgkmcnt(6)
    v_mfma_f32_16x16x32_bf16 a[0:3], v[160:163], v[112:115], a[0:3]
    ds_read_b64_tr_b16 v[152:153], v11 offset:256
    ds_read_b64_tr_b16 v[154:155], v11 offset:4864
    v_mfma_f32_16x16x32_bf16 a[4:7], v[160:163], v[116:119], a[4:7]
    s_waitcnt lgkmcnt(6)
    v_mfma_f32_16x16x32_bf16 a[0:3], v[164:167], v[120:123], a[0:3]
    ds_read_b64_tr_b16 v[156:157], v11 offset:9472
    ds_read_b64_tr_b16 v[158:159], v11 offset:14080
    v_mfma_f32_16x16x32_bf16 a[4:7], v[164:167], v[124:127], a[4:7]
    v_cvt_pk_bf16_f32 v16, v216, v217
    v_cvt_pk_bf16_f32 v17, v218, v219
    v_cvt_pk_bf16_f32 v18, v220, v221
    v_cvt_pk_bf16_f32 v19, v222, v223
    s_mov_b32 s35, 4096
    buffer_store_dwordx4 v[16:19], v13, s[16:19], s35 offen offset:2048 sc1
    s_waitcnt lgkmcnt(6)
    v_mfma_f32_16x16x32_bf16 a[0:3], v[144:147], v[128:131], a[0:3]
    ds_read_b64_tr_b16 v[160:161], v11 offset:18688
    ds_read_b64_tr_b16 v[162:163], v11 offset:23296
    v_mfma_f32_16x16x32_bf16 a[4:7], v[144:147], v[132:135], a[4:7]
    s_waitcnt lgkmcnt(6)
    v_mfma_f32_16x16x32_bf16 a[0:3], v[148:151], v[136:139], a[0:3]
    ds_read_b64_tr_b16 v[164:165], v11 offset:27904
    ds_read_b64_tr_b16 v[166:167], v11 offset:32512
    v_mfma_f32_16x16x32_bf16 a[4:7], v[148:151], v[140:143], a[4:7]
    s_waitcnt lgkmcnt(6)
    v_mfma_f32_16x16x32_bf16 a[8:11], v[152:155], v[112:115], a[8:11]
    v_mfma_f32_16x16x32_bf16 a[12:15], v[152:155], v[116:119], a[12:15]
    s_waitcnt lgkmcnt(4)
    v_mfma_f32_16x16x32_bf16 a[8:11], v[156:159], v[120:123], a[8:11]
    v_mfma_f32_16x16x32_bf16 a[12:15], v[156:159], v[124:127], a[12:15]
    v_accvgpr_read_b32 v32, a0
    v_accvgpr_read_b32 v33, a1
    v_accvgpr_read_b32 v34, a2
    v_accvgpr_read_b32 v35, a3
    v_accvgpr_read_b32 v36, a4
    v_accvgpr_read_b32 v37, a5
    v_accvgpr_read_b32 v38, a6
    v_accvgpr_read_b32 v39, a7
    v_cvt_pk_bf16_f32 v28, v32, v33
    v_cvt_pk_bf16_f32 v29, v34, v35
    v_cvt_pk_bf16_f32 v30, v36, v37
    v_cvt_pk_bf16_f32 v31, v38, v39
    s_mov_b32 s35, 4096
    buffer_store_dwordx4 v[28:31], v13, s[16:19], s35 offen offset:3072 sc1
    s_waitcnt lgkmcnt(2)
    v_mfma_f32_16x16x32_bf16 a[8:11], v[160:163], v[128:131], a[8:11]
    v_mfma_f32_16x16x32_bf16 a[12:15], v[160:163], v[132:135], a[12:15]
    s_waitcnt lgkmcnt(0)
    v_mfma_f32_16x16x32_bf16 a[8:11], v[164:167], v[136:139], a[8:11]
    v_mfma_f32_16x16x32_bf16 a[12:15], v[164:167], v[140:143], a[12:15]
    s_nop 6
    v_accvgpr_read_b32 v20, a8
    v_accvgpr_read_b32 v21, a9
    v_accvgpr_read_b32 v22, a10
    v_accvgpr_read_b32 v23, a11
    v_accvgpr_read_b32 v24, a12
    v_accvgpr_read_b32 v25, a13
    v_accvgpr_read_b32 v26, a14
    v_accvgpr_read_b32 v27, a15
    v_cvt_pk_bf16_f32 v16, v20, v21
    v_cvt_pk_bf16_f32 v17, v22, v23
    v_cvt_pk_bf16_f32 v18, v24, v25
    v_cvt_pk_bf16_f32 v19, v26, v27
    s_mov_b32 s35, 8192
    buffer_store_dwordx4 v[16:19], v13, s[16:19], s35 offen offset:0 sc1
    s_waitcnt vmcnt(0)
    s_and_b32 s6, s4, 3
    s_lshl_b32 s30, s3, 2
    s_add_u32 s30, s30, s6
    s_mul_i32 s30, s30, 294912
    s_add_u32 s30, s30, 8388608
    s_add_u32 s16, s54, s30
    s_addc_u32 s17, s55, 0
    s_mov_b32 s18, 294912
    s_mov_b32 s19, 0x20000
    s_mul_i32 s30, s3, 147456
    s_add_u32 s24, s50, s30
    s_addc_u32 s25, s51, 0
    s_mov_b32 s26, 147456
    s_mov_b32 s27, 0x20000
    s_mov_b32 s57, s38
    s_barrier
    s_cmp_lg_u32 s5, 0
    s_cbranch_scc1 L_nopub2
    s_lshl_b32 s29, s39, 7
    s_add_u32 s29, s29, 32768
    v_mov_b32 v3, s58
    buffer_store_dword v3, off, s[20:23], s29 sc1
    s_lshl_b32 s29, s3, 5
    s_add_u32 s29, s29, s6
    v_and_b32 v4, 7, v1
    v_lshlrev_b32 v4, 2, v4
    v_add_u32 v4, s29, v4
    v_lshlrev_b32 v4, 7, v4
    v_add_u32 v4, 32768, v4
    s_mov_b32 s32, 200000
    buffer_load_dword v120, v4, s[20:23], 0 offen sc1
    s_sleep 4
    buffer_load_dword v121, v4, s[20:23], 0 offen sc1
    s_sleep 4
    buffer_load_dword v122, v4, s[20:23], 0 offen sc1
    s_sleep 4
    buffer_load_dword v123, v4, s[20:23], 0 offen sc1
L_poll_f2:
    s_waitcnt vmcnt(3)
    v_cmp_ne_u32 vcc, s58, v120
    s_nop 1
    s_cbranch_vccz L_polld_f2
    buffer_load_dword v120, v4, s[20:23], 0 offen sc1
    s_waitcnt vmcnt(3)
    v_cmp_ne_u32 vcc, s58, v121
    s_nop 1
    s_cbranch_vccz L_polld_f2
    buffer_load_dword v121, v4, s[20:23], 0 offen sc1
    s_waitcnt vmcnt(3)
    v_cmp_ne_u32 vcc, s58, v122
    s_nop 1
    s_cbranch_vccz L_polld_f2
    buffer_load_dword v122, v4, s[20:23], 0 offen sc1
    s_waitcnt vmcnt(3)
    v_cmp_ne_u32 vcc, s58, v123
    s_nop 1
    s_cbranch_vccz L_polld_f2
    buffer_load_dword v123, v4, s[20:23], 0 offen sc1
    s_sub_u32 s32, s32, 1
    s_cmp_lg_u32 s32, 0
    s_cbranch_scc1 L_poll_f2
L_polld_f2:
L_nopub2:
    s_nop 1
    s_barrier
L_R:
    s_nop 1
    s_lshr_b32 s29, s4, 2
    s_mul_i32 s29, s29, 288
    s_mul_i32 s30, s57, 36
    s_add_u32 s29, s29, s30
    v_add_u32 v2, s29, v1
    v_lshlrev_b32 v8, 4, v2
    s_mov_b32 exec_lo, -1
    s_mov_b32 exec_hi, 15
    s_mov_b32 s35, 0
    buffer_load_dwordx4 v[16:19], v8, s[16:19], s35 offen sc1
    s_mov_b32 s35, 36864
    buffer_load_dwordx4 v[20:23], v8, s[16:19], s35 offen sc1
    s_mov_b32 s35, 73728
    buffer_load_dwordx4 v[24:27], v8, s[16:19], s35 offen sc1
    s_mov_b32 s35, 110592
    buffer_load_dwordx4 v[28:31], v8, s[16:19], s35 offen sc1
    s_mov_b32 s35, 147456
    buffer_load_dwordx4 v[32:35], v8, s[16:19], s35 offen sc1
    s_mov_b32 s35, 184320
    buffer_load_dwordx4 v[36:39], v8, s[16:19], s35 offen sc1
    s_mov_b32 s35, 221184
    buffer_load_dwordx4 v[40:43], v8, s[16:19], s35 offen sc1
    s_mov_b32 s35, 258048
    buffer_load_dwordx4 v[44:47], v8, s[16:19], s35 offen sc1
    v_lshrrev_b32 v3, 6, v2
    v_mul_u32_u24 v4, 7282, v3
    v_lshrrev_b32 v4, 16, v4
    v_mul_u32_u24 v5, 9, v4
    v_sub_u32 v5, v3, v5
    v_and_b32 v6, 15, v2
    v_bfe_u32 v7, v2, 4, 2
    v_lshl_add_u32 v6, v4, 5, v6
    v_mul_u32_u24 v6, 1152, v6
    v_lshl_add_u32 v6, v5, 5, v6
    v_lshl_add_u32 v11, v7, 3, v6
    s_and_b32 s39, s4, 3
    s_mul_i32 s39, s39, 288
    s_add_u32 s36, s39, 18432
    v_mov_b32 v9, 0x3f80
    v_mov_b32 v10, 0x3f800000
    s_waitcnt vmcnt(7)
    v_lshlrev_b32 v48, 16, v16
    v_and_b32 v49, 0xffff0000, v16
    v_lshlrev_b32 v50, 16, v17
    v_and_b32 v51, 0xffff0000, v17
    v_lshlrev_b32 v52, 16, v18
    v_and_b32 v53, 0xffff0000, v18
    v_lshlrev_b32 v54, 16, v19
    v_and_b32 v55, 0xffff0000, v19
    s_waitcnt vmcnt(6)
    v_dot2_f32_bf16 v48, v20, v9, v48
    v_dot2_f32_bf16 v49, v20, v10, v49
    v_dot2_f32_bf16 v50, v21, v9, v50
    v_dot2_f32_bf16 v51, v21, v10, v51
    v_dot2_f32_bf16 v52, v22, v9, v52
    v_dot2_f32_bf16 v53, v22, v10, v53
    v_dot2_f32_bf16 v54, v23, v9, v54
    v_dot2_f32_bf16 v55, v23, v10, v55
    s_waitcnt vmcnt(5)
    v_dot2_f32_bf16 v48, v24, v9, v48
    v_dot2_f32_bf16 v49, v24, v10, v49
    v_dot2_f32_bf16 v50, v25, v9, v50
    v_dot2_f32_bf16 v51, v25, v10, v51
    v_dot2_f32_bf16 v52, v26, v9, v52
    v_dot2_f32_bf16 v53, v26, v10, v53
    v_dot2_f32_bf16 v54, v27, v9, v54
    v_dot2_f32_bf16 v55, v27, v10, v55
    s_waitcnt vmcnt(4)
    v_dot2_f32_bf16 v48, v28, v9, v48
    v_dot2_f32_bf16 v49, v28, v10, v49
    v_dot2_f32_bf16 v50, v29, v9, v50
    v_dot2_f32_bf16 v51, v29, v10, v51
    v_dot2_f32_bf16 v52, v30, v9, v52
    v_dot2_f32_bf16 v53, v30, v10, v53
    v_dot2_f32_bf16 v54, v31, v9, v54
    v_dot2_f32_bf16 v55, v31, v10, v55
    s_waitcnt vmcnt(3)
    v_dot2_f32_bf16 v48, v32, v9, v48
    v_dot2_f32_bf16 v49, v32, v10, v49
    v_dot2_f32_bf16 v50, v33, v9, v50
    v_dot2_f32_bf16 v51, v33, v10, v51
    v_dot2_f32_bf16 v52, v34, v9, v52
    v_dot2_f32_bf16 v53, v34, v10, v53
    v_dot2_f32_bf16 v54, v35, v9, v54
    v_dot2_f32_bf16 v55, v35, v10, v55
    s_waitcnt vmcnt(2)
    v_dot2_f32_bf16 v48, v36, v9, v48
    v_dot2_f32_bf16 v49, v36, v10, v49
    v_dot2_f32_bf16 v50, v37, v9, v50
    v_dot2_f32_bf16 v51, v37, v10, v51
    v_dot2_f32_bf16 v52, v38, v9, v52
    v_dot2_f32_bf16 v53, v38, v10, v53
    v_dot2_f32_bf16 v54, v39, v9, v54
    v_dot2_f32_bf16 v55, v39, v10, v55
    s_waitcnt vmcnt(1)
    v_dot2_f32_bf16 v48, v40, v9, v48
    v_dot2_f32_bf16 v49, v40, v10, v49
    v_dot2_f32_bf16 v50, v41, v9, v50
    v_dot2_f32_bf16 v51, v41, v10, v51
    v_dot2_f32_bf16 v52, v42, v9, v52
    v_dot2_f32_bf16 v53, v42, v10, v53
    v_dot2_f32_bf16 v54, v43, v9, v54
    v_dot2_f32_bf16 v55, v43, v10, v55
    s_waitcnt vmcnt(0)
    v_dot2_f32_bf16 v48, v44, v9, v48
    v_dot2_f32_bf16 v49, v44, v10, v49
    v_dot2_f32_bf16 v50, v45, v9, v50
    v_dot2_f32_bf16 v51, v45, v10, v51
    v_dot2_f32_bf16 v52, v46, v9, v52
    v_dot2_f32_bf16 v53, v46, v10, v53
    v_dot2_f32_bf16 v54, v47, v9, v54
    v_dot2_f32_bf16 v55, v47, v10, v55
    v_cvt_pk_bf16_f32 v56, v48, v49
    v_cvt_pk_bf16_f32 v57, v50, v51
    v_cvt_pk_bf16_f32 v58, v52, v53
    v_cvt_pk_bf16_f32 v59, v54, v55
    buffer_store_dwordx2 v[56:57], v11, s[24:27], s39 offen
    buffer_store_dwordx2 v[58:59], v11, s[24:27], s36 offen
    s_mov_b32 exec_hi, -1
    s_endpgm
L_loader:
    s_nop 3
    s_lshr_b32 s29, s3, 2
    s_cmp_eq_u32 s29, 1
    s_cbranch_scc1 L_var1
    v_lshrrev_b32 v2, 3, v1
    s_lshl_b32 s29, s5, 5
    v_add_u32 v2, s29, v2
    v_mul_u32_u24 v2, 1152, v2
    v_lshrrev_b32 v3, 4, v1
    v_and_b32 v4, 7, v1
    v_xor_b32 v5, v3, v4
    v_lshl_add_u32 v8, v5, 4, v2
    v_xor_b32 v5, 4, v5
    v_lshl_add_u32 v5, v5, 4, v2
    v_add_u32 v9, 8192, v5
    v_add_u32 v10, 16384, v8
    v_add_u32 v11, 24576, v5
    s_lshl_b32 s29, s5, 4
    v_add_u32 v2, s29, v3
    v_and_b32 v4, 15, v1
    v_lshlrev_b32 v5, 2, v3
    v_xor_b32 v5, v5, v4
    v_lshlrev_b32 v5, 4, v5
    v_lshl_add_u32 v12, v2, 13, v5
    v_add_u32 v13, 31744, v12
    v_add_u32 v14, 63488, v12
    v_add_u32 v15, 95232, v12
    v_lshlrev_b32 v6, 8, v2
    v_add_u32 v20, v6, v5
    v_xor_b32 v5, v3, v4
    v_lshl_add_u32 v16, v5, 4, v6
    v_xor_b32 v7, 4, v5
    v_lshl_add_u32 v17, v7, 4, v6
    v_xor_b32 v7, 8, v5
    v_lshl_add_u32 v18, v7, 4, v6
    v_xor_b32 v7, 12, v5
    v_lshl_add_u32 v19, v7, 4, v6
    v_lshlrev_b32 v21, 4, v1
    v_add_u32 v21, s33, v21
    s_waitcnt lgkmcnt(0)
    s_mul_i32 s29, s3, 147456
    s_add_u32 s8, s40, s29
    s_addc_u32 s9, s41, 0
    s_mov_b32 s10, 147456
    s_mov_b32 s11, 0x20000
    s_lshl_b32 s29, s4, 8
    s_add_u32 s12, s46, s29
    s_addc_u32 s13, s47, 0
    s_sub_u32 s14, 4718592, s29
    s_mov_b32 s15, 0x20000
    s_lshl_b32 s29, s3, 5
    s_add_u32 s29, s29, s4
    s_lshl_b32 s30, s29, 17
    s_add_u32 s16, s42, s30
    s_addc_u32 s17, s43, 0
    s_mov_b32 s18, 131072
    s_mov_b32 s19, 0x20000
    s_add_u32 s20, s44, s30
    s_addc_u32 s21, s45, 0
    s_mov_b32 s22, 131072
    s_mov_b32 s23, 0x20000
    s_lshl_b32 s30, s29, 15
    s_add_u32 s24, s54, s30
    s_addc_u32 s25, s55, 0
    s_mov_b32 s26, 32768
    s_mov_b32 s27, 0x20000
    buffer_load_dword v24, off, s[16:19], 0 nt
    buffer_load_dword v25, off, s[20:23], 0 nt
    v_lshlrev_b32 v30, 21, v1
    buffer_load_dword v26, off, s[8:11], 0
    buffer_load_dword v27, v30, s[12:15], 0 offen
    s_mov_b32 s35, 0
    buffer_load_dwordx4 v[32:35], v16, s[16:19], s35 offen offset:0 nt
    buffer_load_dwordx4 v[36:39], v17, s[16:19], s35 offen offset:1024 nt
    buffer_load_dwordx4 v[40:43], v18, s[16:19], s35 offen offset:2048 nt
    buffer_load_dwordx4 v[44:47], v19, s[16:19], s35 offen offset:3072 nt
    s_mov_b32 s35, 16384
    buffer_load_dwordx4 v[48:51], v16, s[16:19], s35 offen offset:0 nt
    buffer_load_dwordx4 v[52:55], v17, s[16:19], s35 offen offset:1024 nt
    buffer_load_dwordx4 v[56:59], v18, s[16:19], s35 offen offset:2048 nt
    buffer_load_dwordx4 v[60:63], v19, s[16:19], s35 offen offset:3072 nt
    s_mov_b32 s35, 0
    buffer_load_dwordx4 v[64:67], v20, s[20:23], s35 offen offset:0 nt
    buffer_load_dwordx4 v[68:71], v20, s[20:23], s35 offen offset:1024 nt
    buffer_load_dwordx4 v[72:75], v20, s[20:23], s35 offen offset:2048 nt
    buffer_load_dwordx4 v[76:79], v20, s[20:23], s35 offen offset:3072 nt
    s_mov_b32 s35, 32768
    buffer_load_dwordx4 v[80:83], v16, s[16:19], s35 offen offset:0 nt
    buffer_load_dwordx4 v[84:87], v17, s[16:19], s35 offen offset:1024 nt
    buffer_load_dwordx4 v[88:91], v18, s[16:19], s35 offen offset:2048 nt
    buffer_load_dwordx4 v[92:95], v19, s[16:19], s35 offen offset:3072 nt
    s_mov_b32 s35, 16384
    buffer_load_dwordx4 v[96:99], v20, s[20:23], s35 offen offset:0 nt
    buffer_load_dwordx4 v[100:103], v20, s[20:23], s35 offen offset:1024 nt
    buffer_load_dwordx4 v[104:107], v20, s[20:23], s35 offen offset:2048 nt
    buffer_load_dwordx4 v[108:111], v20, s[20:23], s35 offen offset:3072 nt
    s_mov_b32 s35, 49152
    buffer_load_dwordx4 v[112:115], v16, s[16:19], s35 offen offset:0 nt
    buffer_load_dwordx4 v[116:119], v17, s[16:19], s35 offen offset:1024 nt
    buffer_load_dwordx4 v[120:123], v18, s[16:19], s35 offen offset:2048 nt
    buffer_load_dwordx4 v[124:127], v19, s[16:19], s35 offen offset:3072 nt
    s_mov_b32 s35, 32768
    buffer_load_dwordx4 v[128:131], v20, s[20:23], s35 offen offset:0 nt
    buffer_load_dwordx4 v[132:135], v20, s[20:23], s35 offen offset:1024 nt
    buffer_load_dwordx4 v[136:139], v20, s[20:23], s35 offen offset:2048 nt
    buffer_load_dwordx4 v[140:143], v20, s[20:23], s35 offen offset:3072 nt
    s_add_u32 s29, s28, 0
    s_cmp_ge_u32 s29, 9
    s_cselect_b32 s30, 9, 0
    s_sub_u32 s29, s29, s30
    s_lshl_b32 s35, s29, 7
    s_add_u32 m0, s33, 0
    s_nop 0
    buffer_load_dwordx4 v8, s[8:11], s35 offen offset:0  lds
    buffer_load_dwordx4 v9, s[8:11], s35 offen offset:1024  lds
    buffer_load_dwordx4 v10, s[8:11], s35 offen offset:2048  lds
    buffer_load_dwordx4 v11, s[8:11], s35 offen offset:3072  lds
    s_add_u32 s29, s28, 0
    s_cmp_ge_u32 s29, 9
    s_cselect_b32 s30, 9, 0
    s_sub_u32 s29, s29, s30
    s_lshl_b32 s35, s29, 19
    s_add_u32 m0, s33, 16384
    s_nop 0
    buffer_load_dwordx4 v12, s[12:15], s35 offen offset:0  lds
    buffer_load_dwordx4 v13, s[12:15], s35 offen offset:1024  lds
    buffer_load_dwordx4 v14, s[12:15], s35 offen offset:2048  lds
    buffer_load_dwordx4 v15, s[12:15], s35 offen offset:3072  lds
    s_add_u32 s29, s28, 1
    s_cmp_ge_u32 s29, 9
    s_cselect_b32 s30, 9, 0
    s_sub_u32 s29, s29, s30
    s_lshl_b32 s35, s29, 7
    s_add_u32 m0, s33, 32768
    s_nop 0
    buffer_load_dwordx4 v8, s[8:11], s35 offen offset:0  lds
    buffer_load_dwordx4 v9, s[8:11], s35 offen offset:1024  lds
    buffer_load_dwordx4 v10, s[8:11], s35 offen offset:2048  lds
    buffer_load_dwordx4 v11, s[8:11], s35 offen offset:3072  lds
    s_add_u32 s29, s28, 1
    s_cmp_ge_u32 s29, 9
    s_cselect_b32 s30, 9, 0
    s_sub_u32 s29, s29, s30
    s_lshl_b32 s35, s29, 19
    s_add_u32 m0, s33, 49152
    s_nop 0
    buffer_load_dwordx4 v12, s[12:15], s35 offen offset:0  lds
    buffer_load_dwordx4 v13, s[12:15], s35 offen offset:1024  lds
    buffer_load_dwordx4 v14, s[12:15], s35 offen offset:2048  lds
    buffer_load_dwordx4 v15, s[12:15], s35 offen offset:3072  lds
    s_waitcnt vmcnt(8)
    s_barrier
    s_add_u32 s29, s28, 2
    s_cmp_ge_u32 s29, 9
    s_cselect_b32 s30, 9, 0
    s_sub_u32 s29, s29, s30
    s_lshl_b32 s35, s29, 7
    s_add_u32 m0, s33, 65536
    s_nop 0
    buffer_load_dwordx4 v8, s[8:11], s35 offen offset:0  lds
    buffer_load_dwordx4 v9, s[8:11], s35 offen offset:1024  lds
    buffer_load_dwordx4 v10, s[8:11], s35 offen offset:2048  lds
    buffer_load_dwordx4 v11, s[8:11], s35 offen offset:3072  lds
    s_add_u32 s29, s28, 2
    s_cmp_ge_u32 s29, 9
    s_cselect_b32 s30, 9, 0
    s_sub_u32 s29, s29, s30
    s_lshl_b32 s35, s29, 19
    s_add_u32 m0, s33, 81920
    s_nop 0
    buffer_load_dwordx4 v12, s[12:15], s35 offen offset:0  lds
    buffer_load_dwordx4 v13, s[12:15], s35 offen offset:1024  lds
    buffer_load_dwordx4 v14, s[12:15], s35 offen offset:2048  lds
    buffer_load_dwordx4 v15, s[12:15], s35 offen offset:3072  lds
    s_waitcnt vmcnt(8)
    s_barrier
    s_add_u32 s29, s28, 3
    s_cmp_ge_u32 s29, 9
    s_cselect_b32 s30, 9, 0
    s_sub_u32 s29, s29, s30
    s_lshl_b32 s35, s29, 7
    s_add_u32 m0, s33, 98304
    s_nop 0
    buffer_load_dwordx4 v8, s[8:11], s35 offen offset:0  lds
    buffer_load_dwordx4 v9, s[8:11], s35 offen offset:1024  lds
    buffer_load_dwordx4 v10, s[8:11], s35 offen offset:2048  lds
    buffer_load_dwordx4 v11, s[8:11], s35 offen offset:3072  lds
    s_add_u32 s29, s28, 3
    s_cmp_ge_u32 s29, 9
    s_cselect_b32 s30, 9, 0
    s_sub_u32 s29, s29, s30
    s_lshl_b32 s35, s29, 19
    s_add_u32 m0, s33, 114688
    s_nop 0
    buffer_load_dwordx4 v12, s[12:15], s35 offen offset:0  lds
    buffer_load_dwordx4 v13, s[12:15], s35 offen offset:1024  lds
    buffer_load_dwordx4 v14, s[12:15], s35 offen offset:2048  lds
    buffer_load_dwordx4 v15, s[12:15], s35 offen offset:3072  lds
    s_waitcnt vmcnt(8)
    s_barrier
    s_add_u32 s29, s28, 4
    s_cmp_ge_u32 s29, 9
    s_cselect_b32 s30, 9, 0
    s_sub_u32 s29, s29, s30
    s_lshl_b32 s35, s29, 7
    s_add_u32 m0, s33, 131072
    s_nop 0
    buffer_load_dwordx4 v8, s[8:11], s35 offen offset:0  lds
    buffer_load_dwordx4 v9, s[8:11], s35 offen offset:1024  lds
    buffer_load_dwordx4 v10, s[8:11], s35 offen offset:2048  lds
    buffer_load_dwordx4 v11, s[8:11], s35 offen offset:3072  lds
    s_add_u32 s29, s28, 4
    s_cmp_ge_u32 s29, 9
    s_cselect_b32 s30, 9, 0
    s_sub_u32 s29, s29, s30
    s_lshl_b32 s35, s29, 19
    s_add_u32 m0, s33, 147456
    s_nop 0
    buffer_load_dwordx4 v12, s[12:15], s35 offen offset:0  lds
    buffer_load_dwordx4 v13, s[12:15], s35 offen offset:1024  lds
    buffer_load_dwordx4 v14, s[12:15], s35 offen offset:2048  lds
    buffer_load_dwordx4 v15, s[12:15], s35 offen offset:3072  lds
    s_waitcnt vmcnt(8)
    s_barrier
    s_add_u32 s29, s28, 5
    s_cmp_ge_u32 s29, 9
    s_cselect_b32 s30, 9, 0
    s_sub_u32 s29, s29, s30
    s_lshl_b32 s35, s29, 7
    s_add_u32 m0, s33, 0
    s_nop 0
    buffer_load_dwordx4 v8, s[8:11], s35 offen offset:0  lds
    buffer_load_dwordx4 v9, s[8:11], s35 offen offset:1024  lds
    buffer_load_dwordx4 v10, s[8:11], s35 offen offset:2048  lds
    buffer_load_dwordx4 v11, s[8:11], s35 offen offset:3072  lds
    s_add_u32 s29, s28, 5
    s_cmp_ge_u32 s29, 9
    s_cselect_b32 s30, 9, 0
    s_sub_u32 s29, s29, s30
    s_lshl_b32 s35, s29, 19
    s_add_u32 m0, s33, 16384
    s_nop 0
    buffer_load_dwordx4 v12, s[12:15], s35 offen offset:0  lds
    buffer_load_dwordx4 v13, s[12:15], s35 offen offset:1024  lds
    buffer_load_dwordx4 v14, s[12:15], s35 offen offset:2048  lds
    buffer_load_dwordx4 v15, s[12:15], s35 offen offset:3072  lds
    v_add_u32 v2, 0, v1
    v_mul_u32_u24 v3, 3641, v2
    v_lshrrev_b32 v3, 16, v3
    v_mul_u32_u24 v4, 18, v3
    v_sub_u32 v4, v2, v4
    v_mul_u32_u24 v3, 1152, v3
    v_lshl_add_u32 v22, v4, 4, v3
    v_add_u32 v2, 64, v1
    v_mul_u32_u24 v3, 3641, v2
    v_lshrrev_b32 v3, 16, v3
    v_mul_u32_u24 v4, 18, v3
    v_sub_u32 v4, v2, v4
    v_mul_u32_u24 v3, 1152, v3
    v_lshl_add_u32 v23, v4, 4, v3
    v_add_u32 v2, 128, v1
    v_mul_u32_u24 v3, 3641, v2
    v_lshrrev_b32 v3, 16, v3
    v_mul_u32_u24 v4, 18, v3
    v_sub_u32 v4, v2, v4
    v_mul_u32_u24 v3, 1152, v3
    v_lshl_add_u32 v24, v4, 4, v3
    v_add_u32 v2, 192, v1
    v_mul_u32_u24 v3, 3641, v2
    v_lshrrev_b32 v3, 16, v3
    v_mul_u32_u24 v4, 18, v3
    v_sub_u32 v4, v2, v4
    v_mul_u32_u24 v3, 1152, v3
    v_lshl_add_u32 v25, v4, 4, v3
    v_add_u32 v2, 256, v1
    v_mul_u32_u24 v3, 3641, v2
    v_lshrrev_b32 v3, 16, v3
    v_mul_u32_u24 v4, 18, v3
    v_sub_u32 v4, v2, v4
    v_mul_u32_u24 v3, 1152, v3
    v_lshl_add_u32 v26, v4, 4, v3
    v_add_u32 v2, 320, v1
    v_mul_u32_u24 v3, 3641, v2
    v_lshrrev_b32 v3, 16, v3
    v_mul_u32_u24 v4, 18, v3
    v_sub_u32 v4, v2, v4
    v_mul_u32_u24 v3, 1152, v3
    v_lshl_add_u32 v27, v4, 4, v3
    v_add_u32 v2, 384, v1
    v_mul_u32_u24 v3, 3641, v2
    v_lshrrev_b32 v3, 16, v3
    v_mul_u32_u24 v4, 18, v3
    v_sub_u32 v4, v2, v4
    v_mul_u32_u24 v3, 1152, v3
    v_lshl_add_u32 v28, v4, 4, v3
    v_add_u32 v2, 448, v1
    v_mul_u32_u24 v3, 3641, v2
    v_lshrrev_b32 v3, 16, v3
    v_mul_u32_u24 v4, 18, v3
    v_sub_u32 v4, v2, v4
    v_mul_u32_u24 v3, 1152, v3
    v_lshl_add_u32 v29, v4, 4, v3
    v_add_u32 v2, 512, v1
    v_mul_u32_u24 v3, 3641, v2
    v_lshrrev_b32 v3, 16, v3
    v_mul_u32_u24 v4, 18, v3
    v_sub_u32 v4, v2, v4
    v_mul_u32_u24 v3, 1152, v3
    v_lshl_add_u32 v30, v4, 4, v3
    s_mul_i32 s29, s5, 36864
    v_add_u32 v22, s29, v22
    v_add_u32 v23, s29, v23
    v_add_u32 v24, s29, v24
    v_add_u32 v25, s29, v25
    v_add_u32 v26, s29, v26
    v_add_u32 v27, s29, v27
    v_add_u32 v28, s29, v28
    v_add_u32 v29, s29, v29
    v_add_u32 v30, s29, v30
    s_lshr_b32 s29, s4, 2
    s_mul_i32 s30, s29, 589824
    s_and_b32 s6, s4, 3
    s_mul_i32 s31, s6, 288
    s_add_u32 s30, s30, s31
    s_add_u32 s96, s48, s30
    s_addc_u32 s97, s49, 0
    s_sub_u32 s98, 4718592, s30
    s_mov_b32 s99, 0x20000
    s_cmp_lg_u32 s5, 0
    s_cbranch_scc1 L_d_nowarm1_v0
    s_lshl_b32 s29, s3, 6
    v_add_u32 v2, s29, v1
    v_mul_u32_u24 v2, 1152, v2
    buffer_load_dword v31, v2, s[96:99], 0 offen offset:0
    buffer_load_dword v31, v2, s[96:99], 0 offen offset:128
    buffer_load_dword v31, v2, s[96:99], 0 offen offset:284
L_d_nowarm1_v0:
    s_nop 1
    s_waitcnt vmcnt(8)
    s_barrier
    s_add_u32 s29, s28, 6
    s_cmp_ge_u32 s29, 9
    s_cselect_b32 s30, 9, 0
    s_sub_u32 s29, s29, s30
    s_lshl_b32 s35, s29, 7
    s_add_u32 m0, s33, 32768
    s_nop 0
    buffer_load_dwordx4 v8, s[8:11], s35 offen offset:0  lds
    buffer_load_dwordx4 v9, s[8:11], s35 offen offset:1024  lds
    buffer_load_dwordx4 v10, s[8:11], s35 offen offset:2048  lds
    buffer_load_dwordx4 v11, s[8:11], s35 offen offset:3072  lds
    s_add_u32 s29, s28, 6
    s_cmp_ge_u32 s29, 9
    s_cselect_b32 s30, 9, 0
    s_sub_u32 s29, s29, s30
    s_lshl_b32 s35, s29, 19
    s_add_u32 m0, s33, 49152
    s_nop 0
    buffer_load_dwordx4 v12, s[12:15], s35 offen offset:0  lds
    buffer_load_dwordx4 v13, s[12:15], s35 offen offset:1024  lds
    buffer_load_dwordx4 v14, s[12:15], s35 offen offset:2048  lds
    buffer_load_dwordx4 v15, s[12:15], s35 offen offset:3072  lds
    s_waitcnt vmcnt(8)
    s_barrier
    s_add_u32 s29, s28, 7
    s_cmp_ge_u32 s29, 9
    s_cselect_b32 s30, 9, 0
    s_sub_u32 s29, s29, s30
    s_lshl_b32 s35, s29, 7
    s_add_u32 m0, s33, 65536
    s_nop 0
    buffer_load_dwordx4 v8, s[8:11], s35 offen offset:0  lds
    buffer_load_dwordx4 v9, s[8:11], s35 offen offset:1024  lds
    buffer_load_dwordx4 v10, s[8:11], s35 offen offset:2048  lds
    buffer_load_dwordx4 v11, s[8:11], s35 offen offset:3072  lds
    s_add_u32 s29, s28, 7
    s_cmp_ge_u32 s29, 9
    s_cselect_b32 s30, 9, 0
    s_sub_u32 s29, s29, s30
    s_lshl_b32 s35, s29, 19
    s_add_u32 m0, s33, 81920
    s_nop 0
    buffer_load_dwordx4 v12, s[12:15], s35 offen offset:0  lds
    buffer_load_dwordx4 v13, s[12:15], s35 offen offset:1024  lds
    buffer_load_dwordx4 v14, s[12:15], s35 offen offset:2048  lds
    buffer_load_dwordx4 v15, s[12:15], s35 offen offset:3072  lds
    s_waitcnt vmcnt(8)
    s_barrier
    s_add_u32 s29, s28, 8
    s_cmp_ge_u32 s29, 9
    s_cselect_b32 s30, 9, 0
    s_sub_u32 s29, s29, s30
    s_lshl_b32 s35, s29, 7
    s_add_u32 m0, s33, 98304
    s_nop 0
    buffer_load_dwordx4 v8, s[8:11], s35 offen offset:0  lds
    buffer_load_dwordx4 v9, s[8:11], s35 offen offset:1024  lds
    buffer_load_dwordx4 v10, s[8:11], s35 offen offset:2048  lds
    buffer_load_dwordx4 v11, s[8:11], s35 offen offset:3072  lds
    s_add_u32 s29, s28, 8
    s_cmp_ge_u32 s29, 9
    s_cselect_b32 s30, 9, 0
    s_sub_u32 s29, s29, s30
    s_lshl_b32 s35, s29, 19
    s_add_u32 m0, s33, 114688
    s_nop 0
    buffer_load_dwordx4 v12, s[12:15], s35 offen offset:0  lds
    buffer_load_dwordx4 v13, s[12:15], s35 offen offset:1024  lds
    buffer_load_dwordx4 v14, s[12:15], s35 offen offset:2048  lds
    buffer_load_dwordx4 v15, s[12:15], s35 offen offset:3072  lds
    v_add_u32 v2, 131072, v21
    ds_write_b128 v2, v[64:67] offset:0
    ds_write_b128 v2, v[68:71] offset:1024
    ds_write_b128 v2, v[72:75] offset:2048
    ds_write_b128 v2, v[76:79] offset:3072
    s_waitcnt lgkmcnt(0)
    v_add_u32 v2, 147456, v21
    ds_write_b128 v2, v[96:99] offset:0
    ds_write_b128 v2, v[100:103] offset:1024
    ds_write_b128 v2, v[104:107] offset:2048
    ds_write_b128 v2, v[108:111] offset:3072
    s_waitcnt vmcnt(8)
    s_waitcnt lgkmcnt(0)
    s_barrier
    ds_write_b128 v21, v[32:35] offset:0
    ds_write_b128 v21, v[36:39] offset:1024
    ds_write_b128 v21, v[40:43] offset:2048
    ds_write_b128 v21, v[44:47] offset:3072
    ds_write_b128 v21, v[48:51] offset:16384
    ds_write_b128 v21, v[52:55] offset:17408
    ds_write_b128 v21, v[56:59] offset:18432
    ds_write_b128 v21, v[60:63] offset:19456
    s_waitcnt vmcnt(0)
    s_waitcnt lgkmcnt(0)
    s_barrier
    ds_write_b128 v21, v[80:83] offset:32768
    ds_write_b128 v21, v[84:87] offset:33792
    ds_write_b128 v21, v[88:91] offset:34816
    ds_write_b128 v21, v[92:95] offset:35840
    ds_write_b128 v21, v[112:115] offset:49152
    ds_write_b128 v21, v[116:119] offset:50176
    ds_write_b128 v21, v[120:123] offset:51200
    ds_write_b128 v21, v[124:127] offset:52224
    s_waitcnt lgkmcnt(0)
    s_barrier
    v_add_u32 v2, 65536, v21
    ds_write_b128 v2, v[128:131] offset:0
    ds_write_b128 v2, v[132:135] offset:1024
    ds_write_b128 v2, v[136:139] offset:2048
    ds_write_b128 v2, v[140:143] offset:3072
    s_waitcnt lgkmcnt(0)
    s_barrier
    s_barrier
    s_mov_b32 s35, 65536
    s_add_u32 m0, s33, 0
    s_nop 0
    buffer_load_dwordx4 v16, s[16:19], s35 offen offset:0 nt lds
    buffer_load_dwordx4 v17, s[16:19], s35 offen offset:1024 nt lds
    buffer_load_dwordx4 v18, s[16:19], s35 offen offset:2048 nt lds
    buffer_load_dwordx4 v19, s[16:19], s35 offen offset:3072 nt lds
    s_mov_b32 s35, 49152
    s_add_u32 m0, s33, 81920
    s_nop 0
    buffer_load_dwordx4 v20, s[20:23], s35 offen offset:0 nt lds
    buffer_load_dwordx4 v20, s[20:23], s35 offen offset:1024 nt lds
    buffer_load_dwordx4 v20, s[20:23], s35 offen offset:2048 nt lds
    buffer_load_dwordx4 v20, s[20:23], s35 offen offset:3072 nt lds
    s_mov_b32 s35, 81920
    s_add_u32 m0, s33, 16384
    s_nop 0
    buffer_load_dwordx4 v16, s[16:19], s35 offen offset:0 nt lds
    buffer_load_dwordx4 v17, s[16:19], s35 offen offset:1024 nt lds
    buffer_load_dwordx4 v18, s[16:19], s35 offen offset:2048 nt lds
    buffer_load_dwordx4 v19, s[16:19], s35 offen offset:3072 nt lds
    s_mov_b32 s35, 65536
    s_add_u32 m0, s33, 98304
    s_nop 0
    buffer_load_dwordx4 v20, s[20:23], s35 offen offset:0 nt lds
    buffer_load_dwordx4 v20, s[20:23], s35 offen offset:1024 nt lds
    buffer_load_dwordx4 v20, s[20:23], s35 offen offset:2048 nt lds
    buffer_load_dwordx4 v20, s[20:23], s35 offen offset:3072 nt lds
    s_barrier
    s_mov_b32 s35, 98304
    s_add_u32 m0, s33, 32768
    s_nop 0
    buffer_load_dwordx4 v16, s[16:19], s35 offen offset:0 nt lds
    buffer_load_dwordx4 v17, s[16:19], s35 offen offset:1024 nt lds
    buffer_load_dwordx4 v18, s[16:19], s35 offen offset:2048 nt lds
    buffer_load_dwordx4 v19, s[16:19], s35 offen offset:3072 nt lds
    s_waitcnt vmcnt(12)
    s_barrier
    s_mov_b32 s35, 81920
    s_add_u32 m0, s33, 114688
    s_nop 0
    buffer_load_dwordx4 v20, s[20:23], s35 offen offset:0 nt lds
    buffer_load_dwordx4 v20, s[20:23], s35 offen offset:1024 nt lds
    buffer_load_dwordx4 v20, s[20:23], s35 offen offset:2048 nt lds
    buffer_load_dwordx4 v20, s[20:23], s35 offen offset:3072 nt lds
    s_mov_b32 s35, 114688
    s_add_u32 m0, s33, 49152
    s_nop 0
    buffer_load_dwordx4 v16, s[16:19], s35 offen offset:0 nt lds
    buffer_load_dwordx4 v17, s[16:19], s35 offen offset:1024 nt lds
    buffer_load_dwordx4 v18, s[16:19], s35 offen offset:2048 nt lds
    buffer_load_dwordx4 v19, s[16:19], s35 offen offset:3072 nt lds
    s_waitcnt vmcnt(12)
    s_barrier
    s_mov_b32 s35, 98304
    s_add_u32 m0, s33, 131072
    s_nop 0
    buffer_load_dwordx4 v20, s[20:23], s35 offen offset:0 nt lds
    buffer_load_dwordx4 v20, s[20:23], s35 offen offset:1024 nt lds
    buffer_load_dwordx4 v20, s[20:23], s35 offen offset:2048 nt lds
    buffer_load_dwordx4 v20, s[20:23], s35 offen offset:3072 nt lds
    s_mov_b32 s35, 114688
    s_add_u32 m0, s33, 147456
    s_nop 0
    buffer_load_dwordx4 v20, s[20:23], s35 offen offset:0 nt lds
    buffer_load_dwordx4 v20, s[20:23], s35 offen offset:1024 nt lds
    buffer_load_dwordx4 v20, s[20:23], s35 offen offset:2048 nt lds
    buffer_load_dwordx4 v20, s[20:23], s35 offen offset:3072 nt lds
    s_waitcnt vmcnt(12)
    s_barrier
    s_waitcnt vmcnt(4)
    s_barrier
    s_add_u32 s29, s6, 0
    s_and_b32 s29, s29, 3
    s_mul_i32 s35, s29, 147456
    s_mul_i32 s36, s5, 9216
    s_add_u32 m0, s36, 73728
    s_nop 0
    buffer_load_dwordx4 v22, s[96:99], s35 offen  lds
    s_add_u32 m0, s36, 74752
    s_nop 0
    buffer_load_dwordx4 v23, s[96:99], s35 offen  lds
    s_add_u32 m0, s36, 75776
    s_nop 0
    buffer_load_dwordx4 v24, s[96:99], s35 offen  lds
    s_add_u32 m0, s36, 76800
    s_nop 0
    buffer_load_dwordx4 v25, s[96:99], s35 offen  lds
    s_add_u32 m0, s36, 77824
    s_nop 0
    buffer_load_dwordx4 v26, s[96:99], s35 offen  lds
    s_add_u32 m0, s36, 78848
    s_nop 0
    buffer_load_dwordx4 v27, s[96:99], s35 offen  lds
    s_add_u32 m0, s36, 79872
    s_nop 0
    buffer_load_dwordx4 v28, s[96:99], s35 offen  lds
    s_add_u32 m0, s36, 80896
    s_nop 0
    buffer_load_dwordx4 v29, s[96:99], s35 offen  lds
    s_add_u32 m0, s36, 81920
    s_nop 0
    buffer_load_dwordx4 v30, s[96:99], s35 offen  lds
    s_add_u32 s29, s6, 1
    s_and_b32 s29, s29, 3
    s_mul_i32 s35, s29, 147456
    s_mul_i32 s36, s5, 9216
    s_add_u32 m0, s36, 0
    s_nop 0
    buffer_load_dwordx4 v22, s[96:99], s35 offen  lds
    s_add_u32 m0, s36, 1024
    s_nop 0
    buffer_load_dwordx4 v23, s[96:99], s35 offen  lds
    s_add_u32 m0, s36, 2048
    s_nop 0
    buffer_load_dwordx4 v24, s[96:99], s35 offen  lds
    s_add_u32 m0, s36, 3072
    s_nop 0
    buffer_load_dwordx4 v25, s[96:99], s35 offen  lds
    s_add_u32 m0, s36, 4096
    s_nop 0
    buffer_load_dwordx4 v26, s[96:99], s35 offen  lds
    s_add_u32 m0, s36, 5120
    s_nop 0
    buffer_load_dwordx4 v27, s[96:99], s35 offen  lds
    s_add_u32 m0, s36, 6144
    s_nop 0
    buffer_load_dwordx4 v28, s[96:99], s35 offen  lds
    s_add_u32 m0, s36, 7168
    s_nop 0
    buffer_load_dwordx4 v29, s[96:99], s35 offen  lds
    s_add_u32 m0, s36, 8192
    s_nop 0
    buffer_load_dwordx4 v30, s[96:99], s35 offen  lds
    s_waitcnt vmcnt(18)
    s_barrier
    s_add_u32 s29, s6, 2
    s_and_b32 s29, s29, 3
    s_mul_i32 s35, s29, 147456
    s_mul_i32 s36, s5, 9216
    s_add_u32 m0, s36, 36864
    s_nop 0
    buffer_load_dwordx4 v22, s[96:99], s35 offen  lds
    s_add_u32 m0, s36, 37888
    s_nop 0
    buffer_load_dwordx4 v23, s[96:99], s35 offen  lds
    s_add_u32 m0, s36, 38912
    s_nop 0
    buffer_load_dwordx4 v24, s[96:99], s35 offen  lds
    s_add_u32 m0, s36, 39936
    s_nop 0
    buffer_load_dwordx4 v25, s[96:99], s35 offen  lds
    s_add_u32 m0, s36, 40960
    s_nop 0
    buffer_load_dwordx4 v26, s[96:99], s35 offen  lds
    s_add_u32 m0, s36, 41984
    s_nop 0
    buffer_load_dwordx4 v27, s[96:99], s35 offen  lds
    s_add_u32 m0, s36, 43008
    s_nop 0
    buffer_load_dwordx4 v28, s[96:99], s35 offen  lds
    s_add_u32 m0, s36, 44032
    s_nop 0
    buffer_load_dwordx4 v29, s[96:99], s35 offen  lds
    s_add_u32 m0, s36, 45056
    s_nop 0
    buffer_load_dwordx4 v30, s[96:99], s35 offen  lds
    s_waitcnt vmcnt(18)
    s_barrier
    s_barrier
    s_waitcnt vmcnt(9)
    s_barrier
    s_barrier
    s_add_u32 s29, s6, 3
    s_and_b32 s29, s29, 3
    s_mul_i32 s35, s29, 147456
    s_mul_i32 s36, s5, 9216
    s_add_u32 m0, s36, 110592
    s_nop 0
    buffer_load_dwordx4 v22, s[96:99], s35 offen  lds
    s_add_u32 m0, s36, 111616
    s_nop 0
    buffer_load_dwordx4 v23, s[96:99], s35 offen  lds
    s_add_u32 m0, s36, 112640
    s_nop 0
    buffer_load_dwordx4 v24, s[96:99], s35 offen  lds
    s_add_u32 m0, s36, 113664
    s_nop 0
    buffer_load_dwordx4 v25, s[96:99], s35 offen  lds
    s_add_u32 m0, s36, 114688
    s_nop 0
    buffer_load_dwordx4 v26, s[96:99], s35 offen  lds
    s_add_u32 m0, s36, 115712
    s_nop 0
    buffer_load_dwordx4 v27, s[96:99], s35 offen  lds
    s_add_u32 m0, s36, 116736
    s_nop 0
    buffer_load_dwordx4 v28, s[96:99], s35 offen  lds
    s_add_u32 m0, s36, 117760
    s_nop 0
    buffer_load_dwordx4 v29, s[96:99], s35 offen  lds
    s_add_u32 m0, s36, 118784
    s_nop 0
    buffer_load_dwordx4 v30, s[96:99], s35 offen  lds
    s_waitcnt vmcnt(9)
    s_barrier
    s_waitcnt vmcnt(0)
    s_barrier
    s_and_b32 s6, s4, 3
    s_lshl_b32 s30, s3, 2
    s_add_u32 s30, s30, s6
    s_mul_i32 s30, s30, 294912
    s_add_u32 s30, s30, 8388608
    s_add_u32 s16, s54, s30
    s_addc_u32 s17, s55, 0
    s_mov_b32 s18, 294912
    s_mov_b32 s19, 0x20000
    s_mul_i32 s30, s3, 147456
    s_add_u32 s24, s50, s30
    s_addc_u32 s25, s51, 0
    s_mov_b32 s26, 147456
    s_mov_b32 s27, 0x20000
    s_mov_b32 s57, s38
    s_barrier
    s_barrier
    s_branch L_R
L_var1:
    s_nop 3
    v_lshrrev_b32 v2, 3, v1
    s_lshl_b32 s29, s5, 5
    v_add_u32 v2, s29, v2
    v_mul_u32_u24 v2, 1152, v2
    v_lshrrev_b32 v3, 4, v1
    v_and_b32 v4, 7, v1
    v_xor_b32 v5, v3, v4
    v_lshl_add_u32 v8, v5, 4, v2
    v_xor_b32 v5, 4, v5
    v_lshl_add_u32 v5, v5, 4, v2
    v_add_u32 v9, 8192, v5
    v_add_u32 v10, 16384, v8
    v_add_u32 v11, 24576, v5
    s_lshl_b32 s29, s5, 4
    v_add_u32 v2, s29, v3
    v_and_b32 v4, 15, v1
    v_lshlrev_b32 v5, 2, v3
    v_xor_b32 v5, v5, v4
    v_lshlrev_b32 v5, 4, v5
    v_lshl_add_u32 v12, v2, 13, v5
    v_add_u32 v13, 31744, v12
    v_add_u32 v14, 63488, v12
    v_add_u32 v15, 95232, v12
    v_lshlrev_b32 v6, 8, v2
    v_add_u32 v20, v6, v5
    v_xor_b32 v5, v3, v4
    v_lshl_add_u32 v16, v5, 4, v6
    v_xor_b32 v7, 4, v5
    v_lshl_add_u32 v17, v7, 4, v6
    v_xor_b32 v7, 8, v5
    v_lshl_add_u32 v18, v7, 4, v6
    v_xor_b32 v7, 12, v5
    v_lshl_add_u32 v19, v7, 4, v6
    v_lshlrev_b32 v21, 4, v1
    v_add_u32 v21, s33, v21
    s_waitcnt lgkmcnt(0)
    s_mul_i32 s29, s3, 147456
    s_add_u32 s8, s40, s29
    s_addc_u32 s9, s41, 0
    s_mov_b32 s10, 147456
    s_mov_b32 s11, 0x20000
    s_lshl_b32 s29, s4, 8
    s_add_u32 s12, s46, s29
    s_addc_u32 s13, s47, 0
    s_sub_u32 s14, 4718592, s29
    s_mov_b32 s15, 0x20000
    s_lshl_b32 s29, s3, 5
    s_add_u32 s29, s29, s4
    s_lshl_b32 s30, s29, 17
    s_add_u32 s16, s42, s30
    s_addc_u32 s17, s43, 0
    s_mov_b32 s18, 131072
    s_mov_b32 s19, 0x20000
    s_add_u32 s20, s44, s30
    s_addc_u32 s21, s45, 0
    s_mov_b32 s22, 131072
    s_mov_b32 s23, 0x20000
    s_lshl_b32 s30, s29, 15
    s_add_u32 s24, s54, s30
    s_addc_u32 s25, s55, 0
    s_mov_b32 s26, 32768
    s_mov_b32 s27, 0x20000
    buffer_load_dword v24, off, s[16:19], 0 nt
    buffer_load_dword v25, off, s[20:23], 0 nt
    s_add_u32 s29, s28, 0
    s_cmp_ge_u32 s29, 9
    s_cselect_b32 s30, 9, 0
    s_sub_u32 s29, s29, s30
    s_lshl_b32 s35, s29, 7
    s_add_u32 m0, s33, 0
    s_nop 0
    buffer_load_dwordx4 v8, s[8:11], s35 offen offset:0  lds
    buffer_load_dwordx4 v9, s[8:11], s35 offen offset:1024  lds
    buffer_load_dwordx4 v10, s[8:11], s35 offen offset:2048  lds
    buffer_load_dwordx4 v11, s[8:11], s35 offen offset:3072  lds
    s_add_u32 s29, s28, 0
    s_cmp_ge_u32 s29, 9
    s_cselect_b32 s30, 9, 0
    s_sub_u32 s29, s29, s30
    s_lshl_b32 s35, s29, 19
    s_add_u32 m0, s33, 16384
    s_nop 0
    buffer_load_dwordx4 v12, s[12:15], s35 offen offset:0  lds
    buffer_load_dwordx4 v13, s[12:15], s35 offen offset:1024  lds
    buffer_load_dwordx4 v14, s[12:15], s35 offen offset:2048  lds
    buffer_load_dwordx4 v15, s[12:15], s35 offen offset:3072  lds
    s_add_u32 s29, s28, 1
    s_cmp_ge_u32 s29, 9
    s_cselect_b32 s30, 9, 0
    s_sub_u32 s29, s29, s30
    s_lshl_b32 s35, s29, 7
    s_add_u32 m0, s33, 32768
    s_nop 0
    buffer_load_dwordx4 v8, s[8:11], s35 offen offset:0  lds
    buffer_load_dwordx4 v9, s[8:11], s35 offen offset:1024  lds
    buffer_load_dwordx4 v10, s[8:11], s35 offen offset:2048  lds
    buffer_load_dwordx4 v11, s[8:11], s35 offen offset:3072  lds
    s_add_u32 s29, s28, 1
    s_cmp_ge_u32 s29, 9
    s_cselect_b32 s30, 9, 0
    s_sub_u32 s29, s29, s30
    s_lshl_b32 s35, s29, 19
    s_add_u32 m0, s33, 49152
    s_nop 0
    buffer_load_dwordx4 v12, s[12:15], s35 offen offset:0  lds
    buffer_load_dwordx4 v13, s[12:15], s35 offen offset:1024  lds
    buffer_load_dwordx4 v14, s[12:15], s35 offen offset:2048  lds
    buffer_load_dwordx4 v15, s[12:15], s35 offen offset:3072  lds
    s_waitcnt vmcnt(8)
    s_barrier
    s_add_u32 s29, s28, 2
    s_cmp_ge_u32 s29, 9
    s_cselect_b32 s30, 9, 0
    s_sub_u32 s29, s29, s30
    s_lshl_b32 s35, s29, 7
    s_add_u32 m0, s33, 65536
    s_nop 0
    buffer_load_dwordx4 v8, s[8:11], s35 offen offset:0  lds
    buffer_load_dwordx4 v9, s[8:11], s35 offen offset:1024  lds
    buffer_load_dwordx4 v10, s[8:11], s35 offen offset:2048  lds
    buffer_load_dwordx4 v11, s[8:11], s35 offen offset:3072  lds
    s_add_u32 s29, s28, 2
    s_cmp_ge_u32 s29, 9
    s_cselect_b32 s30, 9, 0
    s_sub_u32 s29, s29, s30
    s_lshl_b32 s35, s29, 19
    s_add_u32 m0, s33, 81920
    s_nop 0
    buffer_load_dwordx4 v12, s[12:15], s35 offen offset:0  lds
    buffer_load_dwordx4 v13, s[12:15], s35 offen offset:1024  lds
    buffer_load_dwordx4 v14, s[12:15], s35 offen offset:2048  lds
    buffer_load_dwordx4 v15, s[12:15], s35 offen offset:3072  lds
    s_waitcnt vmcnt(8)
    s_barrier
    s_add_u32 s29, s28, 3
    s_cmp_ge_u32 s29, 9
    s_cselect_b32 s30, 9, 0
    s_sub_u32 s29, s29, s30
    s_lshl_b32 s35, s29, 7
    s_add_u32 m0, s33, 98304
    s_nop 0
    buffer_load_dwordx4 v8, s[8:11], s35 offen offset:0  lds
    buffer_load_dwordx4 v9, s[8:11], s35 offen offset:1024  lds
    buffer_load_dwordx4 v10, s[8:11], s35 offen offset:2048  lds
    buffer_load_dwordx4 v11, s[8:11], s35 offen offset:3072  lds
    s_add_u32 s29, s28, 3
    s_cmp_ge_u32 s29, 9
    s_cselect_b32 s30, 9, 0
    s_sub_u32 s29, s29, s30
    s_lshl_b32 s35, s29, 19
    s_add_u32 m0, s33, 114688
    s_nop 0
    buffer_load_dwordx4 v12, s[12:15], s35 offen offset:0  lds
    buffer_load_dwordx4 v13, s[12:15], s35 offen offset:1024  lds
    buffer_load_dwordx4 v14, s[12:15], s35 offen offset:2048  lds
    buffer_load_dwordx4 v15, s[12:15], s35 offen offset:3072  lds
    s_waitcnt vmcnt(8)
    s_barrier
    s_add_u32 s29, s28, 4
    s_cmp_ge_u32 s29, 9
    s_cselect_b32 s30, 9, 0
    s_sub_u32 s29, s29, s30
    s_lshl_b32 s35, s29, 7
    s_add_u32 m0, s33, 131072
    s_nop 0
    buffer_load_dwordx4 v8, s[8:11], s35 offen offset:0  lds
    buffer_load_dwordx4 v9, s[8:11], s35 offen offset:1024  lds
    buffer_load_dwordx4 v10, s[8:11], s35 offen offset:2048  lds
    buffer_load_dwordx4 v11, s[8:11], s35 offen offset:3072  lds
    s_add_u32 s29, s28, 4
    s_cmp_ge_u32 s29, 9
    s_cselect_b32 s30, 9, 0
    s_sub_u32 s29, s29, s30
    s_lshl_b32 s35, s29, 19
    s_add_u32 m0, s33, 147456
    s_nop 0
    buffer_load_dwordx4 v12, s[12:15], s35 offen offset:0  lds
    buffer_load_dwordx4 v13, s[12:15], s35 offen offset:1024  lds
    buffer_load_dwordx4 v14, s[12:15], s35 offen offset:2048  lds
    buffer_load_dwordx4 v15, s[12:15], s35 offen offset:3072  lds
    s_waitcnt vmcnt(8)
    s_barrier
    s_add_u32 s29, s28, 5
    s_cmp_ge_u32 s29, 9
    s_cselect_b32 s30, 9, 0
    s_sub_u32 s29, s29, s30
    s_lshl_b32 s35, s29, 7
    s_add_u32 m0, s33, 0
    s_nop 0
    buffer_load_dwordx4 v8, s[8:11], s35 offen offset:0  lds
    buffer_load_dwordx4 v9, s[8:11], s35 offen offset:1024  lds
    buffer_load_dwordx4 v10, s[8:11], s35 offen offset:2048  lds
    buffer_load_dwordx4 v11, s[8:11], s35 offen offset:3072  lds
    s_add_u32 s29, s28, 5
    s_cmp_ge_u32 s29, 9
    s_cselect_b32 s30, 9, 0
    s_sub_u32 s29, s29, s30
    s_lshl_b32 s35, s29, 19
    s_add_u32 m0, s33, 16384
    s_nop 0
    buffer_load_dwordx4 v12, s[12:15], s35 offen offset:0  lds
    buffer_load_dwordx4 v13, s[12:15], s35 offen offset:1024  lds
    buffer_load_dwordx4 v14, s[12:15], s35 offen offset:2048  lds
    buffer_load_dwordx4 v15, s[12:15], s35 offen offset:3072  lds
    v_add_u32 v2, 0, v1
    v_mul_u32_u24 v3, 3641, v2
    v_lshrrev_b32 v3, 16, v3
    v_mul_u32_u24 v4, 18, v3
    v_sub_u32 v4, v2, v4
    v_mul_u32_u24 v3, 1152, v3
    v_lshl_add_u32 v22, v4, 4, v3
    v_add_u32 v2, 64, v1
    v_mul_u32_u24 v3, 3641, v2
    v_lshrrev_b32 v3, 16, v3
    v_mul_u32_u24 v4, 18, v3
    v_sub_u32 v4, v2, v4
    v_mul_u32_u24 v3, 1152, v3
    v_lshl_add_u32 v23, v4, 4, v3
    v_add_u32 v2, 128, v1
    v_mul_u32_u24 v3, 3641, v2
    v_lshrrev_b32 v3, 16, v3
    v_mul_u32_u24 v4, 18, v3
    v_sub_u32 v4, v2, v4
    v_mul_u32_u24 v3, 1152, v3
    v_lshl_add_u32 v24, v4, 4, v3
    v_add_u32 v2, 192, v1
    v_mul_u32_u24 v3, 3641, v2
    v_lshrrev_b32 v3, 16, v3
    v_mul_u32_u24 v4, 18, v3
    v_sub_u32 v4, v2, v4
    v_mul_u32_u24 v3, 1152, v3
    v_lshl_add_u32 v25, v4, 4, v3
    v_add_u32 v2, 256, v1
    v_mul_u32_u24 v3, 3641, v2
    v_lshrrev_b32 v3, 16, v3
    v_mul_u32_u24 v4, 18, v3
    v_sub_u32 v4, v2, v4
    v_mul_u32_u24 v3, 1152, v3
    v_lshl_add_u32 v26, v4, 4, v3
    v_add_u32 v2, 320, v1
    v_mul_u32_u24 v3, 3641, v2
    v_lshrrev_b32 v3, 16, v3
    v_mul_u32_u24 v4, 18, v3
    v_sub_u32 v4, v2, v4
    v_mul_u32_u24 v3, 1152, v3
    v_lshl_add_u32 v27, v4, 4, v3
    v_add_u32 v2, 384, v1
    v_mul_u32_u24 v3, 3641, v2
    v_lshrrev_b32 v3, 16, v3
    v_mul_u32_u24 v4, 18, v3
    v_sub_u32 v4, v2, v4
    v_mul_u32_u24 v3, 1152, v3
    v_lshl_add_u32 v28, v4, 4, v3
    v_add_u32 v2, 448, v1
    v_mul_u32_u24 v3, 3641, v2
    v_lshrrev_b32 v3, 16, v3
    v_mul_u32_u24 v4, 18, v3
    v_sub_u32 v4, v2, v4
    v_mul_u32_u24 v3, 1152, v3
    v_lshl_add_u32 v29, v4, 4, v3
    v_add_u32 v2, 512, v1
    v_mul_u32_u24 v3, 3641, v2
    v_lshrrev_b32 v3, 16, v3
    v_mul_u32_u24 v4, 18, v3
    v_sub_u32 v4, v2, v4
    v_mul_u32_u24 v3, 1152, v3
    v_lshl_add_u32 v30, v4, 4, v3
    s_mul_i32 s29, s5, 36864
    v_add_u32 v22, s29, v22
    v_add_u32 v23, s29, v23
    v_add_u32 v24, s29, v24
    v_add_u32 v25, s29, v25
    v_add_u32 v26, s29, v26
    v_add_u32 v27, s29, v27
    v_add_u32 v28, s29, v28
    v_add_u32 v29, s29, v29
    v_add_u32 v30, s29, v30
    s_lshr_b32 s29, s4, 2
    s_mul_i32 s30, s29, 589824
    s_and_b32 s6, s4, 3
    s_mul_i32 s31, s6, 288
    s_add_u32 s30, s30, s31
    s_add_u32 s96, s48, s30
    s_addc_u32 s97, s49, 0
    s_sub_u32 s98, 4718592, s30
    s_mov_b32 s99, 0x20000
    s_cmp_lg_u32 s5, 0
    s_cbranch_scc1 L_d_nowarm1_v1
    s_lshl_b32 s29, s3, 6
    v_add_u32 v2, s29, v1
    v_mul_u32_u24 v2, 1152, v2
    buffer_load_dword v31, v2, s[96:99], 0 offen offset:0
    buffer_load_dword v31, v2, s[96:99], 0 offen offset:128
    buffer_load_dword v31, v2, s[96:99], 0 offen offset:284
L_d_nowarm1_v1:
    s_nop 1
    s_waitcnt vmcnt(8)
    s_barrier
    s_add_u32 s29, s28, 6
    s_cmp_ge_u32 s29, 9
    s_cselect_b32 s30, 9, 0
    s_sub_u32 s29, s29, s30
    s_lshl_b32 s35, s29, 7
    s_add_u32 m0, s33, 32768
    s_nop 0
    buffer_load_dwordx4 v8, s[8:11], s35 offen offset:0  lds
    buffer_load_dwordx4 v9, s[8:11], s35 offen offset:1024  lds
    buffer_load_dwordx4 v10, s[8:11], s35 offen offset:2048  lds
    buffer_load_dwordx4 v11, s[8:11], s35 offen offset:3072  lds
    s_add_u32 s29, s28, 6
    s_cmp_ge_u32 s29, 9
    s_cselect_b32 s30, 9, 0
    s_sub_u32 s29, s29, s30
    s_lshl_b32 s35, s29, 19
    s_add_u32 m0, s33, 49152
    s_nop 0
    buffer_load_dwordx4 v12, s[12:15], s35 offen offset:0  lds
    buffer_load_dwordx4 v13, s[12:15], s35 offen offset:1024  lds
    buffer_load_dwordx4 v14, s[12:15], s35 offen offset:2048  lds
    buffer_load_dwordx4 v15, s[12:15], s35 offen offset:3072  lds
    s_waitcnt vmcnt(8)
    s_barrier
    s_add_u32 s29, s28, 7
    s_cmp_ge_u32 s29, 9
    s_cselect_b32 s30, 9, 0
    s_sub_u32 s29, s29, s30
    s_lshl_b32 s35, s29, 7
    s_add_u32 m0, s33, 65536
    s_nop 0
    buffer_load_dwordx4 v8, s[8:11], s35 offen offset:0  lds
    buffer_load_dwordx4 v9, s[8:11], s35 offen offset:1024  lds
    buffer_load_dwordx4 v10, s[8:11], s35 offen offset:2048  lds
    buffer_load_dwordx4 v11, s[8:11], s35 offen offset:3072  lds
    s_add_u32 s29, s28, 7
    s_cmp_ge_u32 s29, 9
    s_cselect_b32 s30, 9, 0
    s_sub_u32 s29, s29, s30
    s_lshl_b32 s35, s29, 19
    s_add_u32 m0, s33, 81920
    s_nop 0
    buffer_load_dwordx4 v12, s[12:15], s35 offen offset:0  lds
    buffer_load_dwordx4 v13, s[12:15], s35 offen offset:1024  lds
    buffer_load_dwordx4 v14, s[12:15], s35 offen offset:2048  lds
    buffer_load_dwordx4 v15, s[12:15], s35 offen offset:3072  lds
    s_waitcnt vmcnt(8)
    s_barrier
    s_add_u32 s29, s28, 8
    s_cmp_ge_u32 s29, 9
    s_cselect_b32 s30, 9, 0
    s_sub_u32 s29, s29, s30
    s_lshl_b32 s35, s29, 7
    s_add_u32 m0, s33, 98304
    s_nop 0
    buffer_load_dwordx4 v8, s[8:11], s35 offen offset:0  lds
    buffer_load_dwordx4 v9, s[8:11], s35 offen offset:1024  lds
    buffer_load_dwordx4 v10, s[8:11], s35 offen offset:2048  lds
    buffer_load_dwordx4 v11, s[8:11], s35 offen offset:3072  lds
    s_add_u32 s29, s28, 8
    s_cmp_ge_u32 s29, 9
    s_cselect_b32 s30, 9, 0
    s_sub_u32 s29, s29, s30
    s_lshl_b32 s35, s29, 19
    s_add_u32 m0, s33, 114688
    s_nop 0
    buffer_load_dwordx4 v12, s[12:15], s35 offen offset:0  lds
    buffer_load_dwordx4 v13, s[12:15], s35 offen offset:1024  lds
    buffer_load_dwordx4 v14, s[12:15], s35 offen offset:2048  lds
    buffer_load_dwordx4 v15, s[12:15], s35 offen offset:3072  lds
    s_waitcnt vmcnt(8)
    s_barrier
    s_mov_b32 s35, 0
    s_add_u32 m0, s33, 0
    s_nop 0
    buffer_load_dwordx4 v16, s[16:19], s35 offen offset:0 nt lds
    buffer_load_dwordx4 v17, s[16:19], s35 offen offset:1024 nt lds
    buffer_load_dwordx4 v18, s[16:19], s35 offen offset:2048 nt lds
    buffer_load_dwordx4 v19, s[16:19], s35 offen offset:3072 nt lds
    s_mov_b32 s35, 16384
    s_add_u32 m0, s33, 16384
    s_nop 0
    buffer_load_dwordx4 v16, s[16:19], s35 offen offset:0 nt lds
    buffer_load_dwordx4 v17, s[16:19], s35 offen offset:1024 nt lds
    buffer_load_dwordx4 v18, s[16:19], s35 offen offset:2048 nt lds
    buffer_load_dwordx4 v19, s[16:19], s35 offen offset:3072 nt lds
    s_waitcnt vmcnt(8)
    s_barrier
    s_waitcnt vmcnt(4)
    s_barrier
    s_mov_b32 s35, 0
    s_add_u32 m0, s33, 131072
    s_nop 0
    buffer_load_dwordx4 v20, s[20:23], s35 offen offset:0 nt lds
    buffer_load_dwordx4 v20, s[20:23], s35 offen offset:1024 nt lds
    buffer_load_dwordx4 v20, s[20:23], s35 offen offset:2048 nt lds
    buffer_load_dwordx4 v20, s[20:23], s35 offen offset:3072 nt lds
    s_mov_b32 s35, 32768
    s_add_u32 m0, s33, 32768
    s_nop 0
    buffer_load_dwordx4 v16, s[16:19], s35 offen offset:0 nt lds
    buffer_load_dwordx4 v17, s[16:19], s35 offen offset:1024 nt lds
    buffer_load_dwordx4 v18, s[16:19], s35 offen offset:2048 nt lds
    buffer_load_dwordx4 v19, s[16:19], s35 offen offset:3072 nt lds
    s_mov_b32 s35, 16384
    s_add_u32 m0, s33, 147456
    s_nop 0
    buffer_load_dwordx4 v20, s[20:23], s35 offen offset:0 nt lds
    buffer_load_dwordx4 v20, s[20:23], s35 offen offset:1024 nt lds
    buffer_load_dwordx4 v20, s[20:23], s35 offen offset:2048 nt lds
    buffer_load_dwordx4 v20, s[20:23], s35 offen offset:3072 nt lds
    s_mov_b32 s35, 49152
    s_add_u32 m0, s33, 49152
    s_nop 0
    buffer_load_dwordx4 v16, s[16:19], s35 offen offset:0 nt lds
    buffer_load_dwordx4 v17, s[16:19], s35 offen offset:1024 nt lds
    buffer_load_dwordx4 v18, s[16:19], s35 offen offset:2048 nt lds
    buffer_load_dwordx4 v19, s[16:19], s35 offen offset:3072 nt lds
    s_waitcnt vmcnt(12)
    s_barrier
    s_mov_b32 s35, 32768
    s_add_u32 m0, s33, 65536
    s_nop 0
    buffer_load_dwordx4 v20, s[20:23], s35 offen offset:0 nt lds
    buffer_load_dwordx4 v20, s[20:23], s35 offen offset:1024 nt lds
    buffer_load_dwordx4 v20, s[20:23], s35 offen offset:2048 nt lds
    buffer_load_dwordx4 v20, s[20:23], s35 offen offset:3072 nt lds
    s_waitcnt vmcnt(8)
    s_barrier
    s_mov_b32 s35, 65536
    s_add_u32 m0, s33, 0
    s_nop 0
    buffer_load_dwordx4 v16, s[16:19], s35 offen offset:0 nt lds
    buffer_load_dwordx4 v17, s[16:19], s35 offen offset:1024 nt lds
    buffer_load_dwordx4 v18, s[16:19], s35 offen offset:2048 nt lds
    buffer_load_dwordx4 v19, s[16:19], s35 offen offset:3072 nt lds
    s_mov_b32 s35, 49152
    s_add_u32 m0, s33, 81920
    s_nop 0
    buffer_load_dwordx4 v20, s[20:23], s35 offen offset:0 nt lds
    buffer_load_dwordx4 v20, s[20:23], s35 offen offset:1024 nt lds
    buffer_load_dwordx4 v20, s[20:23], s35 offen offset:2048 nt lds
    buffer_load_dwordx4 v20, s[20:23], s35 offen offset:3072 nt lds
    s_mov_b32 s35, 81920
    s_add_u32 m0, s33, 16384
    s_nop 0
    buffer_load_dwordx4 v16, s[16:19], s35 offen offset:0 nt lds
    buffer_load_dwordx4 v17, s[16:19], s35 offen offset:1024 nt lds
    buffer_load_dwordx4 v18, s[16:19], s35 offen offset:2048 nt lds
    buffer_load_dwordx4 v19, s[16:19], s35 offen offset:3072 nt lds
    s_waitcnt vmcnt(12)
    s_barrier
    s_mov_b32 s35, 65536
    s_add_u32 m0, s33, 98304
    s_nop 0
    buffer_load_dwordx4 v20, s[20:23], s35 offen offset:0 nt lds
    buffer_load_dwordx4 v20, s[20:23], s35 offen offset:1024 nt lds
    buffer_load_dwordx4 v20, s[20:23], s35 offen offset:2048 nt lds
    buffer_load_dwordx4 v20, s[20:23], s35 offen offset:3072 nt lds
    s_mov_b32 s35, 98304
    s_add_u32 m0, s33, 32768
    s_nop 0
    buffer_load_dwordx4 v16, s[16:19], s35 offen offset:0 nt lds
    buffer_load_dwordx4 v17, s[16:19], s35 offen offset:1024 nt lds
    buffer_load_dwordx4 v18, s[16:19], s35 offen offset:2048 nt lds
    buffer_load_dwordx4 v19, s[16:19], s35 offen offset:3072 nt lds
    s_waitcnt vmcnt(12)
    s_barrier
    s_mov_b32 s35, 81920
    s_add_u32 m0, s33, 114688
    s_nop 0
    buffer_load_dwordx4 v20, s[20:23], s35 offen offset:0 nt lds
    buffer_load_dwordx4 v20, s[20:23], s35 offen offset:1024 nt lds
    buffer_load_dwordx4 v20, s[20:23], s35 offen offset:2048 nt lds
    buffer_load_dwordx4 v20, s[20:23], s35 offen offset:3072 nt lds
    s_mov_b32 s35, 114688
    s_add_u32 m0, s33, 49152
    s_nop 0
    buffer_load_dwordx4 v16, s[16:19], s35 offen offset:0 nt lds
    buffer_load_dwordx4 v17, s[16:19], s35 offen offset:1024 nt lds
    buffer_load_dwordx4 v18, s[16:19], s35 offen offset:2048 nt lds
    buffer_load_dwordx4 v19, s[16:19], s35 offen offset:3072 nt lds
    s_waitcnt vmcnt(12)
    s_barrier
    s_mov_b32 s35, 98304
    s_add_u32 m0, s33, 131072
    s_nop 0
    buffer_load_dwordx4 v20, s[20:23], s35 offen offset:0 nt lds
    buffer_load_dwordx4 v20, s[20:23], s35 offen offset:1024 nt lds
    buffer_load_dwordx4 v20, s[20:23], s35 offen offset:2048 nt lds
    buffer_load_dwordx4 v20, s[20:23], s35 offen offset:3072 nt lds
    s_mov_b32 s35, 114688
    s_add_u32 m0, s33, 147456
    s_nop 0
    buffer_load_dwordx4 v20, s[20:23], s35 offen offset:0 nt lds
    buffer_load_dwordx4 v20, s[20:23], s35 offen offset:1024 nt lds
    buffer_load_dwordx4 v20, s[20:23], s35 offen offset:2048 nt lds
    buffer_load_dwordx4 v20, s[20:23], s35 offen offset:3072 nt lds
    s_waitcnt vmcnt(12)
    s_barrier
    s_waitcnt vmcnt(4)
    s_barrier
    s_add_u32 s29, s6, 0
    s_and_b32 s29, s29, 3
    s_mul_i32 s35, s29, 147456
    s_mul_i32 s36, s5, 9216
    s_add_u32 m0, s36, 73728
    s_nop 0
    buffer_load_dwordx4 v22, s[96:99], s35 offen  lds
    s_add_u32 m0, s36, 74752
    s_nop 0
    buffer_load_dwordx4 v23, s[96:99], s35 offen  lds
    s_add_u32 m0, s36, 75776
    s_nop 0
    buffer_load_dwordx4 v24, s[96:99], s35 offen  lds
    s_add_u32 m0, s36, 76800
    s_nop 0
    buffer_load_dwordx4 v25, s[96:99], s35 offen  lds
    s_add_u32 m0, s36, 77824
    s_nop 0
    buffer_load_dwordx4 v26, s[96:99], s35 offen  lds
    s_add_u32 m0, s36, 78848
    s_nop 0
    buffer_load_dwordx4 v27, s[96:99], s35 offen  lds
    s_add_u32 m0, s36, 79872
    s_nop 0
    buffer_load_dwordx4 v28, s[96:99], s35 offen  lds
    s_add_u32 m0, s36, 80896
    s_nop 0
    buffer_load_dwordx4 v29, s[96:99], s35 offen  lds
    s_add_u32 m0, s36, 81920
    s_nop 0
    buffer_load_dwordx4 v30, s[96:99], s35 offen  lds
    s_add_u32 s29, s6, 1
    s_and_b32 s29, s29, 3
    s_mul_i32 s35, s29, 147456
    s_mul_i32 s36, s5, 9216
    s_add_u32 m0, s36, 0
    s_nop 0
    buffer_load_dwordx4 v22, s[96:99], s35 offen  lds
    s_add_u32 m0, s36, 1024
    s_nop 0
    buffer_load_dwordx4 v23, s[96:99], s35 offen  lds
    s_add_u32 m0, s36, 2048
    s_nop 0
    buffer_load_dwordx4 v24, s[96:99], s35 offen  lds
    s_add_u32 m0, s36, 3072
    s_nop 0
    buffer_load_dwordx4 v25, s[96:99], s35 offen  lds
    s_add_u32 m0, s36, 4096
    s_nop 0
    buffer_load_dwordx4 v26, s[96:99], s35 offen  lds
    s_add_u32 m0, s36, 5120
    s_nop 0
    buffer_load_dwordx4 v27, s[96:99], s35 offen  lds
    s_add_u32 m0, s36, 6144
    s_nop 0
    buffer_load_dwordx4 v28, s[96:99], s35 offen  lds
    s_add_u32 m0, s36, 7168
    s_nop 0
    buffer_load_dwordx4 v29, s[96:99], s35 offen  lds
    s_add_u32 m0, s36, 8192
    s_nop 0
    buffer_load_dwordx4 v30, s[96:99], s35 offen  lds
    s_waitcnt vmcnt(18)
    s_barrier
    s_add_u32 s29, s6, 2
    s_and_b32 s29, s29, 3
    s_mul_i32 s35, s29, 147456
    s_mul_i32 s36, s5, 9216
    s_add_u32 m0, s36, 36864
    s_nop 0
    buffer_load_dwordx4 v22, s[96:99], s35 offen  lds
    s_add_u32 m0, s36, 37888
    s_nop 0
    buffer_load_dwordx4 v23, s[96:99], s35 offen  lds
    s_add_u32 m0, s36, 38912
    s_nop 0
    buffer_load_dwordx4 v24, s[96:99], s35 offen  lds
    s_add_u32 m0, s36, 39936
    s_nop 0
    buffer_load_dwordx4 v25, s[96:99], s35 offen  lds
    s_add_u32 m0, s36, 40960
    s_nop 0
    buffer_load_dwordx4 v26, s[96:99], s35 offen  lds
    s_add_u32 m0, s36, 41984
    s_nop 0
    buffer_load_dwordx4 v27, s[96:99], s35 offen  lds
    s_add_u32 m0, s36, 43008
    s_nop 0
    buffer_load_dwordx4 v28, s[96:99], s35 offen  lds
    s_add_u32 m0, s36, 44032
    s_nop 0
    buffer_load_dwordx4 v29, s[96:99], s35 offen  lds
    s_add_u32 m0, s36, 45056
    s_nop 0
    buffer_load_dwordx4 v30, s[96:99], s35 offen  lds
    s_waitcnt vmcnt(18)
    s_barrier
    s_barrier
    s_waitcnt vmcnt(9)
    s_barrier
    s_barrier
    s_add_u32 s29, s6, 3
    s_and_b32 s29, s29, 3
    s_mul_i32 s35, s29, 147456
    s_mul_i32 s36, s5, 9216
    s_add_u32 m0, s36, 110592
    s_nop 0
    buffer_load_dwordx4 v22, s[96:99], s35 offen  lds
    s_add_u32 m0, s36, 111616
    s_nop 0
    buffer_load_dwordx4 v23, s[96:99], s35 offen  lds
    s_add_u32 m0, s36, 112640
    s_nop 0
    buffer_load_dwordx4 v24, s[96:99], s35 offen  lds
    s_add_u32 m0, s36, 113664
    s_nop 0
    buffer_load_dwordx4 v25, s[96:99], s35 offen  lds
    s_add_u32 m0, s36, 114688
    s_nop 0
    buffer_load_dwordx4 v26, s[96:99], s35 offen  lds
    s_add_u32 m0, s36, 115712
    s_nop 0
    buffer_load_dwordx4 v27, s[96:99], s35 offen  lds
    s_add_u32 m0, s36, 116736
    s_nop 0
    buffer_load_dwordx4 v28, s[96:99], s35 offen  lds
    s_add_u32 m0, s36, 117760
    s_nop 0
    buffer_load_dwordx4 v29, s[96:99], s35 offen  lds
    s_add_u32 m0, s36, 118784
    s_nop 0
    buffer_load_dwordx4 v30, s[96:99], s35 offen  lds
    s_waitcnt vmcnt(9)
    s_barrier
    s_waitcnt vmcnt(0)
    s_barrier
    s_and_b32 s6, s4, 3
    s_lshl_b32 s30, s3, 2
    s_add_u32 s30, s30, s6
    s_mul_i32 s30, s30, 294912
    s_add_u32 s30, s30, 8388608
    s_add_u32 s16, s54, s30
    s_addc_u32 s17, s55, 0
    s_mov_b32 s18, 294912
    s_mov_b32 s19, 0x20000
    s_mul_i32 s30, s3, 147456
    s_add_u32 s24, s50, s30
    s_addc_u32 s25, s51, 0
    s_mov_b32 s26, 147456
    s_mov_b32 s27, 0x20000
    s_mov_b32 s57, s38
    s_barrier
    s_barrier
    s_branch L_R
L_end:
    s_endpgm
L_rare0:
    s_nop 15
    v_max3_f32 v46, v144, v145, v146
    v_max3_f32 v47, v147, v148, v149
    v_max3_f32 v46, v46, v150, v151
    v_max3_f32 v47, v47, v152, v153
    v_max3_f32 v46, v46, v154, v155
    v_max3_f32 v47, v47, v156, v157
    v_max3_f32 v46, v46, v158, v159
    v_max_f32 v46, v46, v47
    v_mov_b32 v47, v46
    s_nop 1
    v_permlane32_swap_b32 v46, v47
    v_max_f32 v46, v46, v47
    v_max_f32 v46, 0, v46
    v_exp_f32 v43, -v46
    v_sub_f32 v144, v144, v46
    v_sub_f32 v145, v145, v46
    v_sub_f32 v146, v146, v46
    v_sub_f32 v147, v147, v46
    v_sub_f32 v148, v148, v46
    v_sub_f32 v149, v149, v46
    v_sub_f32 v150, v150, v46
    v_sub_f32 v151, v151, v46
    v_sub_f32 v152, v152, v46
    v_sub_f32 v153, v153, v46
    v_sub_f32 v154, v154, v46
    v_sub_f32 v155, v155, v46
    v_sub_f32 v156, v156, v46
    v_sub_f32 v157, v157, v46
    v_sub_f32 v158, v158, v46
    v_sub_f32 v159, v159, v46
    v_sub_f32 v160, v160, v46
    v_sub_f32 v161, v161, v46
    v_sub_f32 v162, v162, v46
    v_sub_f32 v163, v163, v46
    v_sub_f32 v164, v164, v46
    v_sub_f32 v165, v165, v46
    v_sub_f32 v166, v166, v46
    v_sub_f32 v167, v167, v46
    v_sub_f32 v168, v168, v46
    v_sub_f32 v169, v169, v46
    v_sub_f32 v170, v170, v46
    v_sub_f32 v171, v171, v46
    v_sub_f32 v172, v172, v46
    v_sub_f32 v173, v173, v46
    v_sub_f32 v174, v174, v46
    v_sub_f32 v175, v175, v46
    v_sub_f32 v208, v208, v46
    v_sub_f32 v209, v209, v46
    v_sub_f32 v210, v210, v46
    v_sub_f32 v211, v211, v46
    v_sub_f32 v212, v212, v46
    v_sub_f32 v213, v213, v46
    v_sub_f32 v214, v214, v46
    v_sub_f32 v215, v215, v46
    v_sub_f32 v216, v216, v46
    v_sub_f32 v217, v217, v46
    v_sub_f32 v218, v218, v46
    v_sub_f32 v219, v219, v46
    v_sub_f32 v220, v220, v46
    v_sub_f32 v221, v221, v46
    v_sub_f32 v222, v222, v46
    v_sub_f32 v223, v223, v46
    v_exp_f32 v192, v144
    v_exp_f32 v193, v145
    v_exp_f32 v194, v146
    v_exp_f32 v195, v147
    v_exp_f32 v196, v148
    v_exp_f32 v197, v149
    v_exp_f32 v198, v150
    v_exp_f32 v199, v151
    v_add_f32 v44, v192, v193
    v_add_f32 v45, v194, v195
    v_cvt_pk_bf16_f32 v176, v192, v193
    v_cvt_pk_bf16_f32 v177, v194, v195
    v_exp_f32 v200, v152
    v_exp_f32 v201, v153
    v_exp_f32 v202, v154
    v_exp_f32 v203, v155
    v_add_f32 v44, v44, v196
    v_add_f32 v45, v45, v197
    v_add_f32 v44, v44, v198
    v_add_f32 v45, v45, v199
    v_cvt_pk_bf16_f32 v178, v196, v197
    v_cvt_pk_bf16_f32 v179, v198, v199
    v_exp_f32 v204, v156
    v_exp_f32 v205, v157
    v_exp_f32 v206, v158
    v_exp_f32 v207, v159
    v_add_f32 v44, v44, v200
    v_add_f32 v45, v45, v201
    v_add_f32 v44, v44, v202
    v_add_f32 v45, v45, v203
    v_add_f32 v44, v44, v204
    v_add_f32 v45, v45, v205
    v_add_f32 v44, v44, v206
    v_add_f32 v45, v45, v207
    v_add_f32 v44, v44, v45
    v_cmp_nge_f32 vcc, s37, v44
    v_cvt_pk_bf16_f32 v180, v200, v201
    v_cvt_pk_bf16_f32 v181, v202, v203
    v_cvt_pk_bf16_f32 v182, v204, v205
    v_cvt_pk_bf16_f32 v183, v206, v207
    s_nop 3
    s_branch L_back0
L_rare1:
    s_nop 15
    v_max3_f32 v46, v160, v161, v162
    v_max3_f32 v47, v163, v164, v165
    v_max3_f32 v46, v46, v166, v167
    v_max3_f32 v47, v47, v168, v169
    v_max3_f32 v46, v46, v170, v171
    v_max3_f32 v47, v47, v172, v173
    v_max3_f32 v46, v46, v174, v175
    v_max_f32 v46, v46, v47
    v_mov_b32 v47, v46
    s_nop 1
    v_permlane32_swap_b32 v46, v47
    v_max_f32 v46, v46, v47
    v_max_f32 v46, 0, v46
    v_exp_f32 v43, -v46
    v_sub_f32 v160, v160, v46
    v_sub_f32 v161, v161, v46
    v_sub_f32 v162, v162, v46
    v_sub_f32 v163, v163, v46
    v_sub_f32 v164, v164, v46
    v_sub_f32 v165, v165, v46
    v_sub_f32 v166, v166, v46
    v_sub_f32 v167, v167, v46
    v_sub_f32 v168, v168, v46
    v_sub_f32 v169, v169, v46
    v_sub_f32 v170, v170, v46
    v_sub_f32 v171, v171, v46
    v_sub_f32 v172, v172, v46
    v_sub_f32 v173, v173, v46
    v_sub_f32 v174, v174, v46
    v_sub_f32 v175, v175, v46
    v_sub_f32 v144, v144, v46
    v_sub_f32 v145, v145, v46
    v_sub_f32 v146, v146, v46
    v_sub_f32 v147, v147, v46
    v_sub_f32 v148, v148, v46
    v_sub_f32 v149, v149, v46
    v_sub_f32 v150, v150, v46
    v_sub_f32 v151, v151, v46
    v_sub_f32 v152, v152, v46
    v_sub_f32 v153, v153, v46
    v_sub_f32 v154, v154, v46
    v_sub_f32 v155, v155, v46
    v_sub_f32 v156, v156, v46
    v_sub_f32 v157, v157, v46
    v_sub_f32 v158, v158, v46
    v_sub_f32 v159, v159, v46
    v_sub_f32 v208, v208, v46
    v_sub_f32 v209, v209, v46
    v_sub_f32 v210, v210, v46
    v_sub_f32 v211, v211, v46
    v_sub_f32 v212, v212, v46
    v_sub_f32 v213, v213, v46
    v_sub_f32 v214, v214, v46
    v_sub_f32 v215, v215, v46
    v_sub_f32 v216, v216, v46
    v_sub_f32 v217, v217, v46
    v_sub_f32 v218, v218, v46
    v_sub_f32 v219, v219, v46
    v_sub_f32 v220, v220, v46
    v_sub_f32 v221, v221, v46
    v_sub_f32 v222, v222, v46
    v_sub_f32 v223, v223, v46
    v_mul_f32 v41, v43, v41
    v_mul_f32 v48, v43, v48
    v_mul_f32 v49, v43, v49
    v_mul_f32 v50, v43, v50
    v_mul_f32 v51, v43, v51
    v_mul_f32 v52, v43, v52
    v_mul_f32 v53, v43, v53
    v_mul_f32 v54, v43, v54
    v_mul_f32 v55, v43, v55
    v_mul_f32 v56, v43, v56
    v_mul_f32 v57, v43, v57
    v_mul_f32 v58, v43, v58
    v_mul_f32 v59, v43, v59
    v_mul_f32 v60, v43, v60
    v_mul_f32 v61, v43, v61
    v_mul_f32 v62, v43, v62
    v_mul_f32 v63, v43, v63
    v_mul_f32 v64, v43, v64
    v_mul_f32 v65, v43, v65
    v_mul_f32 v66, v43, v66
    v_mul_f32 v67, v43, v67
    v_mul_f32 v68, v43, v68
    v_mul_f32 v69, v43, v69
    v_mul_f32 v70, v43, v70
    v_mul_f32 v71, v43, v71
    v_mul_f32 v72, v43, v72
    v_mul_f32 v73, v43, v73
    v_mul_f32 v74, v43, v74
    v_mul_f32 v75, v43, v75
    v_mul_f32 v76, v43, v76
    v_mul_f32 v77, v43, v77
    v_mul_f32 v78, v43, v78
    v_mul_f32 v79, v43, v79
    v_mul_f32 v80, v43, v80
    v_mul_f32 v81, v43, v81
    v_mul_f32 v82, v43, v82
    v_mul_f32 v83, v43, v83
    v_mul_f32 v84, v43, v84
    v_mul_f32 v85, v43, v85
    v_mul_f32 v86, v43, v86
    v_mul_f32 v87, v43, v87
    v_mul_f32 v88, v43, v88
    v_mul_f32 v89, v43, v89
    v_mul_f32 v90, v43, v90
    v_mul_f32 v91, v43, v91
    v_mul_f32 v92, v43, v92
    v_mul_f32 v93, v43, v93
    v_mul_f32 v94, v43, v94
    v_mul_f32 v95, v43, v95
    v_mul_f32 v96, v43, v96
    v_mul_f32 v97, v43, v97
    v_mul_f32 v98, v43, v98
    v_mul_f32 v99, v43, v99
    v_mul_f32 v100, v43, v100
    v_mul_f32 v101, v43, v101
    v_mul_f32 v102, v43, v102
    v_mul_f32 v103, v43, v103
    v_mul_f32 v104, v43, v104
    v_mul_f32 v105, v43, v105
    v_mul_f32 v106, v43, v106
    v_mul_f32 v107, v43, v107
    v_mul_f32 v108, v43, v108
    v_mul_f32 v109, v43, v109
    v_mul_f32 v110, v43, v110
    v_mul_f32 v111, v43, v111
    v_exp_f32 v192, v160
    v_exp_f32 v193, v161
    v_exp_f32 v194, v162
    v_exp_f32 v195, v163
    v_exp_f32 v196, v164
    v_exp_f32 v197, v165
    v_exp_f32 v198, v166
    v_exp_f32 v199, v167
    v_add_f32 v44, v192, v193
    v_add_f32 v45, v194, v195
    v_cvt_pk_bf16_f32 v184, v192, v193
    v_cvt_pk_bf16_f32 v185, v194, v195
    v_exp_f32 v200, v168
    v_exp_f32 v201, v169
    v_exp_f32 v202, v170
    v_exp_f32 v203, v171
    v_add_f32 v44, v44, v196
    v_add_f32 v45, v45, v197
    v_add_f32 v44, v44, v198
    v_add_f32 v45, v45, v199
    v_cvt_pk_bf16_f32 v186, v196, v197
    v_cvt_pk_bf16_f32 v187, v198, v199
    v_exp_f32 v204, v172
    v_exp_f32 v205, v173
    v_exp_f32 v206, v174
    v_exp_f32 v207, v175
    v_add_f32 v44, v44, v200
    v_add_f32 v45, v45, v201
    v_add_f32 v44, v44, v202
    v_add_f32 v45, v45, v203
    v_add_f32 v44, v44, v204
    v_add_f32 v45, v45, v205
    v_add_f32 v44, v44, v206
    v_add_f32 v45, v45, v207
    v_add_f32 v44, v44, v45
    v_cmp_nge_f32 vcc, s37, v44
    v_cvt_pk_bf16_f32 v188, v200, v201
    v_cvt_pk_bf16_f32 v189, v202, v203
    v_cvt_pk_bf16_f32 v190, v204, v205
    v_cvt_pk_bf16_f32 v191, v206, v207
    s_nop 3
    s_branch L_back1
L_rare2:
    s_nop 15
    v_max3_f32 v46, v144, v145, v146
    v_max3_f32 v47, v147, v148, v149
    v_max3_f32 v46, v46, v150, v151
    v_max3_f32 v47, v47, v152, v153
    v_max3_f32 v46, v46, v154, v155
    v_max3_f32 v47, v47, v156, v157
    v_max3_f32 v46, v46, v158, v159
    v_max_f32 v46, v46, v47
    v_mov_b32 v47, v46
    s_nop 1
    v_permlane32_swap_b32 v46, v47
    v_max_f32 v46, v46, v47
    v_max_f32 v46, 0, v46
    v_exp_f32 v43, -v46
    v_sub_f32 v144, v144, v46
    v_sub_f32 v145, v145, v46
    v_sub_f32 v146, v146, v46
    v_sub_f32 v147, v147, v46
    v_sub_f32 v148, v148, v46
    v_sub_f32 v149, v149, v46
    v_sub_f32 v150, v150, v46
    v_sub_f32 v151, v151, v46
    v_sub_f32 v152, v152, v46
    v_sub_f32 v153, v153, v46
    v_sub_f32 v154, v154, v46
    v_sub_f32 v155, v155, v46
    v_sub_f32 v156, v156, v46
    v_sub_f32 v157, v157, v46
    v_sub_f32 v158, v158, v46
    v_sub_f32 v159, v159, v46
    v_sub_f32 v160, v160, v46
    v_sub_f32 v161, v161, v46
    v_sub_f32 v162, v162, v46
    v_sub_f32 v163, v163, v46
    v_sub_f32 v164, v164, v46
    v_sub_f32 v165, v165, v46
    v_sub_f32 v166, v166, v46
    v_sub_f32 v167, v167, v46
    v_sub_f32 v168, v168, v46
    v_sub_f32 v169, v169, v46
    v_sub_f32 v170, v170, v46
    v_sub_f32 v171, v171, v46
    v_sub_f32 v172, v172, v46
    v_sub_f32 v173, v173, v46
    v_sub_f32 v174, v174, v46
    v_sub_f32 v175, v175, v46
    v_sub_f32 v208, v208, v46
    v_sub_f32 v209, v209, v46
    v_sub_f32 v210, v210, v46
    v_sub_f32 v211, v211, v46
    v_sub_f32 v212, v212, v46
    v_sub_f32 v213, v213, v46
    v_sub_f32 v214, v214, v46
    v_sub_f32 v215, v215, v46
    v_sub_f32 v216, v216, v46
    v_sub_f32 v217, v217, v46
    v_sub_f32 v218, v218, v46
    v_sub_f32 v219, v219, v46
    v_sub_f32 v220, v220, v46
    v_sub_f32 v221, v221, v46
    v_sub_f32 v222, v222, v46
    v_sub_f32 v223, v223, v46
    v_mul_f32 v41, v43, v41
    v_mul_f32 v48, v43, v48
    v_mul_f32 v49, v43, v49
    v_mul_f32 v50, v43, v50
    v_mul_f32 v51, v43, v51
    v_mul_f32 v52, v43, v52
    v_mul_f32 v53, v43, v53
    v_mul_f32 v54, v43, v54
    v_mul_f32 v55, v43, v55
    v_mul_f32 v56, v43, v56
    v_mul_f32 v57, v43, v57
    v_mul_f32 v58, v43, v58
    v_mul_f32 v59, v43, v59
    v_mul_f32 v60, v43, v60
    v_mul_f32 v61, v43, v61
    v_mul_f32 v62, v43, v62
    v_mul_f32 v63, v43, v63
    v_mul_f32 v64, v43, v64
    v_mul_f32 v65, v43, v65
    v_mul_f32 v66, v43, v66
    v_mul_f32 v67, v43, v67
    v_mul_f32 v68, v43, v68
    v_mul_f32 v69, v43, v69
    v_mul_f32 v70, v43, v70
    v_mul_f32 v71, v43, v71
    v_mul_f32 v72, v43, v72
    v_mul_f32 v73, v43, v73
    v_mul_f32 v74, v43, v74
    v_mul_f32 v75, v43, v75
    v_mul_f32 v76, v43, v76
    v_mul_f32 v77, v43, v77
    v_mul_f32 v78, v43, v78
    v_mul_f32 v79, v43, v79
    v_mul_f32 v80, v43, v80
    v_mul_f32 v81, v43, v81
    v_mul_f32 v82, v43, v82
    v_mul_f32 v83, v43, v83
    v_mul_f32 v84, v43, v84
    v_mul_f32 v85, v43, v85
    v_mul_f32 v86, v43, v86
    v_mul_f32 v87, v43, v87
    v_mul_f32 v88, v43, v88
    v_mul_f32 v89, v43, v89
    v_mul_f32 v90, v43, v90
    v_mul_f32 v91, v43, v91
    v_mul_f32 v92, v43, v92
    v_mul_f32 v93, v43, v93
    v_mul_f32 v94, v43, v94
    v_mul_f32 v95, v43, v95
    v_mul_f32 v96, v43, v96
    v_mul_f32 v97, v43, v97
    v_mul_f32 v98, v43, v98
    v_mul_f32 v99, v43, v99
    v_mul_f32 v100, v43, v100
    v_mul_f32 v101, v43, v101
    v_mul_f32 v102, v43, v102
    v_mul_f32 v103, v43, v103
    v_mul_f32 v104, v43, v104
    v_mul_f32 v105, v43, v105
    v_mul_f32 v106, v43, v106
    v_mul_f32 v107, v43, v107
    v_mul_f32 v108, v43, v108
    v_mul_f32 v109, v43, v109
    v_mul_f32 v110, v43, v110
    v_mul_f32 v111, v43, v111
    v_exp_f32 v192, v144
    v_exp_f32 v193, v145
    v_exp_f32 v194, v146
    v_exp_f32 v195, v147
    v_exp_f32 v196, v148
    v_exp_f32 v197, v149
    v_exp_f32 v198, v150
    v_exp_f32 v199, v151
    v_add_f32 v44, v192, v193
    v_add_f32 v45, v194, v195
    v_cvt_pk_bf16_f32 v176, v192, v193
    v_cvt_pk_bf16_f32 v177, v194, v195
    v_exp_f32 v200, v152
    v_exp_f32 v201, v153
    v_exp_f32 v202, v154
    v_exp_f32 v203, v155
    v_add_f32 v44, v44, v196
    v_add_f32 v45, v45, v197
    v_add_f32 v44, v44, v198
    v_add_f32 v45, v45, v199
    v_cvt_pk_bf16_f32 v178, v196, v197
    v_cvt_pk_bf16_f32 v179, v198, v199
    v_exp_f32 v204, v156
    v_exp_f32 v205, v157
    v_exp_f32 v206, v158
    v_exp_f32 v207, v159
    v_add_f32 v44, v44, v200
    v_add_f32 v45, v45, v201
    v_add_f32 v44, v44, v202
    v_add_f32 v45, v45, v203
    v_add_f32 v44, v44, v204
    v_add_f32 v45, v45, v205
    v_add_f32 v44, v44, v206
    v_add_f32 v45, v45, v207
    v_add_f32 v44, v44, v45
    v_cmp_nge_f32 vcc, s37, v44
    v_cvt_pk_bf16_f32 v180, v200, v201
    v_cvt_pk_bf16_f32 v181, v202, v203
    v_cvt_pk_bf16_f32 v182, v204, v205
    v_cvt_pk_bf16_f32 v183, v206, v207
    s_nop 3
    s_branch L_back2
L_rare3:
    s_nop 15
    v_max3_f32 v46, v160, v161, v162
    v_max3_f32 v47, v163, v164, v165
    v_max3_f32 v46, v46, v166, v167
    v_max3_f32 v47, v47, v168, v169
    v_max3_f32 v46, v46, v170, v171
    v_max3_f32 v47, v47, v172, v173
    v_max3_f32 v46, v46, v174, v175
    v_max_f32 v46, v46, v47
    v_mov_b32 v47, v46
    s_nop 1
    v_permlane32_swap_b32 v46, v47
    v_max_f32 v46, v46, v47
    v_max_f32 v46, 0, v46
    v_exp_f32 v43, -v46
    v_sub_f32 v160, v160, v46
    v_sub_f32 v161, v161, v46
    v_sub_f32 v162, v162, v46
    v_sub_f32 v163, v163, v46
    v_sub_f32 v164, v164, v46
    v_sub_f32 v165, v165, v46
    v_sub_f32 v166, v166, v46
    v_sub_f32 v167, v167, v46
    v_sub_f32 v168, v168, v46
    v_sub_f32 v169, v169, v46
    v_sub_f32 v170, v170, v46
    v_sub_f32 v171, v171, v46
    v_sub_f32 v172, v172, v46
    v_sub_f32 v173, v173, v46
    v_sub_f32 v174, v174, v46
    v_sub_f32 v175, v175, v46
    v_sub_f32 v144, v144, v46
    v_sub_f32 v145, v145, v46
    v_sub_f32 v146, v146, v46
    v_sub_f32 v147, v147, v46
    v_sub_f32 v148, v148, v46
    v_sub_f32 v149, v149, v46
    v_sub_f32 v150, v150, v46
    v_sub_f32 v151, v151, v46
    v_sub_f32 v152, v152, v46
    v_sub_f32 v153, v153, v46
    v_sub_f32 v154, v154, v46
    v_sub_f32 v155, v155, v46
    v_sub_f32 v156, v156, v46
    v_sub_f32 v157, v157, v46
    v_sub_f32 v158, v158, v46
    v_sub_f32 v159, v159, v46
    v_sub_f32 v208, v208, v46
    v_sub_f32 v209, v209, v46
    v_sub_f32 v210, v210, v46
    v_sub_f32 v211, v211, v46
    v_sub_f32 v212, v212, v46
    v_sub_f32 v213, v213, v46
    v_sub_f32 v214, v214, v46
    v_sub_f32 v215, v215, v46
    v_sub_f32 v216, v216, v46
    v_sub_f32 v217, v217, v46
    v_sub_f32 v218, v218, v46
    v_sub_f32 v219, v219, v46
    v_sub_f32 v220, v220, v46
    v_sub_f32 v221, v221, v46
    v_sub_f32 v222, v222, v46
    v_sub_f32 v223, v223, v46
    v_mul_f32 v41, v43, v41
    v_mul_f32 v48, v43, v48
    v_mul_f32 v49, v43, v49
    v_mul_f32 v50, v43, v50
    v_mul_f32 v51, v43, v51
    v_mul_f32 v52, v43, v52
    v_mul_f32 v53, v43, v53
    v_mul_f32 v54, v43, v54
    v_mul_f32 v55, v43, v55
    v_mul_f32 v56, v43, v56
    v_mul_f32 v57, v43, v57
    v_mul_f32 v58, v43, v58
    v_mul_f32 v59, v43, v59
    v_mul_f32 v60, v43, v60
    v_mul_f32 v61, v43, v61
    v_mul_f32 v62, v43, v62
    v_mul_f32 v63, v43, v63
    v_mul_f32 v64, v43, v64
    v_mul_f32 v65, v43, v65
    v_mul_f32 v66, v43, v66
    v_mul_f32 v67, v43, v67
    v_mul_f32 v68, v43, v68
    v_mul_f32 v69, v43, v69
    v_mul_f32 v70, v43, v70
    v_mul_f32 v71, v43, v71
    v_mul_f32 v72, v43, v72
    v_mul_f32 v73, v43, v73
    v_mul_f32 v74, v43, v74
    v_mul_f32 v75, v43, v75
    v_mul_f32 v76, v43, v76
    v_mul_f32 v77, v43, v77
    v_mul_f32 v78, v43, v78
    v_mul_f32 v79, v43, v79
    v_mul_f32 v80, v43, v80
    v_mul_f32 v81, v43, v81
    v_mul_f32 v82, v43, v82
    v_mul_f32 v83, v43, v83
    v_mul_f32 v84, v43, v84
    v_mul_f32 v85, v43, v85
    v_mul_f32 v86, v43, v86
    v_mul_f32 v87, v43, v87
    v_mul_f32 v88, v43, v88
    v_mul_f32 v89, v43, v89
    v_mul_f32 v90, v43, v90
    v_mul_f32 v91, v43, v91
    v_mul_f32 v92, v43, v92
    v_mul_f32 v93, v43, v93
    v_mul_f32 v94, v43, v94
    v_mul_f32 v95, v43, v95
    v_mul_f32 v96, v43, v96
    v_mul_f32 v97, v43, v97
    v_mul_f32 v98, v43, v98
    v_mul_f32 v99, v43, v99
    v_mul_f32 v100, v43, v100
    v_mul_f32 v101, v43, v101
    v_mul_f32 v102, v43, v102
    v_mul_f32 v103, v43, v103
    v_mul_f32 v104, v43, v104
    v_mul_f32 v105, v43, v105
    v_mul_f32 v106, v43, v106
    v_mul_f32 v107, v43, v107
    v_mul_f32 v108, v43, v108
    v_mul_f32 v109, v43, v109
    v_mul_f32 v110, v43, v110
    v_mul_f32 v111, v43, v111
    v_exp_f32 v192, v160
    v_exp_f32 v193, v161
    v_exp_f32 v194, v162
    v_exp_f32 v195, v163
    v_exp_f32 v196, v164
    v_exp_f32 v197, v165
    v_exp_f32 v198, v166
    v_exp_f32 v199, v167
    v_add_f32 v44, v192, v193
    v_add_f32 v45, v194, v195
    v_cvt_pk_bf16_f32 v184, v192, v193
    v_cvt_pk_bf16_f32 v185, v194, v195
    v_exp_f32 v200, v168
    v_exp_f32 v201, v169
    v_exp_f32 v202, v170
    v_exp_f32 v203, v171
    v_add_f32 v44, v44, v196
    v_add_f32 v45, v45, v197
    v_add_f32 v44, v44, v198
    v_add_f32 v45, v45, v199
    v_cvt_pk_bf16_f32 v186, v196, v197
    v_cvt_pk_bf16_f32 v187, v198, v199
    v_exp_f32 v204, v172
    v_exp_f32 v205, v173
    v_exp_f32 v206, v174
    v_exp_f32 v207, v175
    v_add_f32 v44, v44, v200
    v_add_f32 v45, v45, v201
    v_add_f32 v44, v44, v202
    v_add_f32 v45, v45, v203
    v_add_f32 v44, v44, v204
    v_add_f32 v45, v45, v205
    v_add_f32 v44, v44, v206
    v_add_f32 v45, v45, v207
    v_add_f32 v44, v44, v45
    v_cmp_nge_f32 vcc, s37, v44
    v_cvt_pk_bf16_f32 v188, v200, v201
    v_cvt_pk_bf16_f32 v189, v202, v203
    v_cvt_pk_bf16_f32 v190, v204, v205
    v_cvt_pk_bf16_f32 v191, v206, v207
    s_nop 3
    s_branch L_back3
L_rare4:
    s_nop 15
    v_max3_f32 v46, v144, v145, v146
    v_max3_f32 v47, v147, v148, v149
    v_max3_f32 v46, v46, v150, v151
    v_max3_f32 v47, v47, v152, v153
    v_max3_f32 v46, v46, v154, v155
    v_max3_f32 v47, v47, v156, v157
    v_max3_f32 v46, v46, v158, v159
    v_max_f32 v46, v46, v47
    v_mov_b32 v47, v46
    s_nop 1
    v_permlane32_swap_b32 v46, v47
    v_max_f32 v46, v46, v47
    v_max_f32 v46, 0, v46
    v_exp_f32 v43, -v46
    v_sub_f32 v144, v144, v46
    v_sub_f32 v145, v145, v46
    v_sub_f32 v146, v146, v46
    v_sub_f32 v147, v147, v46
    v_sub_f32 v148, v148, v46
    v_sub_f32 v149, v149, v46
    v_sub_f32 v150, v150, v46
    v_sub_f32 v151, v151, v46
    v_sub_f32 v152, v152, v46
    v_sub_f32 v153, v153, v46
    v_sub_f32 v154, v154, v46
    v_sub_f32 v155, v155, v46
    v_sub_f32 v156, v156, v46
    v_sub_f32 v157, v157, v46
    v_sub_f32 v158, v158, v46
    v_sub_f32 v159, v159, v46
    v_sub_f32 v160, v160, v46
    v_sub_f32 v161, v161, v46
    v_sub_f32 v162, v162, v46
    v_sub_f32 v163, v163, v46
    v_sub_f32 v164, v164, v46
    v_sub_f32 v165, v165, v46
    v_sub_f32 v166, v166, v46
    v_sub_f32 v167, v167, v46
    v_sub_f32 v168, v168, v46
    v_sub_f32 v169, v169, v46
    v_sub_f32 v170, v170, v46
    v_sub_f32 v171, v171, v46
    v_sub_f32 v172, v172, v46
    v_sub_f32 v173, v173, v46
    v_sub_f32 v174, v174, v46
    v_sub_f32 v175, v175, v46
    v_sub_f32 v208, v208, v46
    v_sub_f32 v209, v209, v46
    v_sub_f32 v210, v210, v46
    v_sub_f32 v211, v211, v46
    v_sub_f32 v212, v212, v46
    v_sub_f32 v213, v213, v46
    v_sub_f32 v214, v214, v46
    v_sub_f32 v215, v215, v46
    v_sub_f32 v216, v216, v46
    v_sub_f32 v217, v217, v46
    v_sub_f32 v218, v218, v46
    v_sub_f32 v219, v219, v46
    v_sub_f32 v220, v220, v46
    v_sub_f32 v221, v221, v46
    v_sub_f32 v222, v222, v46
    v_sub_f32 v223, v223, v46
    v_mul_f32 v41, v43, v41
    v_mul_f32 v48, v43, v48
    v_mul_f32 v49, v43, v49
    v_mul_f32 v50, v43, v50
    v_mul_f32 v51, v43, v51
    v_mul_f32 v52, v43, v52
    v_mul_f32 v53, v43, v53
    v_mul_f32 v54, v43, v54
    v_mul_f32 v55, v43, v55
    v_mul_f32 v56, v43, v56
    v_mul_f32 v57, v43, v57
    v_mul_f32 v58, v43, v58
    v_mul_f32 v59, v43, v59
    v_mul_f32 v60, v43, v60
    v_mul_f32 v61, v43, v61
    v_mul_f32 v62, v43, v62
    v_mul_f32 v63, v43, v63
    v_mul_f32 v64, v43, v64
    v_mul_f32 v65, v43, v65
    v_mul_f32 v66, v43, v66
    v_mul_f32 v67, v43, v67
    v_mul_f32 v68, v43, v68
    v_mul_f32 v69, v43, v69
    v_mul_f32 v70, v43, v70
    v_mul_f32 v71, v43, v71
    v_mul_f32 v72, v43, v72
    v_mul_f32 v73, v43, v73
    v_mul_f32 v74, v43, v74
    v_mul_f32 v75, v43, v75
    v_mul_f32 v76, v43, v76
    v_mul_f32 v77, v43, v77
    v_mul_f32 v78, v43, v78
    v_mul_f32 v79, v43, v79
    v_mul_f32 v80, v43, v80
    v_mul_f32 v81, v43, v81
    v_mul_f32 v82, v43, v82
    v_mul_f32 v83, v43, v83
    v_mul_f32 v84, v43, v84
    v_mul_f32 v85, v43, v85
    v_mul_f32 v86, v43, v86
    v_mul_f32 v87, v43, v87
    v_mul_f32 v88, v43, v88
    v_mul_f32 v89, v43, v89
    v_mul_f32 v90, v43, v90
    v_mul_f32 v91, v43, v91
    v_mul_f32 v92, v43, v92
    v_mul_f32 v93, v43, v93
    v_mul_f32 v94, v43, v94
    v_mul_f32 v95, v43, v95
    v_mul_f32 v96, v43, v96
    v_mul_f32 v97, v43, v97
    v_mul_f32 v98, v43, v98
    v_mul_f32 v99, v43, v99
    v_mul_f32 v100, v43, v100
    v_mul_f32 v101, v43, v101
    v_mul_f32 v102, v43, v102
    v_mul_f32 v103, v43, v103
    v_mul_f32 v104, v43, v104
    v_mul_f32 v105, v43, v105
    v_mul_f32 v106, v43, v106
    v_mul_f32 v107, v43, v107
    v_mul_f32 v108, v43, v108
    v_mul_f32 v109, v43, v109
    v_mul_f32 v110, v43, v110
    v_mul_f32 v111, v43, v111
    v_exp_f32 v192, v144
    v_exp_f32 v193, v145
    v_exp_f32 v194, v146
    v_exp_f32 v195, v147
    v_exp_f32 v196, v148
    v_exp_f32 v197, v149
    v_exp_f32 v198, v150
    v_exp_f32 v199, v151
    v_add_f32 v44, v192, v193
    v_add_f32 v45, v194, v195
    v_cvt_pk_bf16_f32 v176, v192, v193
    v_cvt_pk_bf16_f32 v177, v194, v195
    v_exp_f32 v200, v152
    v_exp_f32 v201, v153
    v_exp_f32 v202, v154
    v_exp_f32 v203, v155
    v_add_f32 v44, v44, v196
    v_add_f32 v45, v45, v197
    v_add_f32 v44, v44, v198
    v_add_f32 v45, v45, v199
    v_cvt_pk_bf16_f32 v178, v196, v197
    v_cvt_pk_bf16_f32 v179, v198, v199
    v_exp_f32 v204, v156
    v_exp_f32 v205, v157
    v_exp_f32 v206, v158
    v_exp_f32 v207, v159
    v_add_f32 v44, v44, v200
    v_add_f32 v45, v45, v201
    v_add_f32 v44, v44, v202
    v_add_f32 v45, v45, v203
    v_add_f32 v44, v44, v204
    v_add_f32 v45, v45, v205
    v_add_f32 v44, v44, v206
    v_add_f32 v45, v45, v207
    v_add_f32 v44, v44, v45
    v_cmp_nge_f32 vcc, s37, v44
    v_cvt_pk_bf16_f32 v180, v200, v201
    v_cvt_pk_bf16_f32 v181, v202, v203
    v_cvt_pk_bf16_f32 v182, v204, v205
    v_cvt_pk_bf16_f32 v183, v206, v207
    s_nop 3
    s_branch L_back4
L_rare5:
    s_nop 15
    v_max3_f32 v46, v160, v161, v162
    v_max3_f32 v47, v163, v164, v165
    v_max3_f32 v46, v46, v166, v167
    v_max3_f32 v47, v47, v168, v169
    v_max3_f32 v46, v46, v170, v171
    v_max3_f32 v47, v47, v172, v173
    v_max3_f32 v46, v46, v174, v175
    v_max_f32 v46, v46, v47
    v_mov_b32 v47, v46
    s_nop 1
    v_permlane32_swap_b32 v46, v47
    v_max_f32 v46, v46, v47
    v_max_f32 v46, 0, v46
    v_exp_f32 v43, -v46
    v_sub_f32 v160, v160, v46
    v_sub_f32 v161, v161, v46
    v_sub_f32 v162, v162, v46
    v_sub_f32 v163, v163, v46
    v_sub_f32 v164, v164, v46
    v_sub_f32 v165, v165, v46
    v_sub_f32 v166, v166, v46
    v_sub_f32 v167, v167, v46
    v_sub_f32 v168, v168, v46
    v_sub_f32 v169, v169, v46
    v_sub_f32 v170, v170, v46
    v_sub_f32 v171, v171, v46
    v_sub_f32 v172, v172, v46
    v_sub_f32 v173, v173, v46
    v_sub_f32 v174, v174, v46
    v_sub_f32 v175, v175, v46
    v_sub_f32 v144, v144, v46
    v_sub_f32 v145, v145, v46
    v_sub_f32 v146, v146, v46
    v_sub_f32 v147, v147, v46
    v_sub_f32 v148, v148, v46
    v_sub_f32 v149, v149, v46
    v_sub_f32 v150, v150, v46
    v_sub_f32 v151, v151, v46
    v_sub_f32 v152, v152, v46
    v_sub_f32 v153, v153, v46
    v_sub_f32 v154, v154, v46
    v_sub_f32 v155, v155, v46
    v_sub_f32 v156, v156, v46
    v_sub_f32 v157, v157, v46
    v_sub_f32 v158, v158, v46
    v_sub_f32 v159, v159, v46
    v_sub_f32 v208, v208, v46
    v_sub_f32 v209, v209, v46
    v_sub_f32 v210, v210, v46
    v_sub_f32 v211, v211, v46
    v_sub_f32 v212, v212, v46
    v_sub_f32 v213, v213, v46
    v_sub_f32 v214, v214, v46
    v_sub_f32 v215, v215, v46
    v_sub_f32 v216, v216, v46
    v_sub_f32 v217, v217, v46
    v_sub_f32 v218, v218, v46
    v_sub_f32 v219, v219, v46
    v_sub_f32 v220, v220, v46
    v_sub_f32 v221, v221, v46
    v_sub_f32 v222, v222, v46
    v_sub_f32 v223, v223, v46
    v_mul_f32 v41, v43, v41
    v_mul_f32 v48, v43, v48
    v_mul_f32 v49, v43, v49
    v_mul_f32 v50, v43, v50
    v_mul_f32 v51, v43, v51
    v_mul_f32 v52, v43, v52
    v_mul_f32 v53, v43, v53
    v_mul_f32 v54, v43, v54
    v_mul_f32 v55, v43, v55
    v_mul_f32 v56, v43, v56
    v_mul_f32 v57, v43, v57
    v_mul_f32 v58, v43, v58
    v_mul_f32 v59, v43, v59
    v_mul_f32 v60, v43, v60
    v_mul_f32 v61, v43, v61
    v_mul_f32 v62, v43, v62
    v_mul_f32 v63, v43, v63
    v_mul_f32 v64, v43, v64
    v_mul_f32 v65, v43, v65
    v_mul_f32 v66, v43, v66
    v_mul_f32 v67, v43, v67
    v_mul_f32 v68, v43, v68
    v_mul_f32 v69, v43, v69
    v_mul_f32 v70, v43, v70
    v_mul_f32 v71, v43, v71
    v_mul_f32 v72, v43, v72
    v_mul_f32 v73, v43, v73
    v_mul_f32 v74, v43, v74
    v_mul_f32 v75, v43, v75
    v_mul_f32 v76, v43, v76
    v_mul_f32 v77, v43, v77
    v_mul_f32 v78, v43, v78
    v_mul_f32 v79, v43, v79
    v_mul_f32 v80, v43, v80
    v_mul_f32 v81, v43, v81
    v_mul_f32 v82, v43, v82
    v_mul_f32 v83, v43, v83
    v_mul_f32 v84, v43, v84
    v_mul_f32 v85, v43, v85
    v_mul_f32 v86, v43, v86
    v_mul_f32 v87, v43, v87
    v_mul_f32 v88, v43, v88
    v_mul_f32 v89, v43, v89
    v_mul_f32 v90, v43, v90
    v_mul_f32 v91, v43, v91
    v_mul_f32 v92, v43, v92
    v_mul_f32 v93, v43, v93
    v_mul_f32 v94, v43, v94
    v_mul_f32 v95, v43, v95
    v_mul_f32 v96, v43, v96
    v_mul_f32 v97, v43, v97
    v_mul_f32 v98, v43, v98
    v_mul_f32 v99, v43, v99
    v_mul_f32 v100, v43, v100
    v_mul_f32 v101, v43, v101
    v_mul_f32 v102, v43, v102
    v_mul_f32 v103, v43, v103
    v_mul_f32 v104, v43, v104
    v_mul_f32 v105, v43, v105
    v_mul_f32 v106, v43, v106
    v_mul_f32 v107, v43, v107
    v_mul_f32 v108, v43, v108
    v_mul_f32 v109, v43, v109
    v_mul_f32 v110, v43, v110
    v_mul_f32 v111, v43, v111
    v_exp_f32 v192, v160
    v_exp_f32 v193, v161
    v_exp_f32 v194, v162
    v_exp_f32 v195, v163
    v_exp_f32 v196, v164
    v_exp_f32 v197, v165
    v_exp_f32 v198, v166
    v_exp_f32 v199, v167
    v_add_f32 v44, v192, v193
    v_add_f32 v45, v194, v195
    v_cvt_pk_bf16_f32 v184, v192, v193
    v_cvt_pk_bf16_f32 v185, v194, v195
    v_exp_f32 v200, v168
    v_exp_f32 v201, v169
    v_exp_f32 v202, v170
    v_exp_f32 v203, v171
    v_add_f32 v44, v44, v196
    v_add_f32 v45, v45, v197
    v_add_f32 v44, v44, v198
    v_add_f32 v45, v45, v199
    v_cvt_pk_bf16_f32 v186, v196, v197
    v_cvt_pk_bf16_f32 v187, v198, v199
    v_exp_f32 v204, v172
    v_exp_f32 v205, v173
    v_exp_f32 v206, v174
    v_exp_f32 v207, v175
    v_add_f32 v44, v44, v200
    v_add_f32 v45, v45, v201
    v_add_f32 v44, v44, v202
    v_add_f32 v45, v45, v203
    v_add_f32 v44, v44, v204
    v_add_f32 v45, v45, v205
    v_add_f32 v44, v44, v206
    v_add_f32 v45, v45, v207
    v_add_f32 v44, v44, v45
    v_cmp_nge_f32 vcc, s37, v44
    v_cvt_pk_bf16_f32 v188, v200, v201
    v_cvt_pk_bf16_f32 v189, v202, v203
    v_cvt_pk_bf16_f32 v190, v204, v205
    v_cvt_pk_bf16_f32 v191, v206, v207
    s_nop 3
    s_branch L_back5
L_rare6:
    s_nop 15
    v_max3_f32 v46, v144, v145, v146
    v_max3_f32 v47, v147, v148, v149
    v_max3_f32 v46, v46, v150, v151
    v_max3_f32 v47, v47, v152, v153
    v_max3_f32 v46, v46, v154, v155
    v_max3_f32 v47, v47, v156, v157
    v_max3_f32 v46, v46, v158, v159
    v_max_f32 v46, v46, v47
    v_mov_b32 v47, v46
    s_nop 1
    v_permlane32_swap_b32 v46, v47
    v_max_f32 v46, v46, v47
    v_max_f32 v46, 0, v46
    v_exp_f32 v43, -v46
    v_sub_f32 v144, v144, v46
    v_sub_f32 v145, v145, v46
    v_sub_f32 v146, v146, v46
    v_sub_f32 v147, v147, v46
    v_sub_f32 v148, v148, v46
    v_sub_f32 v149, v149, v46
    v_sub_f32 v150, v150, v46
    v_sub_f32 v151, v151, v46
    v_sub_f32 v152, v152, v46
    v_sub_f32 v153, v153, v46
    v_sub_f32 v154, v154, v46
    v_sub_f32 v155, v155, v46
    v_sub_f32 v156, v156, v46
    v_sub_f32 v157, v157, v46
    v_sub_f32 v158, v158, v46
    v_sub_f32 v159, v159, v46
    v_sub_f32 v160, v160, v46
    v_sub_f32 v161, v161, v46
    v_sub_f32 v162, v162, v46
    v_sub_f32 v163, v163, v46
    v_sub_f32 v164, v164, v46
    v_sub_f32 v165, v165, v46
    v_sub_f32 v166, v166, v46
    v_sub_f32 v167, v167, v46
    v_sub_f32 v168, v168, v46
    v_sub_f32 v169, v169, v46
    v_sub_f32 v170, v170, v46
    v_sub_f32 v171, v171, v46
    v_sub_f32 v172, v172, v46
    v_sub_f32 v173, v173, v46
    v_sub_f32 v174, v174, v46
    v_sub_f32 v175, v175, v46
    v_sub_f32 v208, v208, v46
    v_sub_f32 v209, v209, v46
    v_sub_f32 v210, v210, v46
    v_sub_f32 v211, v211, v46
    v_sub_f32 v212, v212, v46
    v_sub_f32 v213, v213, v46
    v_sub_f32 v214, v214, v46
    v_sub_f32 v215, v215, v46
    v_sub_f32 v216, v216, v46
    v_sub_f32 v217, v217, v46
    v_sub_f32 v218, v218, v46
    v_sub_f32 v219, v219, v46
    v_sub_f32 v220, v220, v46
    v_sub_f32 v221, v221, v46
    v_sub_f32 v222, v222, v46
    v_sub_f32 v223, v223, v46
    v_mul_f32 v41, v43, v41
    v_mul_f32 v48, v43, v48
    v_mul_f32 v49, v43, v49
    v_mul_f32 v50, v43, v50
    v_mul_f32 v51, v43, v51
    v_mul_f32 v52, v43, v52
    v_mul_f32 v53, v43, v53
    v_mul_f32 v54, v43, v54
    v_mul_f32 v55, v43, v55
    v_mul_f32 v56, v43, v56
    v_mul_f32 v57, v43, v57
    v_mul_f32 v58, v43, v58
    v_mul_f32 v59, v43, v59
    v_mul_f32 v60, v43, v60
    v_mul_f32 v61, v43, v61
    v_mul_f32 v62, v43, v62
    v_mul_f32 v63, v43, v63
    v_mul_f32 v64, v43, v64
    v_mul_f32 v65, v43, v65
    v_mul_f32 v66, v43, v66
    v_mul_f32 v67, v43, v67
    v_mul_f32 v68, v43, v68
    v_mul_f32 v69, v43, v69
    v_mul_f32 v70, v43, v70
    v_mul_f32 v71, v43, v71
    v_mul_f32 v72, v43, v72
    v_mul_f32 v73, v43, v73
    v_mul_f32 v74, v43, v74
    v_mul_f32 v75, v43, v75
    v_mul_f32 v76, v43, v76
    v_mul_f32 v77, v43, v77
    v_mul_f32 v78, v43, v78
    v_mul_f32 v79, v43, v79
    v_mul_f32 v80, v43, v80
    v_mul_f32 v81, v43, v81
    v_mul_f32 v82, v43, v82
    v_mul_f32 v83, v43, v83
    v_mul_f32 v84, v43, v84
    v_mul_f32 v85, v43, v85
    v_mul_f32 v86, v43, v86
    v_mul_f32 v87, v43, v87
    v_mul_f32 v88, v43, v88
    v_mul_f32 v89, v43, v89
    v_mul_f32 v90, v43, v90
    v_mul_f32 v91, v43, v91
    v_mul_f32 v92, v43, v92
    v_mul_f32 v93, v43, v93
    v_mul_f32 v94, v43, v94
    v_mul_f32 v95, v43, v95
    v_mul_f32 v96, v43, v96
    v_mul_f32 v97, v43, v97
    v_mul_f32 v98, v43, v98
    v_mul_f32 v99, v43, v99
    v_mul_f32 v100, v43, v100
    v_mul_f32 v101, v43, v101
    v_mul_f32 v102, v43, v102
    v_mul_f32 v103, v43, v103
    v_mul_f32 v104, v43, v104
    v_mul_f32 v105, v43, v105
    v_mul_f32 v106, v43, v106
    v_mul_f32 v107, v43, v107
    v_mul_f32 v108, v43, v108
    v_mul_f32 v109, v43, v109
    v_mul_f32 v110, v43, v110
    v_mul_f32 v111, v43, v111
    v_exp_f32 v192, v144
    v_exp_f32 v193, v145
    v_exp_f32 v194, v146
    v_exp_f32 v195, v147
    v_exp_f32 v196, v148
    v_exp_f32 v197, v149
    v_exp_f32 v198, v150
    v_exp_f32 v199, v151
    v_add_f32 v44, v192, v193
    v_add_f32 v45, v194, v195
    v_cvt_pk_bf16_f32 v176, v192, v193
    v_cvt_pk_bf16_f32 v177, v194, v195
    v_exp_f32 v200, v152
    v_exp_f32 v201, v153
    v_exp_f32 v202, v154
    v_exp_f32 v203, v155
    v_add_f32 v44, v44, v196
    v_add_f32 v45, v45, v197
    v_add_f32 v44, v44, v198
    v_add_f32 v45, v45, v199
    v_cvt_pk_bf16_f32 v178, v196, v197
    v_cvt_pk_bf16_f32 v179, v198, v199
    v_exp_f32 v204, v156
    v_exp_f32 v205, v157
    v_exp_f32 v206, v158
    v_exp_f32 v207, v159
    v_add_f32 v44, v44, v200
    v_add_f32 v45, v45, v201
    v_add_f32 v44, v44, v202
    v_add_f32 v45, v45, v203
    v_add_f32 v44, v44, v204
    v_add_f32 v45, v45, v205
    v_add_f32 v44, v44, v206
    v_add_f32 v45, v45, v207
    v_add_f32 v44, v44, v45
    v_cmp_nge_f32 vcc, s37, v44
    v_cvt_pk_bf16_f32 v180, v200, v201
    v_cvt_pk_bf16_f32 v181, v202, v203
    v_cvt_pk_bf16_f32 v182, v204, v205
    v_cvt_pk_bf16_f32 v183, v206, v207
    s_nop 3
    s_branch L_back6
L_rare7:
    s_nop 15
    v_max3_f32 v46, v160, v161, v162
    v_max3_f32 v47, v163, v164, v165
    v_max3_f32 v46, v46, v166, v167
    v_max3_f32 v47, v47, v168, v169
    v_max3_f32 v46, v46, v170, v171
    v_max3_f32 v47, v47, v172, v173
    v_max3_f32 v46, v46, v174, v175
    v_max_f32 v46, v46, v47
    v_mov_b32 v47, v46
    s_nop 1
    v_permlane32_swap_b32 v46, v47
    v_max_f32 v46, v46, v47
    v_max_f32 v46, 0, v46
    v_exp_f32 v43, -v46
    v_sub_f32 v160, v160, v46
    v_sub_f32 v161, v161, v46
    v_sub_f32 v162, v162, v46
    v_sub_f32 v163, v163, v46
    v_sub_f32 v164, v164, v46
    v_sub_f32 v165, v165, v46
    v_sub_f32 v166, v166, v46
    v_sub_f32 v167, v167, v46
    v_sub_f32 v168, v168, v46
    v_sub_f32 v169, v169, v46
    v_sub_f32 v170, v170, v46
    v_sub_f32 v171, v171, v46
    v_sub_f32 v172, v172, v46
    v_sub_f32 v173, v173, v46
    v_sub_f32 v174, v174, v46
    v_sub_f32 v175, v175, v46
    v_sub_f32 v144, v144, v46
    v_sub_f32 v145, v145, v46
    v_sub_f32 v146, v146, v46
    v_sub_f32 v147, v147, v46
    v_sub_f32 v148, v148, v46
    v_sub_f32 v149, v149, v46
    v_sub_f32 v150, v150, v46
    v_sub_f32 v151, v151, v46
    v_sub_f32 v152, v152, v46
    v_sub_f32 v153, v153, v46
    v_sub_f32 v154, v154, v46
    v_sub_f32 v155, v155, v46
    v_sub_f32 v156, v156, v46
    v_sub_f32 v157, v157, v46
    v_sub_f32 v158, v158, v46
    v_sub_f32 v159, v159, v46
    v_sub_f32 v208, v208, v46
    v_sub_f32 v209, v209, v46
    v_sub_f32 v210, v210, v46
    v_sub_f32 v211, v211, v46
    v_sub_f32 v212, v212, v46
    v_sub_f32 v213, v213, v46
    v_sub_f32 v214, v214, v46
    v_sub_f32 v215, v215, v46
    v_sub_f32 v216, v216, v46
    v_sub_f32 v217, v217, v46
    v_sub_f32 v218, v218, v46
    v_sub_f32 v219, v219, v46
    v_sub_f32 v220, v220, v46
    v_sub_f32 v221, v221, v46
    v_sub_f32 v222, v222, v46
    v_sub_f32 v223, v223, v46
    v_mul_f32 v41, v43, v41
    v_mul_f32 v48, v43, v48
    v_mul_f32 v49, v43, v49
    v_mul_f32 v50, v43, v50
    v_mul_f32 v51, v43, v51
    v_mul_f32 v52, v43, v52
    v_mul_f32 v53, v43, v53
    v_mul_f32 v54, v43, v54
    v_mul_f32 v55, v43, v55
    v_mul_f32 v56, v43, v56
    v_mul_f32 v57, v43, v57
    v_mul_f32 v58, v43, v58
    v_mul_f32 v59, v43, v59
    v_mul_f32 v60, v43, v60
    v_mul_f32 v61, v43, v61
    v_mul_f32 v62, v43, v62
    v_mul_f32 v63, v43, v63
    v_mul_f32 v64, v43, v64
    v_mul_f32 v65, v43, v65
    v_mul_f32 v66, v43, v66
    v_mul_f32 v67, v43, v67
    v_mul_f32 v68, v43, v68
    v_mul_f32 v69, v43, v69
    v_mul_f32 v70, v43, v70
    v_mul_f32 v71, v43, v71
    v_mul_f32 v72, v43, v72
    v_mul_f32 v73, v43, v73
    v_mul_f32 v74, v43, v74
    v_mul_f32 v75, v43, v75
    v_mul_f32 v76, v43, v76
    v_mul_f32 v77, v43, v77
    v_mul_f32 v78, v43, v78
    v_mul_f32 v79, v43, v79
    v_mul_f32 v80, v43, v80
    v_mul_f32 v81, v43, v81
    v_mul_f32 v82, v43, v82
    v_mul_f32 v83, v43, v83
    v_mul_f32 v84, v43, v84
    v_mul_f32 v85, v43, v85
    v_mul_f32 v86, v43, v86
    v_mul_f32 v87, v43, v87
    v_mul_f32 v88, v43, v88
    v_mul_f32 v89, v43, v89
    v_mul_f32 v90, v43, v90
    v_mul_f32 v91, v43, v91
    v_mul_f32 v92, v43, v92
    v_mul_f32 v93, v43, v93
    v_mul_f32 v94, v43, v94
    v_mul_f32 v95, v43, v95
    v_mul_f32 v96, v43, v96
    v_mul_f32 v97, v43, v97
    v_mul_f32 v98, v43, v98
    v_mul_f32 v99, v43, v99
    v_mul_f32 v100, v43, v100
    v_mul_f32 v101, v43, v101
    v_mul_f32 v102, v43, v102
    v_mul_f32 v103, v43, v103
    v_mul_f32 v104, v43, v104
    v_mul_f32 v105, v43, v105
    v_mul_f32 v106, v43, v106
    v_mul_f32 v107, v43, v107
    v_mul_f32 v108, v43, v108
    v_mul_f32 v109, v43, v109
    v_mul_f32 v110, v43, v110
    v_mul_f32 v111, v43, v111
    v_exp_f32 v192, v160
    v_exp_f32 v193, v161
    v_exp_f32 v194, v162
    v_exp_f32 v195, v163
    v_exp_f32 v196, v164
    v_exp_f32 v197, v165
    v_exp_f32 v198, v166
    v_exp_f32 v199, v167
    v_add_f32 v44, v192, v193
    v_add_f32 v45, v194, v195
    v_cvt_pk_bf16_f32 v184, v192, v193
    v_cvt_pk_bf16_f32 v185, v194, v195
    v_exp_f32 v200, v168
    v_exp_f32 v201, v169
    v_exp_f32 v202, v170
    v_exp_f32 v203, v171
    v_add_f32 v44, v44, v196
    v_add_f32 v45, v45, v197
    v_add_f32 v44, v44, v198
    v_add_f32 v45, v45, v199
    v_cvt_pk_bf16_f32 v186, v196, v197
    v_cvt_pk_bf16_f32 v187, v198, v199
    v_exp_f32 v204, v172
    v_exp_f32 v205, v173
    v_exp_f32 v206, v174
    v_exp_f32 v207, v175
    v_add_f32 v44, v44, v200
    v_add_f32 v45, v45, v201
    v_add_f32 v44, v44, v202
    v_add_f32 v45, v45, v203
    v_add_f32 v44, v44, v204
    v_add_f32 v45, v45, v205
    v_add_f32 v44, v44, v206
    v_add_f32 v45, v45, v207
    v_add_f32 v44, v44, v45
    v_cmp_nge_f32 vcc, s37, v44
    v_cvt_pk_bf16_f32 v188, v200, v201
    v_cvt_pk_bf16_f32 v189, v202, v203
    v_cvt_pk_bf16_f32 v190, v204, v205
    v_cvt_pk_bf16_f32 v191, v206, v207
    s_nop 3
    s_branch L_back7
L_rare8:
    s_nop 15
    v_max3_f32 v46, v144, v145, v146
    v_max3_f32 v47, v147, v148, v149
    v_max3_f32 v46, v46, v150, v151
    v_max3_f32 v47, v47, v152, v153
    v_max3_f32 v46, v46, v154, v155
    v_max3_f32 v47, v47, v156, v157
    v_max3_f32 v46, v46, v158, v159
    v_max_f32 v46, v46, v47
    v_mov_b32 v47, v46
    s_nop 1
    v_permlane32_swap_b32 v46, v47
    v_max_f32 v46, v46, v47
    v_max_f32 v46, 0, v46
    v_exp_f32 v43, -v46
    v_sub_f32 v144, v144, v46
    v_sub_f32 v145, v145, v46
    v_sub_f32 v146, v146, v46
    v_sub_f32 v147, v147, v46
    v_sub_f32 v148, v148, v46
    v_sub_f32 v149, v149, v46
    v_sub_f32 v150, v150, v46
    v_sub_f32 v151, v151, v46
    v_sub_f32 v152, v152, v46
    v_sub_f32 v153, v153, v46
    v_sub_f32 v154, v154, v46
    v_sub_f32 v155, v155, v46
    v_sub_f32 v156, v156, v46
    v_sub_f32 v157, v157, v46
    v_sub_f32 v158, v158, v46
    v_sub_f32 v159, v159, v46
    v_sub_f32 v160, v160, v46
    v_sub_f32 v161, v161, v46
    v_sub_f32 v162, v162, v46
    v_sub_f32 v163, v163, v46
    v_sub_f32 v164, v164, v46
    v_sub_f32 v165, v165, v46
    v_sub_f32 v166, v166, v46
    v_sub_f32 v167, v167, v46
    v_sub_f32 v168, v168, v46
    v_sub_f32 v169, v169, v46
    v_sub_f32 v170, v170, v46
    v_sub_f32 v171, v171, v46
    v_sub_f32 v172, v172, v46
    v_sub_f32 v173, v173, v46
    v_sub_f32 v174, v174, v46
    v_sub_f32 v175, v175, v46
    v_sub_f32 v208, v208, v46
    v_sub_f32 v209, v209, v46
    v_sub_f32 v210, v210, v46
    v_sub_f32 v211, v211, v46
    v_sub_f32 v212, v212, v46
    v_sub_f32 v213, v213, v46
    v_sub_f32 v214, v214, v46
    v_sub_f32 v215, v215, v46
    v_sub_f32 v216, v216, v46
    v_sub_f32 v217, v217, v46
    v_sub_f32 v218, v218, v46
    v_sub_f32 v219, v219, v46
    v_sub_f32 v220, v220, v46
    v_sub_f32 v221, v221, v46
    v_sub_f32 v222, v222, v46
    v_sub_f32 v223, v223, v46
    v_mul_f32 v41, v43, v41
    v_mul_f32 v48, v43, v48
    v_mul_f32 v49, v43, v49
    v_mul_f32 v50, v43, v50
    v_mul_f32 v51, v43, v51
    v_mul_f32 v52, v43, v52
    v_mul_f32 v53, v43, v53
    v_mul_f32 v54, v43, v54
    v_mul_f32 v55, v43, v55
    v_mul_f32 v56, v43, v56
    v_mul_f32 v57, v43, v57
    v_mul_f32 v58, v43, v58
    v_mul_f32 v59, v43, v59
    v_mul_f32 v60, v43, v60
    v_mul_f32 v61, v43, v61
    v_mul_f32 v62, v43, v62
    v_mul_f32 v63, v43, v63
    v_mul_f32 v64, v43, v64
    v_mul_f32 v65, v43, v65
    v_mul_f32 v66, v43, v66
    v_mul_f32 v67, v43, v67
    v_mul_f32 v68, v43, v68
    v_mul_f32 v69, v43, v69
    v_mul_f32 v70, v43, v70
    v_mul_f32 v71, v43, v71
    v_mul_f32 v72, v43, v72
    v_mul_f32 v73, v43, v73
    v_mul_f32 v74, v43, v74
    v_mul_f32 v75, v43, v75
    v_mul_f32 v76, v43, v76
    v_mul_f32 v77, v43, v77
    v_mul_f32 v78, v43, v78
    v_mul_f32 v79, v43, v79
    v_mul_f32 v80, v43, v80
    v_mul_f32 v81, v43, v81
    v_mul_f32 v82, v43, v82
    v_mul_f32 v83, v43, v83
    v_mul_f32 v84, v43, v84
    v_mul_f32 v85, v43, v85
    v_mul_f32 v86, v43, v86
    v_mul_f32 v87, v43, v87
    v_mul_f32 v88, v43, v88
    v_mul_f32 v89, v43, v89
    v_mul_f32 v90, v43, v90
    v_mul_f32 v91, v43, v91
    v_mul_f32 v92, v43, v92
    v_mul_f32 v93, v43, v93
    v_mul_f32 v94, v43, v94
    v_mul_f32 v95, v43, v95
    v_mul_f32 v96, v43, v96
    v_mul_f32 v97, v43, v97
    v_mul_f32 v98, v43, v98
    v_mul_f32 v99, v43, v99
    v_mul_f32 v100, v43, v100
    v_mul_f32 v101, v43, v101
    v_mul_f32 v102, v43, v102
    v_mul_f32 v103, v43, v103
    v_mul_f32 v104, v43, v104
    v_mul_f32 v105, v43, v105
    v_mul_f32 v106, v43, v106
    v_mul_f32 v107, v43, v107
    v_mul_f32 v108, v43, v108
    v_mul_f32 v109, v43, v109
    v_mul_f32 v110, v43, v110
    v_mul_f32 v111, v43, v111
    v_exp_f32 v192, v144
    v_exp_f32 v193, v145
    v_exp_f32 v194, v146
    v_exp_f32 v195, v147
    v_exp_f32 v196, v148
    v_exp_f32 v197, v149
    v_exp_f32 v198, v150
    v_exp_f32 v199, v151
    v_add_f32 v44, v192, v193
    v_add_f32 v45, v194, v195
    v_cvt_pk_bf16_f32 v176, v192, v193
    v_cvt_pk_bf16_f32 v177, v194, v195
    v_exp_f32 v200, v152
    v_exp_f32 v201, v153
    v_exp_f32 v202, v154
    v_exp_f32 v203, v155
    v_add_f32 v44, v44, v196
    v_add_f32 v45, v45, v197
    v_add_f32 v44, v44, v198
    v_add_f32 v45, v45, v199
    v_cvt_pk_bf16_f32 v178, v196, v197
    v_cvt_pk_bf16_f32 v179, v198, v199
    v_exp_f32 v204, v156
    v_exp_f32 v205, v157
    v_exp_f32 v206, v158
    v_exp_f32 v207, v159
    v_add_f32 v44, v44, v200
    v_add_f32 v45, v45, v201
    v_add_f32 v44, v44, v202
    v_add_f32 v45, v45, v203
    v_add_f32 v44, v44, v204
    v_add_f32 v45, v45, v205
    v_add_f32 v44, v44, v206
    v_add_f32 v45, v45, v207
    v_add_f32 v44, v44, v45
    v_cmp_nge_f32 vcc, s37, v44
    v_cvt_pk_bf16_f32 v180, v200, v201
    v_cvt_pk_bf16_f32 v181, v202, v203
    v_cvt_pk_bf16_f32 v182, v204, v205
    v_cvt_pk_bf16_f32 v183, v206, v207
    s_nop 3
    s_branch L_back8
L_rare9:
    s_nop 15
    v_max3_f32 v46, v160, v161, v162
    v_max3_f32 v47, v163, v164, v165
    v_max3_f32 v46, v46, v166, v167
    v_max3_f32 v47, v47, v168, v169
    v_max3_f32 v46, v46, v170, v171
    v_max3_f32 v47, v47, v172, v173
    v_max3_f32 v46, v46, v174, v175
    v_max_f32 v46, v46, v47
    v_mov_b32 v47, v46
    s_nop 1
    v_permlane32_swap_b32 v46, v47
    v_max_f32 v46, v46, v47
    v_max_f32 v46, 0, v46
    v_exp_f32 v43, -v46
    v_sub_f32 v160, v160, v46
    v_sub_f32 v161, v161, v46
    v_sub_f32 v162, v162, v46
    v_sub_f32 v163, v163, v46
    v_sub_f32 v164, v164, v46
    v_sub_f32 v165, v165, v46
    v_sub_f32 v166, v166, v46
    v_sub_f32 v167, v167, v46
    v_sub_f32 v168, v168, v46
    v_sub_f32 v169, v169, v46
    v_sub_f32 v170, v170, v46
    v_sub_f32 v171, v171, v46
    v_sub_f32 v172, v172, v46
    v_sub_f32 v173, v173, v46
    v_sub_f32 v174, v174, v46
    v_sub_f32 v175, v175, v46
    v_sub_f32 v144, v144, v46
    v_sub_f32 v145, v145, v46
    v_sub_f32 v146, v146, v46
    v_sub_f32 v147, v147, v46
    v_sub_f32 v148, v148, v46
    v_sub_f32 v149, v149, v46
    v_sub_f32 v150, v150, v46
    v_sub_f32 v151, v151, v46
    v_sub_f32 v152, v152, v46
    v_sub_f32 v153, v153, v46
    v_sub_f32 v154, v154, v46
    v_sub_f32 v155, v155, v46
    v_sub_f32 v156, v156, v46
    v_sub_f32 v157, v157, v46
    v_sub_f32 v158, v158, v46
    v_sub_f32 v159, v159, v46
    v_sub_f32 v208, v208, v46
    v_sub_f32 v209, v209, v46
    v_sub_f32 v210, v210, v46
    v_sub_f32 v211, v211, v46
    v_sub_f32 v212, v212, v46
    v_sub_f32 v213, v213, v46
    v_sub_f32 v214, v214, v46
    v_sub_f32 v215, v215, v46
    v_sub_f32 v216, v216, v46
    v_sub_f32 v217, v217, v46
    v_sub_f32 v218, v218, v46
    v_sub_f32 v219, v219, v46
    v_sub_f32 v220, v220, v46
    v_sub_f32 v221, v221, v46
    v_sub_f32 v222, v222, v46
    v_sub_f32 v223, v223, v46
    v_mul_f32 v41, v43, v41
    v_mul_f32 v48, v43, v48
    v_mul_f32 v49, v43, v49
    v_mul_f32 v50, v43, v50
    v_mul_f32 v51, v43, v51
    v_mul_f32 v52, v43, v52
    v_mul_f32 v53, v43, v53
    v_mul_f32 v54, v43, v54
    v_mul_f32 v55, v43, v55
    v_mul_f32 v56, v43, v56
    v_mul_f32 v57, v43, v57
    v_mul_f32 v58, v43, v58
    v_mul_f32 v59, v43, v59
    v_mul_f32 v60, v43, v60
    v_mul_f32 v61, v43, v61
    v_mul_f32 v62, v43, v62
    v_mul_f32 v63, v43, v63
    v_mul_f32 v64, v43, v64
    v_mul_f32 v65, v43, v65
    v_mul_f32 v66, v43, v66
    v_mul_f32 v67, v43, v67
    v_mul_f32 v68, v43, v68
    v_mul_f32 v69, v43, v69
    v_mul_f32 v70, v43, v70
    v_mul_f32 v71, v43, v71
    v_mul_f32 v72, v43, v72
    v_mul_f32 v73, v43, v73
    v_mul_f32 v74, v43, v74
    v_mul_f32 v75, v43, v75
    v_mul_f32 v76, v43, v76
    v_mul_f32 v77, v43, v77
    v_mul_f32 v78, v43, v78
    v_mul_f32 v79, v43, v79
    v_mul_f32 v80, v43, v80
    v_mul_f32 v81, v43, v81
    v_mul_f32 v82, v43, v82
    v_mul_f32 v83, v43, v83
    v_mul_f32 v84, v43, v84
    v_mul_f32 v85, v43, v85
    v_mul_f32 v86, v43, v86
    v_mul_f32 v87, v43, v87
    v_mul_f32 v88, v43, v88
    v_mul_f32 v89, v43, v89
    v_mul_f32 v90, v43, v90
    v_mul_f32 v91, v43, v91
    v_mul_f32 v92, v43, v92
    v_mul_f32 v93, v43, v93
    v_mul_f32 v94, v43, v94
    v_mul_f32 v95, v43, v95
    v_mul_f32 v96, v43, v96
    v_mul_f32 v97, v43, v97
    v_mul_f32 v98, v43, v98
    v_mul_f32 v99, v43, v99
    v_mul_f32 v100, v43, v100
    v_mul_f32 v101, v43, v101
    v_mul_f32 v102, v43, v102
    v_mul_f32 v103, v43, v103
    v_mul_f32 v104, v43, v104
    v_mul_f32 v105, v43, v105
    v_mul_f32 v106, v43, v106
    v_mul_f32 v107, v43, v107
    v_mul_f32 v108, v43, v108
    v_mul_f32 v109, v43, v109
    v_mul_f32 v110, v43, v110
    v_mul_f32 v111, v43, v111
    v_exp_f32 v192, v160
    v_exp_f32 v193, v161
    v_exp_f32 v194, v162
    v_exp_f32 v195, v163
    v_exp_f32 v196, v164
    v_exp_f32 v197, v165
    v_exp_f32 v198, v166
    v_exp_f32 v199, v167
    v_add_f32 v44, v192, v193
    v_add_f32 v45, v194, v195
    v_cvt_pk_bf16_f32 v184, v192, v193
    v_cvt_pk_bf16_f32 v185, v194, v195
    v_exp_f32 v200, v168
    v_exp_f32 v201, v169
    v_exp_f32 v202, v170
    v_exp_f32 v203, v171
    v_add_f32 v44, v44, v196
    v_add_f32 v45, v45, v197
    v_add_f32 v44, v44, v198
    v_add_f32 v45, v45, v199
    v_cvt_pk_bf16_f32 v186, v196, v197
    v_cvt_pk_bf16_f32 v187, v198, v199
    v_exp_f32 v204, v172
    v_exp_f32 v205, v173
    v_exp_f32 v206, v174
    v_exp_f32 v207, v175
    v_add_f32 v44, v44, v200
    v_add_f32 v45, v45, v201
    v_add_f32 v44, v44, v202
    v_add_f32 v45, v45, v203
    v_add_f32 v44, v44, v204
    v_add_f32 v45, v45, v205
    v_add_f32 v44, v44, v206
    v_add_f32 v45, v45, v207
    v_add_f32 v44, v44, v45
    v_cmp_nge_f32 vcc, s37, v44
    v_cvt_pk_bf16_f32 v188, v200, v201
    v_cvt_pk_bf16_f32 v189, v202, v203
    v_cvt_pk_bf16_f32 v190, v204, v205
    v_cvt_pk_bf16_f32 v191, v206, v207
    s_nop 3
    s_branch L_back9
L_rare10:
    s_nop 15
    v_max3_f32 v46, v144, v145, v146
    v_max3_f32 v47, v147, v148, v149
    v_max3_f32 v46, v46, v150, v151
    v_max3_f32 v47, v47, v152, v153
    v_max3_f32 v46, v46, v154, v155
    v_max3_f32 v47, v47, v156, v157
    v_max3_f32 v46, v46, v158, v159
    v_max_f32 v46, v46, v47
    v_mov_b32 v47, v46
    s_nop 1
    v_permlane32_swap_b32 v46, v47
    v_max_f32 v46, v46, v47
    v_max_f32 v46, 0, v46
    v_exp_f32 v43, -v46
    v_sub_f32 v144, v144, v46
    v_sub_f32 v145, v145, v46
    v_sub_f32 v146, v146, v46
    v_sub_f32 v147, v147, v46
    v_sub_f32 v148, v148, v46
    v_sub_f32 v149, v149, v46
    v_sub_f32 v150, v150, v46
    v_sub_f32 v151, v151, v46
    v_sub_f32 v152, v152, v46
    v_sub_f32 v153, v153, v46
    v_sub_f32 v154, v154, v46
    v_sub_f32 v155, v155, v46
    v_sub_f32 v156, v156, v46
    v_sub_f32 v157, v157, v46
    v_sub_f32 v158, v158, v46
    v_sub_f32 v159, v159, v46
    v_sub_f32 v160, v160, v46
    v_sub_f32 v161, v161, v46
    v_sub_f32 v162, v162, v46
    v_sub_f32 v163, v163, v46
    v_sub_f32 v164, v164, v46
    v_sub_f32 v165, v165, v46
    v_sub_f32 v166, v166, v46
    v_sub_f32 v167, v167, v46
    v_sub_f32 v168, v168, v46
    v_sub_f32 v169, v169, v46
    v_sub_f32 v170, v170, v46
    v_sub_f32 v171, v171, v46
    v_sub_f32 v172, v172, v46
    v_sub_f32 v173, v173, v46
    v_sub_f32 v174, v174, v46
    v_sub_f32 v175, v175, v46
    v_sub_f32 v208, v208, v46
    v_sub_f32 v209, v209, v46
    v_sub_f32 v210, v210, v46
    v_sub_f32 v211, v211, v46
    v_sub_f32 v212, v212, v46
    v_sub_f32 v213, v213, v46
    v_sub_f32 v214, v214, v46
    v_sub_f32 v215, v215, v46
    v_sub_f32 v216, v216, v46
    v_sub_f32 v217, v217, v46
    v_sub_f32 v218, v218, v46
    v_sub_f32 v219, v219, v46
    v_sub_f32 v220, v220, v46
    v_sub_f32 v221, v221, v46
    v_sub_f32 v222, v222, v46
    v_sub_f32 v223, v223, v46
    v_mul_f32 v41, v43, v41
    v_mul_f32 v48, v43, v48
    v_mul_f32 v49, v43, v49
    v_mul_f32 v50, v43, v50
    v_mul_f32 v51, v43, v51
    v_mul_f32 v52, v43, v52
    v_mul_f32 v53, v43, v53
    v_mul_f32 v54, v43, v54
    v_mul_f32 v55, v43, v55
    v_mul_f32 v56, v43, v56
    v_mul_f32 v57, v43, v57
    v_mul_f32 v58, v43, v58
    v_mul_f32 v59, v43, v59
    v_mul_f32 v60, v43, v60
    v_mul_f32 v61, v43, v61
    v_mul_f32 v62, v43, v62
    v_mul_f32 v63, v43, v63
    v_mul_f32 v64, v43, v64
    v_mul_f32 v65, v43, v65
    v_mul_f32 v66, v43, v66
    v_mul_f32 v67, v43, v67
    v_mul_f32 v68, v43, v68
    v_mul_f32 v69, v43, v69
    v_mul_f32 v70, v43, v70
    v_mul_f32 v71, v43, v71
    v_mul_f32 v72, v43, v72
    v_mul_f32 v73, v43, v73
    v_mul_f32 v74, v43, v74
    v_mul_f32 v75, v43, v75
    v_mul_f32 v76, v43, v76
    v_mul_f32 v77, v43, v77
    v_mul_f32 v78, v43, v78
    v_mul_f32 v79, v43, v79
    v_mul_f32 v80, v43, v80
    v_mul_f32 v81, v43, v81
    v_mul_f32 v82, v43, v82
    v_mul_f32 v83, v43, v83
    v_mul_f32 v84, v43, v84
    v_mul_f32 v85, v43, v85
    v_mul_f32 v86, v43, v86
    v_mul_f32 v87, v43, v87
    v_mul_f32 v88, v43, v88
    v_mul_f32 v89, v43, v89
    v_mul_f32 v90, v43, v90
    v_mul_f32 v91, v43, v91
    v_mul_f32 v92, v43, v92
    v_mul_f32 v93, v43, v93
    v_mul_f32 v94, v43, v94
    v_mul_f32 v95, v43, v95
    v_mul_f32 v96, v43, v96
    v_mul_f32 v97, v43, v97
    v_mul_f32 v98, v43, v98
    v_mul_f32 v99, v43, v99
    v_mul_f32 v100, v43, v100
    v_mul_f32 v101, v43, v101
    v_mul_f32 v102, v43, v102
    v_mul_f32 v103, v43, v103
    v_mul_f32 v104, v43, v104
    v_mul_f32 v105, v43, v105
    v_mul_f32 v106, v43, v106
    v_mul_f32 v107, v43, v107
    v_mul_f32 v108, v43, v108
    v_mul_f32 v109, v43, v109
    v_mul_f32 v110, v43, v110
    v_mul_f32 v111, v43, v111
    v_exp_f32 v192, v144
    v_exp_f32 v193, v145
    v_exp_f32 v194, v146
    v_exp_f32 v195, v147
    v_exp_f32 v196, v148
    v_exp_f32 v197, v149
    v_exp_f32 v198, v150
    v_exp_f32 v199, v151
    v_add_f32 v44, v192, v193
    v_add_f32 v45, v194, v195
    v_cvt_pk_bf16_f32 v176, v192, v193
    v_cvt_pk_bf16_f32 v177, v194, v195
    v_exp_f32 v200, v152
    v_exp_f32 v201, v153
    v_exp_f32 v202, v154
    v_exp_f32 v203, v155
    v_add_f32 v44, v44, v196
    v_add_f32 v45, v45, v197
    v_add_f32 v44, v44, v198
    v_add_f32 v45, v45, v199
    v_cvt_pk_bf16_f32 v178, v196, v197
    v_cvt_pk_bf16_f32 v179, v198, v199
    v_exp_f32 v204, v156
    v_exp_f32 v205, v157
    v_exp_f32 v206, v158
    v_exp_f32 v207, v159
    v_add_f32 v44, v44, v200
    v_add_f32 v45, v45, v201
    v_add_f32 v44, v44, v202
    v_add_f32 v45, v45, v203
    v_add_f32 v44, v44, v204
    v_add_f32 v45, v45, v205
    v_add_f32 v44, v44, v206
    v_add_f32 v45, v45, v207
    v_add_f32 v44, v44, v45
    v_cmp_nge_f32 vcc, s37, v44
    v_cvt_pk_bf16_f32 v180, v200, v201
    v_cvt_pk_bf16_f32 v181, v202, v203
    v_cvt_pk_bf16_f32 v182, v204, v205
    v_cvt_pk_bf16_f32 v183, v206, v207
    s_nop 3
    s_branch L_back10
L_rare11:
    s_nop 15
    v_max3_f32 v46, v160, v161, v162
    v_max3_f32 v47, v163, v164, v165
    v_max3_f32 v46, v46, v166, v167
    v_max3_f32 v47, v47, v168, v169
    v_max3_f32 v46, v46, v170, v171
    v_max3_f32 v47, v47, v172, v173
    v_max3_f32 v46, v46, v174, v175
    v_max_f32 v46, v46, v47
    v_mov_b32 v47, v46
    s_nop 1
    v_permlane32_swap_b32 v46, v47
    v_max_f32 v46, v46, v47
    v_max_f32 v46, 0, v46
    v_exp_f32 v43, -v46
    v_sub_f32 v160, v160, v46
    v_sub_f32 v161, v161, v46
    v_sub_f32 v162, v162, v46
    v_sub_f32 v163, v163, v46
    v_sub_f32 v164, v164, v46
    v_sub_f32 v165, v165, v46
    v_sub_f32 v166, v166, v46
    v_sub_f32 v167, v167, v46
    v_sub_f32 v168, v168, v46
    v_sub_f32 v169, v169, v46
    v_sub_f32 v170, v170, v46
    v_sub_f32 v171, v171, v46
    v_sub_f32 v172, v172, v46
    v_sub_f32 v173, v173, v46
    v_sub_f32 v174, v174, v46
    v_sub_f32 v175, v175, v46
    v_sub_f32 v144, v144, v46
    v_sub_f32 v145, v145, v46
    v_sub_f32 v146, v146, v46
    v_sub_f32 v147, v147, v46
    v_sub_f32 v148, v148, v46
    v_sub_f32 v149, v149, v46
    v_sub_f32 v150, v150, v46
    v_sub_f32 v151, v151, v46
    v_sub_f32 v152, v152, v46
    v_sub_f32 v153, v153, v46
    v_sub_f32 v154, v154, v46
    v_sub_f32 v155, v155, v46
    v_sub_f32 v156, v156, v46
    v_sub_f32 v157, v157, v46
    v_sub_f32 v158, v158, v46
    v_sub_f32 v159, v159, v46
    v_sub_f32 v208, v208, v46
    v_sub_f32 v209, v209, v46
    v_sub_f32 v210, v210, v46
    v_sub_f32 v211, v211, v46
    v_sub_f32 v212, v212, v46
    v_sub_f32 v213, v213, v46
    v_sub_f32 v214, v214, v46
    v_sub_f32 v215, v215, v46
    v_sub_f32 v216, v216, v46
    v_sub_f32 v217, v217, v46
    v_sub_f32 v218, v218, v46
    v_sub_f32 v219, v219, v46
    v_sub_f32 v220, v220, v46
    v_sub_f32 v221, v221, v46
    v_sub_f32 v222, v222, v46
    v_sub_f32 v223, v223, v46
    v_mul_f32 v41, v43, v41
    v_mul_f32 v48, v43, v48
    v_mul_f32 v49, v43, v49
    v_mul_f32 v50, v43, v50
    v_mul_f32 v51, v43, v51
    v_mul_f32 v52, v43, v52
    v_mul_f32 v53, v43, v53
    v_mul_f32 v54, v43, v54
    v_mul_f32 v55, v43, v55
    v_mul_f32 v56, v43, v56
    v_mul_f32 v57, v43, v57
    v_mul_f32 v58, v43, v58
    v_mul_f32 v59, v43, v59
    v_mul_f32 v60, v43, v60
    v_mul_f32 v61, v43, v61
    v_mul_f32 v62, v43, v62
    v_mul_f32 v63, v43, v63
    v_mul_f32 v64, v43, v64
    v_mul_f32 v65, v43, v65
    v_mul_f32 v66, v43, v66
    v_mul_f32 v67, v43, v67
    v_mul_f32 v68, v43, v68
    v_mul_f32 v69, v43, v69
    v_mul_f32 v70, v43, v70
    v_mul_f32 v71, v43, v71
    v_mul_f32 v72, v43, v72
    v_mul_f32 v73, v43, v73
    v_mul_f32 v74, v43, v74
    v_mul_f32 v75, v43, v75
    v_mul_f32 v76, v43, v76
    v_mul_f32 v77, v43, v77
    v_mul_f32 v78, v43, v78
    v_mul_f32 v79, v43, v79
    v_mul_f32 v80, v43, v80
    v_mul_f32 v81, v43, v81
    v_mul_f32 v82, v43, v82
    v_mul_f32 v83, v43, v83
    v_mul_f32 v84, v43, v84
    v_mul_f32 v85, v43, v85
    v_mul_f32 v86, v43, v86
    v_mul_f32 v87, v43, v87
    v_mul_f32 v88, v43, v88
    v_mul_f32 v89, v43, v89
    v_mul_f32 v90, v43, v90
    v_mul_f32 v91, v43, v91
    v_mul_f32 v92, v43, v92
    v_mul_f32 v93, v43, v93
    v_mul_f32 v94, v43, v94
    v_mul_f32 v95, v43, v95
    v_mul_f32 v96, v43, v96
    v_mul_f32 v97, v43, v97
    v_mul_f32 v98, v43, v98
    v_mul_f32 v99, v43, v99
    v_mul_f32 v100, v43, v100
    v_mul_f32 v101, v43, v101
    v_mul_f32 v102, v43, v102
    v_mul_f32 v103, v43, v103
    v_mul_f32 v104, v43, v104
    v_mul_f32 v105, v43, v105
    v_mul_f32 v106, v43, v106
    v_mul_f32 v107, v43, v107
    v_mul_f32 v108, v43, v108
    v_mul_f32 v109, v43, v109
    v_mul_f32 v110, v43, v110
    v_mul_f32 v111, v43, v111
    v_exp_f32 v192, v160
    v_exp_f32 v193, v161
    v_exp_f32 v194, v162
    v_exp_f32 v195, v163
    v_exp_f32 v196, v164
    v_exp_f32 v197, v165
    v_exp_f32 v198, v166
    v_exp_f32 v199, v167
    v_add_f32 v44, v192, v193
    v_add_f32 v45, v194, v195
    v_cvt_pk_bf16_f32 v184, v192, v193
    v_cvt_pk_bf16_f32 v185, v194, v195
    v_exp_f32 v200, v168
    v_exp_f32 v201, v169
    v_exp_f32 v202, v170
    v_exp_f32 v203, v171
    v_add_f32 v44, v44, v196
    v_add_f32 v45, v45, v197
    v_add_f32 v44, v44, v198
    v_add_f32 v45, v45, v199
    v_cvt_pk_bf16_f32 v186, v196, v197
    v_cvt_pk_bf16_f32 v187, v198, v199
    v_exp_f32 v204, v172
    v_exp_f32 v205, v173
    v_exp_f32 v206, v174
    v_exp_f32 v207, v175
    v_add_f32 v44, v44, v200
    v_add_f32 v45, v45, v201
    v_add_f32 v44, v44, v202
    v_add_f32 v45, v45, v203
    v_add_f32 v44, v44, v204
    v_add_f32 v45, v45, v205
    v_add_f32 v44, v44, v206
    v_add_f32 v45, v45, v207
    v_add_f32 v44, v44, v45
    v_cmp_nge_f32 vcc, s37, v44
    v_cvt_pk_bf16_f32 v188, v200, v201
    v_cvt_pk_bf16_f32 v189, v202, v203
    v_cvt_pk_bf16_f32 v190, v204, v205
    v_cvt_pk_bf16_f32 v191, v206, v207
    s_nop 3
    s_branch L_back11
L_rare12:
    s_nop 15
    v_max3_f32 v46, v144, v145, v146
    v_max3_f32 v47, v147, v148, v149
    v_max3_f32 v46, v46, v150, v151
    v_max3_f32 v47, v47, v152, v153
    v_max3_f32 v46, v46, v154, v155
    v_max3_f32 v47, v47, v156, v157
    v_max3_f32 v46, v46, v158, v159
    v_max_f32 v46, v46, v47
    v_mov_b32 v47, v46
    s_nop 1
    v_permlane32_swap_b32 v46, v47
    v_max_f32 v46, v46, v47
    v_max_f32 v46, 0, v46
    v_exp_f32 v43, -v46
    v_sub_f32 v144, v144, v46
    v_sub_f32 v145, v145, v46
    v_sub_f32 v146, v146, v46
    v_sub_f32 v147, v147, v46
    v_sub_f32 v148, v148, v46
    v_sub_f32 v149, v149, v46
    v_sub_f32 v150, v150, v46
    v_sub_f32 v151, v151, v46
    v_sub_f32 v152, v152, v46
    v_sub_f32 v153, v153, v46
    v_sub_f32 v154, v154, v46
    v_sub_f32 v155, v155, v46
    v_sub_f32 v156, v156, v46
    v_sub_f32 v157, v157, v46
    v_sub_f32 v158, v158, v46
    v_sub_f32 v159, v159, v46
    v_sub_f32 v160, v160, v46
    v_sub_f32 v161, v161, v46
    v_sub_f32 v162, v162, v46
    v_sub_f32 v163, v163, v46
    v_sub_f32 v164, v164, v46
    v_sub_f32 v165, v165, v46
    v_sub_f32 v166, v166, v46
    v_sub_f32 v167, v167, v46
    v_sub_f32 v168, v168, v46
    v_sub_f32 v169, v169, v46
    v_sub_f32 v170, v170, v46
    v_sub_f32 v171, v171, v46
    v_sub_f32 v172, v172, v46
    v_sub_f32 v173, v173, v46
    v_sub_f32 v174, v174, v46
    v_sub_f32 v175, v175, v46
    v_sub_f32 v208, v208, v46
    v_sub_f32 v209, v209, v46
    v_sub_f32 v210, v210, v46
    v_sub_f32 v211, v211, v46
    v_sub_f32 v212, v212, v46
    v_sub_f32 v213, v213, v46
    v_sub_f32 v214, v214, v46
    v_sub_f32 v215, v215, v46
    v_sub_f32 v216, v216, v46
    v_sub_f32 v217, v217, v46
    v_sub_f32 v218, v218, v46
    v_sub_f32 v219, v219, v46
    v_sub_f32 v220, v220, v46
    v_sub_f32 v221, v221, v46
    v_sub_f32 v222, v222, v46
    v_sub_f32 v223, v223, v46
    v_mul_f32 v41, v43, v41
    v_mul_f32 v48, v43, v48
    v_mul_f32 v49, v43, v49
    v_mul_f32 v50, v43, v50
    v_mul_f32 v51, v43, v51
    v_mul_f32 v52, v43, v52
    v_mul_f32 v53, v43, v53
    v_mul_f32 v54, v43, v54
    v_mul_f32 v55, v43, v55
    v_mul_f32 v56, v43, v56
    v_mul_f32 v57, v43, v57
    v_mul_f32 v58, v43, v58
    v_mul_f32 v59, v43, v59
    v_mul_f32 v60, v43, v60
    v_mul_f32 v61, v43, v61
    v_mul_f32 v62, v43, v62
    v_mul_f32 v63, v43, v63
    v_mul_f32 v64, v43, v64
    v_mul_f32 v65, v43, v65
    v_mul_f32 v66, v43, v66
    v_mul_f32 v67, v43, v67
    v_mul_f32 v68, v43, v68
    v_mul_f32 v69, v43, v69
    v_mul_f32 v70, v43, v70
    v_mul_f32 v71, v43, v71
    v_mul_f32 v72, v43, v72
    v_mul_f32 v73, v43, v73
    v_mul_f32 v74, v43, v74
    v_mul_f32 v75, v43, v75
    v_mul_f32 v76, v43, v76
    v_mul_f32 v77, v43, v77
    v_mul_f32 v78, v43, v78
    v_mul_f32 v79, v43, v79
    v_mul_f32 v80, v43, v80
    v_mul_f32 v81, v43, v81
    v_mul_f32 v82, v43, v82
    v_mul_f32 v83, v43, v83
    v_mul_f32 v84, v43, v84
    v_mul_f32 v85, v43, v85
    v_mul_f32 v86, v43, v86
    v_mul_f32 v87, v43, v87
    v_mul_f32 v88, v43, v88
    v_mul_f32 v89, v43, v89
    v_mul_f32 v90, v43, v90
    v_mul_f32 v91, v43, v91
    v_mul_f32 v92, v43, v92
    v_mul_f32 v93, v43, v93
    v_mul_f32 v94, v43, v94
    v_mul_f32 v95, v43, v95
    v_mul_f32 v96, v43, v96
    v_mul_f32 v97, v43, v97
    v_mul_f32 v98, v43, v98
    v_mul_f32 v99, v43, v99
    v_mul_f32 v100, v43, v100
    v_mul_f32 v101, v43, v101
    v_mul_f32 v102, v43, v102
    v_mul_f32 v103, v43, v103
    v_mul_f32 v104, v43, v104
    v_mul_f32 v105, v43, v105
    v_mul_f32 v106, v43, v106
    v_mul_f32 v107, v43, v107
    v_mul_f32 v108, v43, v108
    v_mul_f32 v109, v43, v109
    v_mul_f32 v110, v43, v110
    v_mul_f32 v111, v43, v111
    v_exp_f32 v192, v144
    v_exp_f32 v193, v145
    v_exp_f32 v194, v146
    v_exp_f32 v195, v147
    v_exp_f32 v196, v148
    v_exp_f32 v197, v149
    v_exp_f32 v198, v150
    v_exp_f32 v199, v151
    v_add_f32 v44, v192, v193
    v_add_f32 v45, v194, v195
    v_cvt_pk_bf16_f32 v176, v192, v193
    v_cvt_pk_bf16_f32 v177, v194, v195
    v_exp_f32 v200, v152
    v_exp_f32 v201, v153
    v_exp_f32 v202, v154
    v_exp_f32 v203, v155
    v_add_f32 v44, v44, v196
    v_add_f32 v45, v45, v197
    v_add_f32 v44, v44, v198
    v_add_f32 v45, v45, v199
    v_cvt_pk_bf16_f32 v178, v196, v197
    v_cvt_pk_bf16_f32 v179, v198, v199
    v_exp_f32 v204, v156
    v_exp_f32 v205, v157
    v_exp_f32 v206, v158
    v_exp_f32 v207, v159
    v_add_f32 v44, v44, v200
    v_add_f32 v45, v45, v201
    v_add_f32 v44, v44, v202
    v_add_f32 v45, v45, v203
    v_add_f32 v44, v44, v204
    v_add_f32 v45, v45, v205
    v_add_f32 v44, v44, v206
    v_add_f32 v45, v45, v207
    v_add_f32 v44, v44, v45
    v_cmp_nge_f32 vcc, s37, v44
    v_cvt_pk_bf16_f32 v180, v200, v201
    v_cvt_pk_bf16_f32 v181, v202, v203
    v_cvt_pk_bf16_f32 v182, v204, v205
    v_cvt_pk_bf16_f32 v183, v206, v207
    s_nop 3
    s_branch L_back12
L_rare13:
    s_nop 15
    v_max3_f32 v46, v160, v161, v162
    v_max3_f32 v47, v163, v164, v165
    v_max3_f32 v46, v46, v166, v167
    v_max3_f32 v47, v47, v168, v169
    v_max3_f32 v46, v46, v170, v171
    v_max3_f32 v47, v47, v172, v173
    v_max3_f32 v46, v46, v174, v175
    v_max_f32 v46, v46, v47
    v_mov_b32 v47, v46
    s_nop 1
    v_permlane32_swap_b32 v46, v47
    v_max_f32 v46, v46, v47
    v_max_f32 v46, 0, v46
    v_exp_f32 v43, -v46
    v_sub_f32 v160, v160, v46
    v_sub_f32 v161, v161, v46
    v_sub_f32 v162, v162, v46
    v_sub_f32 v163, v163, v46
    v_sub_f32 v164, v164, v46
    v_sub_f32 v165, v165, v46
    v_sub_f32 v166, v166, v46
    v_sub_f32 v167, v167, v46
    v_sub_f32 v168, v168, v46
    v_sub_f32 v169, v169, v46
    v_sub_f32 v170, v170, v46
    v_sub_f32 v171, v171, v46
    v_sub_f32 v172, v172, v46
    v_sub_f32 v173, v173, v46
    v_sub_f32 v174, v174, v46
    v_sub_f32 v175, v175, v46
    v_sub_f32 v144, v144, v46
    v_sub_f32 v145, v145, v46
    v_sub_f32 v146, v146, v46
    v_sub_f32 v147, v147, v46
    v_sub_f32 v148, v148, v46
    v_sub_f32 v149, v149, v46
    v_sub_f32 v150, v150, v46
    v_sub_f32 v151, v151, v46
    v_sub_f32 v152, v152, v46
    v_sub_f32 v153, v153, v46
    v_sub_f32 v154, v154, v46
    v_sub_f32 v155, v155, v46
    v_sub_f32 v156, v156, v46
    v_sub_f32 v157, v157, v46
    v_sub_f32 v158, v158, v46
    v_sub_f32 v159, v159, v46
    v_sub_f32 v208, v208, v46
    v_sub_f32 v209, v209, v46
    v_sub_f32 v210, v210, v46
    v_sub_f32 v211, v211, v46
    v_sub_f32 v212, v212, v46
    v_sub_f32 v213, v213, v46
    v_sub_f32 v214, v214, v46
    v_sub_f32 v215, v215, v46
    v_sub_f32 v216, v216, v46
    v_sub_f32 v217, v217, v46
    v_sub_f32 v218, v218, v46
    v_sub_f32 v219, v219, v46
    v_sub_f32 v220, v220, v46
    v_sub_f32 v221, v221, v46
    v_sub_f32 v222, v222, v46
    v_sub_f32 v223, v223, v46
    v_mul_f32 v41, v43, v41
    v_mul_f32 v48, v43, v48
    v_mul_f32 v49, v43, v49
    v_mul_f32 v50, v43, v50
    v_mul_f32 v51, v43, v51
    v_mul_f32 v52, v43, v52
    v_mul_f32 v53, v43, v53
    v_mul_f32 v54, v43, v54
    v_mul_f32 v55, v43, v55
    v_mul_f32 v56, v43, v56
    v_mul_f32 v57, v43, v57
    v_mul_f32 v58, v43, v58
    v_mul_f32 v59, v43, v59
    v_mul_f32 v60, v43, v60
    v_mul_f32 v61, v43, v61
    v_mul_f32 v62, v43, v62
    v_mul_f32 v63, v43, v63
    v_mul_f32 v64, v43, v64
    v_mul_f32 v65, v43, v65
    v_mul_f32 v66, v43, v66
    v_mul_f32 v67, v43, v67
    v_mul_f32 v68, v43, v68
    v_mul_f32 v69, v43, v69
    v_mul_f32 v70, v43, v70
    v_mul_f32 v71, v43, v71
    v_mul_f32 v72, v43, v72
    v_mul_f32 v73, v43, v73
    v_mul_f32 v74, v43, v74
    v_mul_f32 v75, v43, v75
    v_mul_f32 v76, v43, v76
    v_mul_f32 v77, v43, v77
    v_mul_f32 v78, v43, v78
    v_mul_f32 v79, v43, v79
    v_mul_f32 v80, v43, v80
    v_mul_f32 v81, v43, v81
    v_mul_f32 v82, v43, v82
    v_mul_f32 v83, v43, v83
    v_mul_f32 v84, v43, v84
    v_mul_f32 v85, v43, v85
    v_mul_f32 v86, v43, v86
    v_mul_f32 v87, v43, v87
    v_mul_f32 v88, v43, v88
    v_mul_f32 v89, v43, v89
    v_mul_f32 v90, v43, v90
    v_mul_f32 v91, v43, v91
    v_mul_f32 v92, v43, v92
    v_mul_f32 v93, v43, v93
    v_mul_f32 v94, v43, v94
    v_mul_f32 v95, v43, v95
    v_mul_f32 v96, v43, v96
    v_mul_f32 v97, v43, v97
    v_mul_f32 v98, v43, v98
    v_mul_f32 v99, v43, v99
    v_mul_f32 v100, v43, v100
    v_mul_f32 v101, v43, v101
    v_mul_f32 v102, v43, v102
    v_mul_f32 v103, v43, v103
    v_mul_f32 v104, v43, v104
    v_mul_f32 v105, v43, v105
    v_mul_f32 v106, v43, v106
    v_mul_f32 v107, v43, v107
    v_mul_f32 v108, v43, v108
    v_mul_f32 v109, v43, v109
    v_mul_f32 v110, v43, v110
    v_mul_f32 v111, v43, v111
    v_exp_f32 v192, v160
    v_exp_f32 v193, v161
    v_exp_f32 v194, v162
    v_exp_f32 v195, v163
    v_exp_f32 v196, v164
    v_exp_f32 v197, v165
    v_exp_f32 v198, v166
    v_exp_f32 v199, v167
    v_add_f32 v44, v192, v193
    v_add_f32 v45, v194, v195
    v_cvt_pk_bf16_f32 v184, v192, v193
    v_cvt_pk_bf16_f32 v185, v194, v195
    v_exp_f32 v200, v168
    v_exp_f32 v201, v169
    v_exp_f32 v202, v170
    v_exp_f32 v203, v171
    v_add_f32 v44, v44, v196
    v_add_f32 v45, v45, v197
    v_add_f32 v44, v44, v198
    v_add_f32 v45, v45, v199
    v_cvt_pk_bf16_f32 v186, v196, v197
    v_cvt_pk_bf16_f32 v187, v198, v199
    v_exp_f32 v204, v172
    v_exp_f32 v205, v173
    v_exp_f32 v206, v174
    v_exp_f32 v207, v175
    v_add_f32 v44, v44, v200
    v_add_f32 v45, v45, v201
    v_add_f32 v44, v44, v202
    v_add_f32 v45, v45, v203
    v_add_f32 v44, v44, v204
    v_add_f32 v45, v45, v205
    v_add_f32 v44, v44, v206
    v_add_f32 v45, v45, v207
    v_add_f32 v44, v44, v45
    v_cmp_nge_f32 vcc, s37, v44
    v_cvt_pk_bf16_f32 v188, v200, v201
    v_cvt_pk_bf16_f32 v189, v202, v203
    v_cvt_pk_bf16_f32 v190, v204, v205
    v_cvt_pk_bf16_f32 v191, v206, v207
    s_nop 3
    s_branch L_back13
L_rare14:
    s_nop 15
    v_max3_f32 v46, v144, v145, v146
    v_max3_f32 v47, v147, v148, v149
    v_max3_f32 v46, v46, v150, v151
    v_max3_f32 v47, v47, v152, v153
    v_max3_f32 v46, v46, v154, v155
    v_max3_f32 v47, v47, v156, v157
    v_max3_f32 v46, v46, v158, v159
    v_max_f32 v46, v46, v47
    v_mov_b32 v47, v46
    s_nop 1
    v_permlane32_swap_b32 v46, v47
    v_max_f32 v46, v46, v47
    v_max_f32 v46, 0, v46
    v_exp_f32 v43, -v46
    v_sub_f32 v144, v144, v46
    v_sub_f32 v145, v145, v46
    v_sub_f32 v146, v146, v46
    v_sub_f32 v147, v147, v46
    v_sub_f32 v148, v148, v46
    v_sub_f32 v149, v149, v46
    v_sub_f32 v150, v150, v46
    v_sub_f32 v151, v151, v46
    v_sub_f32 v152, v152, v46
    v_sub_f32 v153, v153, v46
    v_sub_f32 v154, v154, v46
    v_sub_f32 v155, v155, v46
    v_sub_f32 v156, v156, v46
    v_sub_f32 v157, v157, v46
    v_sub_f32 v158, v158, v46
    v_sub_f32 v159, v159, v46
    v_sub_f32 v160, v160, v46
    v_sub_f32 v161, v161, v46
    v_sub_f32 v162, v162, v46
    v_sub_f32 v163, v163, v46
    v_sub_f32 v164, v164, v46
    v_sub_f32 v165, v165, v46
    v_sub_f32 v166, v166, v46
    v_sub_f32 v167, v167, v46
    v_sub_f32 v168, v168, v46
    v_sub_f32 v169, v169, v46
    v_sub_f32 v170, v170, v46
    v_sub_f32 v171, v171, v46
    v_sub_f32 v172, v172, v46
    v_sub_f32 v173, v173, v46
    v_sub_f32 v174, v174, v46
    v_sub_f32 v175, v175, v46
    v_sub_f32 v208, v208, v46
    v_sub_f32 v209, v209, v46
    v_sub_f32 v210, v210, v46
    v_sub_f32 v211, v211, v46
    v_sub_f32 v212, v212, v46
    v_sub_f32 v213, v213, v46
    v_sub_f32 v214, v214, v46
    v_sub_f32 v215, v215, v46
    v_sub_f32 v216, v216, v46
    v_sub_f32 v217, v217, v46
    v_sub_f32 v218, v218, v46
    v_sub_f32 v219, v219, v46
    v_sub_f32 v220, v220, v46
    v_sub_f32 v221, v221, v46
    v_sub_f32 v222, v222, v46
    v_sub_f32 v223, v223, v46
    v_mul_f32 v41, v43, v41
    v_mul_f32 v48, v43, v48
    v_mul_f32 v49, v43, v49
    v_mul_f32 v50, v43, v50
    v_mul_f32 v51, v43, v51
    v_mul_f32 v52, v43, v52
    v_mul_f32 v53, v43, v53
    v_mul_f32 v54, v43, v54
    v_mul_f32 v55, v43, v55
    v_mul_f32 v56, v43, v56
    v_mul_f32 v57, v43, v57
    v_mul_f32 v58, v43, v58
    v_mul_f32 v59, v43, v59
    v_mul_f32 v60, v43, v60
    v_mul_f32 v61, v43, v61
    v_mul_f32 v62, v43, v62
    v_mul_f32 v63, v43, v63
    v_mul_f32 v64, v43, v64
    v_mul_f32 v65, v43, v65
    v_mul_f32 v66, v43, v66
    v_mul_f32 v67, v43, v67
    v_mul_f32 v68, v43, v68
    v_mul_f32 v69, v43, v69
    v_mul_f32 v70, v43, v70
    v_mul_f32 v71, v43, v71
    v_mul_f32 v72, v43, v72
    v_mul_f32 v73, v43, v73
    v_mul_f32 v74, v43, v74
    v_mul_f32 v75, v43, v75
    v_mul_f32 v76, v43, v76
    v_mul_f32 v77, v43, v77
    v_mul_f32 v78, v43, v78
    v_mul_f32 v79, v43, v79
    v_mul_f32 v80, v43, v80
    v_mul_f32 v81, v43, v81
    v_mul_f32 v82, v43, v82
    v_mul_f32 v83, v43, v83
    v_mul_f32 v84, v43, v84
    v_mul_f32 v85, v43, v85
    v_mul_f32 v86, v43, v86
    v_mul_f32 v87, v43, v87
    v_mul_f32 v88, v43, v88
    v_mul_f32 v89, v43, v89
    v_mul_f32 v90, v43, v90
    v_mul_f32 v91, v43, v91
    v_mul_f32 v92, v43, v92
    v_mul_f32 v93, v43, v93
    v_mul_f32 v94, v43, v94
    v_mul_f32 v95, v43, v95
    v_mul_f32 v96, v43, v96
    v_mul_f32 v97, v43, v97
    v_mul_f32 v98, v43, v98
    v_mul_f32 v99, v43, v99
    v_mul_f32 v100, v43, v100
    v_mul_f32 v101, v43, v101
    v_mul_f32 v102, v43, v102
    v_mul_f32 v103, v43, v103
    v_mul_f32 v104, v43, v104
    v_mul_f32 v105, v43, v105
    v_mul_f32 v106, v43, v106
    v_mul_f32 v107, v43, v107
    v_mul_f32 v108, v43, v108
    v_mul_f32 v109, v43, v109
    v_mul_f32 v110, v43, v110
    v_mul_f32 v111, v43, v111
    v_exp_f32 v192, v144
    v_exp_f32 v193, v145
    v_exp_f32 v194, v146
    v_exp_f32 v195, v147
    v_exp_f32 v196, v148
    v_exp_f32 v197, v149
    v_exp_f32 v198, v150
    v_exp_f32 v199, v151
    v_add_f32 v44, v192, v193
    v_add_f32 v45, v194, v195
    v_cvt_pk_bf16_f32 v176, v192, v193
    v_cvt_pk_bf16_f32 v177, v194, v195
    v_exp_f32 v200, v152
    v_exp_f32 v201, v153
    v_exp_f32 v202, v154
    v_exp_f32 v203, v155
    v_add_f32 v44, v44, v196
    v_add_f32 v45, v45, v197
    v_add_f32 v44, v44, v198
    v_add_f32 v45, v45, v199
    v_cvt_pk_bf16_f32 v178, v196, v197
    v_cvt_pk_bf16_f32 v179, v198, v199
    v_exp_f32 v204, v156
    v_exp_f32 v205, v157
    v_exp_f32 v206, v158
    v_exp_f32 v207, v159
    v_add_f32 v44, v44, v200
    v_add_f32 v45, v45, v201
    v_add_f32 v44, v44, v202
    v_add_f32 v45, v45, v203
    v_add_f32 v44, v44, v204
    v_add_f32 v45, v45, v205
    v_add_f32 v44, v44, v206
    v_add_f32 v45, v45, v207
    v_add_f32 v44, v44, v45
    v_cmp_nge_f32 vcc, s37, v44
    v_cvt_pk_bf16_f32 v180, v200, v201
    v_cvt_pk_bf16_f32 v181, v202, v203
    v_cvt_pk_bf16_f32 v182, v204, v205
    v_cvt_pk_bf16_f32 v183, v206, v207
    s_nop 3
    s_branch L_back14
L_rare15:
    s_nop 15
    v_max3_f32 v46, v160, v161, v162
    v_max3_f32 v47, v163, v164, v165
    v_max3_f32 v46, v46, v166, v167
    v_max3_f32 v47, v47, v168, v169
    v_max3_f32 v46, v46, v170, v171
    v_max3_f32 v47, v47, v172, v173
    v_max3_f32 v46, v46, v174, v175
    v_max_f32 v46, v46, v47
    v_mov_b32 v47, v46
    s_nop 1
    v_permlane32_swap_b32 v46, v47
    v_max_f32 v46, v46, v47
    v_max_f32 v46, 0, v46
    v_exp_f32 v43, -v46
    v_sub_f32 v160, v160, v46
    v_sub_f32 v161, v161, v46
    v_sub_f32 v162, v162, v46
    v_sub_f32 v163, v163, v46
    v_sub_f32 v164, v164, v46
    v_sub_f32 v165, v165, v46
    v_sub_f32 v166, v166, v46
    v_sub_f32 v167, v167, v46
    v_sub_f32 v168, v168, v46
    v_sub_f32 v169, v169, v46
    v_sub_f32 v170, v170, v46
    v_sub_f32 v171, v171, v46
    v_sub_f32 v172, v172, v46
    v_sub_f32 v173, v173, v46
    v_sub_f32 v174, v174, v46
    v_sub_f32 v175, v175, v46
    v_sub_f32 v208, v208, v46
    v_sub_f32 v209, v209, v46
    v_sub_f32 v210, v210, v46
    v_sub_f32 v211, v211, v46
    v_sub_f32 v212, v212, v46
    v_sub_f32 v213, v213, v46
    v_sub_f32 v214, v214, v46
    v_sub_f32 v215, v215, v46
    v_sub_f32 v216, v216, v46
    v_sub_f32 v217, v217, v46
    v_sub_f32 v218, v218, v46
    v_sub_f32 v219, v219, v46
    v_sub_f32 v220, v220, v46
    v_sub_f32 v221, v221, v46
    v_sub_f32 v222, v222, v46
    v_sub_f32 v223, v223, v46
    v_mul_f32 v41, v43, v41
    v_mul_f32 v48, v43, v48
    v_mul_f32 v49, v43, v49
    v_mul_f32 v50, v43, v50
    v_mul_f32 v51, v43, v51
    v_mul_f32 v52, v43, v52
    v_mul_f32 v53, v43, v53
    v_mul_f32 v54, v43, v54
    v_mul_f32 v55, v43, v55
    v_mul_f32 v56, v43, v56
    v_mul_f32 v57, v43, v57
    v_mul_f32 v58, v43, v58
    v_mul_f32 v59, v43, v59
    v_mul_f32 v60, v43, v60
    v_mul_f32 v61, v43, v61
    v_mul_f32 v62, v43, v62
    v_mul_f32 v63, v43, v63
    v_mul_f32 v64, v43, v64
    v_mul_f32 v65, v43, v65
    v_mul_f32 v66, v43, v66
    v_mul_f32 v67, v43, v67
    v_mul_f32 v68, v43, v68
    v_mul_f32 v69, v43, v69
    v_mul_f32 v70, v43, v70
    v_mul_f32 v71, v43, v71
    v_mul_f32 v72, v43, v72
    v_mul_f32 v73, v43, v73
    v_mul_f32 v74, v43, v74
    v_mul_f32 v75, v43, v75
    v_mul_f32 v76, v43, v76
    v_mul_f32 v77, v43, v77
    v_mul_f32 v78, v43, v78
    v_mul_f32 v79, v43, v79
    v_mul_f32 v80, v43, v80
    v_mul_f32 v81, v43, v81
    v_mul_f32 v82, v43, v82
    v_mul_f32 v83, v43, v83
    v_mul_f32 v84, v43, v84
    v_mul_f32 v85, v43, v85
    v_mul_f32 v86, v43, v86
    v_mul_f32 v87, v43, v87
    v_mul_f32 v88, v43, v88
    v_mul_f32 v89, v43, v89
    v_mul_f32 v90, v43, v90
    v_mul_f32 v91, v43, v91
    v_mul_f32 v92, v43, v92
    v_mul_f32 v93, v43, v93
    v_mul_f32 v94, v43, v94
    v_mul_f32 v95, v43, v95
    v_mul_f32 v96, v43, v96
    v_mul_f32 v97, v43, v97
    v_mul_f32 v98, v43, v98
    v_mul_f32 v99, v43, v99
    v_mul_f32 v100, v43, v100
    v_mul_f32 v101, v43, v101
    v_mul_f32 v102, v43, v102
    v_mul_f32 v103, v43, v103
    v_mul_f32 v104, v43, v104
    v_mul_f32 v105, v43, v105
    v_mul_f32 v106, v43, v106
    v_mul_f32 v107, v43, v107
    v_mul_f32 v108, v43, v108
    v_mul_f32 v109, v43, v109
    v_mul_f32 v110, v43, v110
    v_mul_f32 v111, v43, v111
    v_exp_f32 v192, v160
    v_exp_f32 v193, v161
    v_exp_f32 v194, v162
    v_exp_f32 v195, v163
    v_exp_f32 v196, v164
    v_exp_f32 v197, v165
    v_exp_f32 v198, v166
    v_exp_f32 v199, v167
    v_add_f32 v44, v192, v193
    v_add_f32 v45, v194, v195
    v_cvt_pk_bf16_f32 v184, v192, v193
    v_cvt_pk_bf16_f32 v185, v194, v195
    v_exp_f32 v200, v168
    v_exp_f32 v201, v169
    v_exp_f32 v202, v170
    v_exp_f32 v203, v171
    v_add_f32 v44, v44, v196
    v_add_f32 v45, v45, v197
    v_add_f32 v44, v44, v198
    v_add_f32 v45, v45, v199
    v_cvt_pk_bf16_f32 v186, v196, v197
    v_cvt_pk_bf16_f32 v187, v198, v199
    v_exp_f32 v204, v172
    v_exp_f32 v205, v173
    v_exp_f32 v206, v174
    v_exp_f32 v207, v175
    v_add_f32 v44, v44, v200
    v_add_f32 v45, v45, v201
    v_add_f32 v44, v44, v202
    v_add_f32 v45, v45, v203
    v_add_f32 v44, v44, v204
    v_add_f32 v45, v45, v205
    v_add_f32 v44, v44, v206
    v_add_f32 v45, v45, v207
    v_add_f32 v44, v44, v45
    v_cmp_nge_f32 vcc, s37, v44
    v_cvt_pk_bf16_f32 v188, v200, v201
    v_cvt_pk_bf16_f32 v189, v202, v203
    v_cvt_pk_bf16_f32 v190, v204, v205
    v_cvt_pk_bf16_f32 v191, v206, v207
    s_nop 3
    s_branch L_back15

.section .rodata,"a"
.p2align 6
.amdhsa_kernel standalone__mha_block_cached__near_ridge_kernel
  .amdhsa_next_free_vgpr 256
  .amdhsa_next_free_sgpr 102
  .amdhsa_accum_offset 224
  .amdhsa_group_segment_fixed_size 0
  .amdhsa_kernarg_size 64
  .amdhsa_user_sgpr_count 2
  .amdhsa_user_sgpr_kernarg_segment_ptr 1
  .amdhsa_system_sgpr_workgroup_id_x 1
.end_amdhsa_kernel
```
